```python
import torch

def _softmax(x, axis=-1):
    return torch.softmax(x, dim=axis)
def _gelu(x):
    return torch.nn.functional.gelu(x, approximate="tanh")
def _silu(x):
    return torch.nn.functional.silu(x)
def _sigmoid(x):
    return torch.sigmoid(x)
def _layernorm(x, axis=-1, eps=1e-5):
    m = x.mean(dim=axis, keepdim=True)
    v = x.var(dim=axis, keepdim=True, unbiased=False)
    return (x - m) / torch.sqrt(v + eps)
def _scatter_add(tgt, idx, src, axis=0):
    return tgt.clone().index_add_(axis, idx, src)
def _segment_sum(src, seg, n):
    out = torch.zeros((n,) + src.shape[1:], dtype=src.dtype)
    return out.index_add_(0, seg, src)
def _pad(x, pw):
    flat = tuple(v for pair in reversed(pw) for v in pair)
    return torch.nn.functional.pad(x, flat)

kernel_name = 'sequential_preLN__compressed_kv_cla__dense_activation_gelu__prompt'

def setup_inputs():

    _w = (lambda a: (lambda t: t.to(torch.bfloat16) if t.is_floating_point() else t)(torch.as_tensor(a)))
    def _A_setup():
        B, H, Sq, Sk, D, M = 1, 32, 2048, 2048, 128, 512
        Dc = 4 * D
        return {
            "x": _w((lambda *s: torch.randn(*s, dtype=torch.bfloat16) * 0.05)(B, Sq, M)),
            "c_kv": _w((lambda *s: torch.randn(*s, dtype=torch.bfloat16) * 0.2)(B, Sk, Dc)),
            "w_q": _w((lambda *s: torch.randn(*s, dtype=torch.bfloat16) * 6.4)(M, H, D) * (M ** -0.5)),
            "w_uk": _w((lambda *s: torch.randn(*s, dtype=torch.bfloat16) * 12.8)(Dc, H, D) * (Dc ** -0.5)),
            "w_uv": _w((lambda *s: torch.randn(*s, dtype=torch.bfloat16) * 0.2)(Dc, H, D) * (Dc ** -0.5)),
            "w_o": _w((lambda *s: torch.randn(*s, dtype=torch.bfloat16) * 0.2)(H, D, M) * ((H * D) ** -0.5)),
        }
    _A_in = _A_setup()

    def _B_setup():
        B, S, D, F = 1, 2048, 512, 1376
        return {
            "x": _w((lambda *s: torch.randn(*s, dtype=torch.bfloat16) * 0.05)(B, S, D)),
            "w1": _w((lambda *s: torch.randn(*s, dtype=torch.bfloat16) * 0.4)(D, F) * (D ** -0.5)),
            "b1": _w((lambda *s: torch.randn(*s, dtype=torch.bfloat16) * 12.8)(F) * 0.01),
            "w2": _w((lambda *s: torch.randn(*s, dtype=torch.bfloat16) * 0.2)(F, D) * (F ** -0.5)),
            "b2": _w((lambda *s: torch.randn(*s, dtype=torch.bfloat16) * 1.6)(D) * 0.01),
        }
    _B_in = _B_setup()

    return {
        "A_x": _A_in["x"],
        "A_c_kv": _A_in["c_kv"],
        "A_w_q": _A_in["w_q"],
        "A_w_uk": _A_in["w_uk"],
        "A_w_uv": _A_in["w_uv"],
        "A_w_o": _A_in["w_o"],
        "B_x": _B_in["x"],
        "B_w1": _B_in["w1"],
        "B_b1": _B_in["b1"],
        "B_w2": _B_in["w2"],
        "B_b2": _B_in["b2"],
    }

def reference(A_x, A_c_kv, A_w_q, A_w_uk, A_w_uv, A_w_o, B_x, B_w1, B_b1, B_w2, B_b2):
    def _A_ref(x, c_kv, w_q, w_uk, w_uv, w_o):
        B, Sq, M = x.shape[0], x.shape[1], x.shape[2]
        Sk = c_kv.shape[1]
        H, D = w_q.shape[1], w_q.shape[2]
        q = torch.einsum("bqm,mhd->bhqd", x, w_q)
        k = torch.einsum("bkc,chd->bhkd", c_kv, w_uk)
        v = torch.einsum("bkc,chd->bhkd", c_kv, w_uv)
        scores = torch.einsum("bhqd,bhkd->bhqk", q, k) * (D ** -0.5)
        off = Sk - Sq
        qi = torch.arange(Sq)[:, None]
        kj = torch.arange(Sk)[None, :]
        cmask = kj <= (qi + off)
        scores = torch.where(cmask[None, None], scores, -1e9)
        p = _softmax(scores, axis=-1)
        ctx = torch.einsum("bhqk,bhkd->bhqd", p, v)
        return torch.einsum("bhqd,hdm->bqm", ctx, w_o)

    def _B_ref(x, w1, b1, w2, b2):
        h = torch.einsum("bsd,df->bsf", x, w1) + b1
        h = _gelu(h)
        return torch.einsum("bsf,fd->bsd", h, w2) + b2

    x = A_x
    h = x + _A_ref(_layernorm(x, axis=-1), A_c_kv, A_w_q, A_w_uk, A_w_uv, A_w_o)
    h2 = h + _B_ref(_layernorm(h, axis=-1), B_w1, B_b1, B_w2, B_b2)
    return h2
```

```asm
; @launch kernel=ln1_kernel grid=(512,1,1) block=(256,1,1) lds=0
; @launch kernel=qkv_kernel grid=(1536,1,1) block=(256,1,1) lds=65536
; @launch kernel=attn_kernel grid=(256,1,1) block=(512,1,1) lds=131072
; @launch kernel=oproj_kernel grid=(256,1,1) block=(256,1,1) lds=65536
; @launch kernel=ln2_kernel grid=(512,1,1) block=(256,1,1) lds=0
; @launch kernel=ffn1_kernel grid=(176,1,1) block=(256,1,1) lds=65536
; @launch kernel=ffn2_kernel grid=(128,1,1) block=(256,1,1) lds=49152
.amdgcn_target "amdgcn-amd-amdhsa--gfx950"
.text
.globl ln1_kernel
.p2align 8
.type ln1_kernel,@function
ln1_kernel:
    s_cmp_ge_u32 s2, 512
    s_cbranch_scc1 ln1_kernel_done
    s_load_dwordx2 s[4:5], s[0:1], 0
    s_load_dwordx2 s[6:7], s[0:1], 104
    v_lshrrev_b32 v1, 6, v0
    v_and_b32 v2, 63, v0
    s_lshl_b32 s3, s2, 2
    v_add_u32 v1, s3, v1
    v_lshlrev_b32 v3, 10, v1
    v_lshl_add_u32 v3, v2, 4, v3
    v_xor_b32 v48, 1, v2
    v_lshlrev_b32 v48, 2, v48
    v_xor_b32 v49, 2, v2
    v_lshlrev_b32 v49, 2, v49
    v_xor_b32 v50, 4, v2
    v_lshlrev_b32 v50, 2, v50
    v_xor_b32 v51, 8, v2
    v_lshlrev_b32 v51, 2, v51
    v_xor_b32 v52, 16, v2
    v_lshlrev_b32 v52, 2, v52
    v_xor_b32 v53, 32, v2
    v_lshlrev_b32 v53, 2, v53
    s_waitcnt lgkmcnt(0)
    s_mov_b32 s8, s4
    s_and_b32 s9, s5, 0xffff
    s_mov_b32 s10, 0x200000
    s_mov_b32 s11, 0x00020000
    s_mov_b32 s12, s6
    s_and_b32 s13, s7, 0xffff
    s_mov_b32 s14, 0x200000
    s_mov_b32 s15, 0x00020000
    buffer_load_dwordx4 v[4:7], v3, s[8:11], 0 offen
    s_waitcnt vmcnt(0)
    v_lshlrev_b32 v8, 16, v4
    v_and_b32 v9, 0xffff0000, v4
    v_lshlrev_b32 v10, 16, v5
    v_and_b32 v11, 0xffff0000, v5
    v_lshlrev_b32 v12, 16, v6
    v_and_b32 v13, 0xffff0000, v6
    v_lshlrev_b32 v14, 16, v7
    v_and_b32 v15, 0xffff0000, v7
    v_add_f32 v16, v8, v9
    v_add_f32 v16, v16, v10
    v_add_f32 v16, v16, v11
    v_add_f32 v16, v16, v12
    v_add_f32 v16, v16, v13
    v_add_f32 v16, v16, v14
    v_add_f32 v16, v16, v15
    ds_bpermute_b32 v17, v48, v16
    s_waitcnt lgkmcnt(0)
    v_add_f32 v16, v16, v17
    ds_bpermute_b32 v17, v49, v16
    s_waitcnt lgkmcnt(0)
    v_add_f32 v16, v16, v17
    ds_bpermute_b32 v17, v50, v16
    s_waitcnt lgkmcnt(0)
    v_add_f32 v16, v16, v17
    ds_bpermute_b32 v17, v51, v16
    s_waitcnt lgkmcnt(0)
    v_add_f32 v16, v16, v17
    ds_bpermute_b32 v17, v52, v16
    s_waitcnt lgkmcnt(0)
    v_add_f32 v16, v16, v17
    ds_bpermute_b32 v17, v53, v16
    s_waitcnt lgkmcnt(0)
    v_add_f32 v16, v16, v17
    s_mov_b32 s24, 0x3b000000
    v_mul_f32 v16, s24, v16
    v_sub_f32 v18, v8, v16
    v_mul_f32 v19, v18, v18
    v_sub_f32 v18, v9, v16
    v_fma_f32 v19, v18, v18, v19
    v_sub_f32 v18, v10, v16
    v_fma_f32 v19, v18, v18, v19
    v_sub_f32 v18, v11, v16
    v_fma_f32 v19, v18, v18, v19
    v_sub_f32 v18, v12, v16
    v_fma_f32 v19, v18, v18, v19
    v_sub_f32 v18, v13, v16
    v_fma_f32 v19, v18, v18, v19
    v_sub_f32 v18, v14, v16
    v_fma_f32 v19, v18, v18, v19
    v_sub_f32 v18, v15, v16
    v_fma_f32 v19, v18, v18, v19
    ds_bpermute_b32 v17, v48, v19
    s_waitcnt lgkmcnt(0)
    v_add_f32 v19, v19, v17
    ds_bpermute_b32 v17, v49, v19
    s_waitcnt lgkmcnt(0)
    v_add_f32 v19, v19, v17
    ds_bpermute_b32 v17, v50, v19
    s_waitcnt lgkmcnt(0)
    v_add_f32 v19, v19, v17
    ds_bpermute_b32 v17, v51, v19
    s_waitcnt lgkmcnt(0)
    v_add_f32 v19, v19, v17
    ds_bpermute_b32 v17, v52, v19
    s_waitcnt lgkmcnt(0)
    v_add_f32 v19, v19, v17
    ds_bpermute_b32 v17, v53, v19
    s_waitcnt lgkmcnt(0)
    v_add_f32 v19, v19, v17
    v_mul_f32 v19, s24, v19
    v_cvt_pk_bf16_f32 v16, v16, v16
    v_lshlrev_b32 v16, 16, v16
    v_cvt_pk_bf16_f32 v19, v19, v19
    v_lshlrev_b32 v19, 16, v19
    s_mov_b32 s25, 0x3727c5ac
    v_add_f32 v19, s25, v19
    v_cvt_pk_bf16_f32 v19, v19, v19
    v_lshlrev_b32 v19, 16, v19
    v_sqrt_f32 v19, v19
    s_nop 0
    v_cvt_pk_bf16_f32 v19, v19, v19
    v_lshlrev_b32 v19, 16, v19
    v_rcp_f32 v19, v19
    v_sub_f32 v8, v8, v16
    v_sub_f32 v9, v9, v16
    v_cvt_pk_bf16_f32 v17, v8, v9
    v_lshlrev_b32 v8, 16, v17
    v_and_b32 v9, 0xffff0000, v17
    v_mul_f32 v8, v8, v19
    v_mul_f32 v9, v9, v19
    v_cvt_pk_bf16_f32 v4, v8, v9
    v_sub_f32 v10, v10, v16
    v_sub_f32 v11, v11, v16
    v_cvt_pk_bf16_f32 v17, v10, v11
    v_lshlrev_b32 v10, 16, v17
    v_and_b32 v11, 0xffff0000, v17
    v_mul_f32 v10, v10, v19
    v_mul_f32 v11, v11, v19
    v_cvt_pk_bf16_f32 v5, v10, v11
    v_sub_f32 v12, v12, v16
    v_sub_f32 v13, v13, v16
    v_cvt_pk_bf16_f32 v17, v12, v13
    v_lshlrev_b32 v12, 16, v17
    v_and_b32 v13, 0xffff0000, v17
    v_mul_f32 v12, v12, v19
    v_mul_f32 v13, v13, v19
    v_cvt_pk_bf16_f32 v6, v12, v13
    v_sub_f32 v14, v14, v16
    v_sub_f32 v15, v15, v16
    v_cvt_pk_bf16_f32 v17, v14, v15
    v_lshlrev_b32 v14, 16, v17
    v_and_b32 v15, 0xffff0000, v17
    v_mul_f32 v14, v14, v19
    v_mul_f32 v15, v15, v19
    v_cvt_pk_bf16_f32 v7, v14, v15
    buffer_store_dwordx4 v[4:7], v3, s[12:15], 0 offen
ln1_kernel_done:
    s_endpgm
.section .rodata,"a"
.p2align 6
.amdhsa_kernel ln1_kernel
  .amdhsa_next_free_vgpr 64
  .amdhsa_next_free_sgpr 32
  .amdhsa_accum_offset 64
  .amdhsa_group_segment_fixed_size 0
  .amdhsa_kernarg_size 112
  .amdhsa_user_sgpr_count 2
  .amdhsa_user_sgpr_kernarg_segment_ptr 1
  .amdhsa_system_sgpr_workgroup_id_x 1
.end_amdhsa_kernel
.text
.globl qkv_kernel
.p2align 8
.type qkv_kernel,@function
qkv_kernel:
    s_cmp_ge_u32 s2, 1536
    s_cbranch_scc1 qkv_kernel_done
    v_and_b32 v118, 63, v0
    v_lshrrev_b32 v110, 6, v0
    s_nop 0
    v_readfirstlane_b32 s28, v110
    s_lshr_b32 s31, s2, 9
    s_and_b32 s32, s2, 511
    s_lshr_b32 s29, s32, 5
    s_and_b32 s30, s32, 31
    s_load_dwordx2 s[4:5], s[0:1], 104
    s_load_dwordx2 s[6:7], s[0:1], 8
    s_load_dwordx4 s[44:47], s[0:1], 16
    s_load_dwordx2 s[42:43], s[0:1], 32
    s_waitcnt lgkmcnt(0)
    s_cmp_eq_u32 s31, 0
    s_cselect_b32 s6, s4, s6
    s_cselect_b32 s7, s5, s7
    s_cmp_eq_u32 s31, 1
    s_cselect_b32 s44, s46, s44
    s_cselect_b32 s45, s47, s45
    s_cmp_eq_u32 s31, 2
    s_cselect_b32 s44, s42, s44
    s_cselect_b32 s45, s43, s45
    s_lshl_b32 s32, s29, 17
    s_sub_u32 s33, 0x200000, s32
    s_add_u32 s8, s6, s32
    s_addc_u32 s9, s7, 0
    s_and_b32 s9, s9, 0xffff
    s_mov_b32 s10, s33
    s_mov_b32 s11, 0x00020000
    s_lshl_b32 s32, s30, 8
    s_sub_u32 s33, 0x400000, s32
    s_add_u32 s12, s44, s32
    s_addc_u32 s13, s45, 0
    s_and_b32 s13, s13, 0xffff
    s_mov_b32 s14, s33
    s_mov_b32 s15, 0x00020000
    s_lshl_b32 s32, s31, 24
    s_lshl_b32 s33, s29, 20
    s_add_u32 s32, s32, s33
    s_lshl_b32 s33, s30, 8
    s_add_u32 s32, s32, s33
    s_add_u32 s32, s32, 0x1000000
    s_sub_u32 s33, 0x4000000, s32
    s_add_u32 s16, s4, s32
    s_addc_u32 s17, s5, 0
    s_and_b32 s17, s17, 0xffff
    s_mov_b32 s18, s33
    s_mov_b32 s19, 0x00020000
    s_mul_i32 s32, s28, 4
    s_add_u32 s32, s32, 0
    v_lshrrev_b32 v110, 3, v118
    s_lshl_b32 s33, s32, 3
    v_add_u32 v110, s33, v110
    v_lshrrev_b32 v111, 1, v110
    v_and_b32 v111, 7, v111
    v_and_b32 v112, 7, v118
    v_xor_b32 v111, v111, v112
    v_lshlrev_b32 v111, 4, v111
    s_mov_b32 s33, 1024
    v_mul_lo_u32 v96, v110, s33
    v_add_u32 v96, v96, v111
    s_mul_i32 s32, s28, 4
    s_add_u32 s32, s32, 1
    v_lshrrev_b32 v110, 3, v118
    s_lshl_b32 s33, s32, 3
    v_add_u32 v110, s33, v110
    v_lshrrev_b32 v111, 1, v110
    v_and_b32 v111, 7, v111
    v_and_b32 v112, 7, v118
    v_xor_b32 v111, v111, v112
    v_lshlrev_b32 v111, 4, v111
    s_mov_b32 s33, 1024
    v_mul_lo_u32 v97, v110, s33
    v_add_u32 v97, v97, v111
    s_mul_i32 s32, s28, 4
    s_add_u32 s32, s32, 2
    v_lshrrev_b32 v110, 3, v118
    s_lshl_b32 s33, s32, 3
    v_add_u32 v110, s33, v110
    v_lshrrev_b32 v111, 1, v110
    v_and_b32 v111, 7, v111
    v_and_b32 v112, 7, v118
    v_xor_b32 v111, v111, v112
    v_lshlrev_b32 v111, 4, v111
    s_mov_b32 s33, 1024
    v_mul_lo_u32 v98, v110, s33
    v_add_u32 v98, v98, v111
    s_mul_i32 s32, s28, 4
    s_add_u32 s32, s32, 3
    v_lshrrev_b32 v110, 3, v118
    s_lshl_b32 s33, s32, 3
    v_add_u32 v110, s33, v110
    v_lshrrev_b32 v111, 1, v110
    v_and_b32 v111, 7, v111
    v_and_b32 v112, 7, v118
    v_xor_b32 v111, v111, v112
    v_lshlrev_b32 v111, 4, v111
    s_mov_b32 s33, 1024
    v_mul_lo_u32 v99, v110, s33
    v_add_u32 v99, v99, v111
    s_lshl_b32 s32, s28, 2
    s_add_u32 s32, s32, 0
    v_lshrrev_b32 v110, 4, v118
    v_lshlrev_b32 v111, 2, v110
    s_lshl_b32 s33, s32, 2
    v_add_u32 v110, s33, v110
    v_and_b32 v112, 15, v118
    v_xor_b32 v111, v111, v112
    v_lshlrev_b32 v111, 4, v111
    s_mov_b32 s33, 8192
    v_mul_lo_u32 v100, v110, s33
    v_add_u32 v100, v100, v111
    s_lshl_b32 s32, s28, 2
    s_add_u32 s32, s32, 1
    v_lshrrev_b32 v110, 4, v118
    v_lshlrev_b32 v111, 2, v110
    s_lshl_b32 s33, s32, 2
    v_add_u32 v110, s33, v110
    v_and_b32 v112, 15, v118
    v_xor_b32 v111, v111, v112
    v_lshlrev_b32 v111, 4, v111
    s_mov_b32 s33, 8192
    v_mul_lo_u32 v101, v110, s33
    v_add_u32 v101, v101, v111
    s_lshl_b32 s32, s28, 2
    s_add_u32 s32, s32, 2
    v_lshrrev_b32 v110, 4, v118
    v_lshlrev_b32 v111, 2, v110
    s_lshl_b32 s33, s32, 2
    v_add_u32 v110, s33, v110
    v_and_b32 v112, 15, v118
    v_xor_b32 v111, v111, v112
    v_lshlrev_b32 v111, 4, v111
    s_mov_b32 s33, 8192
    v_mul_lo_u32 v102, v110, s33
    v_add_u32 v102, v102, v111
    s_lshl_b32 s32, s28, 2
    s_add_u32 s32, s32, 3
    v_lshrrev_b32 v110, 4, v118
    v_lshlrev_b32 v111, 2, v110
    s_lshl_b32 s33, s32, 2
    v_add_u32 v110, s33, v110
    v_and_b32 v112, 15, v118
    v_xor_b32 v111, v111, v112
    v_lshlrev_b32 v111, 4, v111
    s_mov_b32 s33, 8192
    v_mul_lo_u32 v103, v110, s33
    v_add_u32 v103, v103, v111
    s_lshr_b32 s34, s28, 1
    s_and_b32 s35, s28, 1
    v_and_b32 v110, 31, v118
    s_mul_i32 s32, s34, 64
    v_add_u32 v110, s32, v110
    v_lshrrev_b32 v111, 1, v110
    v_and_b32 v111, 7, v111
    v_lshrrev_b32 v112, 5, v118
    v_xor_b32 v111, v111, v112
    v_lshlrev_b32 v111, 4, v111
    v_lshl_add_u32 v104, v110, 7, v111
    v_xor_b32 v105, 32, v104
    v_xor_b32 v106, 64, v104
    v_xor_b32 v107, 96, v104
    v_lshrrev_b32 v110, 5, v118
    v_lshlrev_b32 v110, 3, v110
    v_bfe_u32 v111, v118, 2, 2
    v_add_u32 v110, v110, v111
    v_lshlrev_b32 v110, 8, v110
    v_bfe_u32 v112, v118, 4, 1
    v_lshlrev_b32 v112, 5, v112
    v_and_b32 v113, 3, v118
    v_lshl_add_u32 v112, v113, 3, v112
    v_add_u32 v110, v110, v112
    s_lshl_b32 s32, s35, 1
    s_add_u32 s32, s32, 0
    v_xor_b32 v113, s32, v111
    v_lshl_add_u32 v108, v113, 6, v110
    s_lshl_b32 s32, s35, 1
    s_add_u32 s32, s32, 1
    v_xor_b32 v113, s32, v111
    v_lshl_add_u32 v109, v113, 6, v110
    v_mov_b32 v0, 0
    v_mov_b32 v1, 0
    v_mov_b32 v2, 0
    v_mov_b32 v3, 0
    v_mov_b32 v4, 0
    v_mov_b32 v5, 0
    v_mov_b32 v6, 0
    v_mov_b32 v7, 0
    v_mov_b32 v8, 0
    v_mov_b32 v9, 0
    v_mov_b32 v10, 0
    v_mov_b32 v11, 0
    v_mov_b32 v12, 0
    v_mov_b32 v13, 0
    v_mov_b32 v14, 0
    v_mov_b32 v15, 0
    v_mov_b32 v16, 0
    v_mov_b32 v17, 0
    v_mov_b32 v18, 0
    v_mov_b32 v19, 0
    v_mov_b32 v20, 0
    v_mov_b32 v21, 0
    v_mov_b32 v22, 0
    v_mov_b32 v23, 0
    v_mov_b32 v24, 0
    v_mov_b32 v25, 0
    v_mov_b32 v26, 0
    v_mov_b32 v27, 0
    v_mov_b32 v28, 0
    v_mov_b32 v29, 0
    v_mov_b32 v30, 0
    v_mov_b32 v31, 0
    v_mov_b32 v32, 0
    v_mov_b32 v33, 0
    v_mov_b32 v34, 0
    v_mov_b32 v35, 0
    v_mov_b32 v36, 0
    v_mov_b32 v37, 0
    v_mov_b32 v38, 0
    v_mov_b32 v39, 0
    v_mov_b32 v40, 0
    v_mov_b32 v41, 0
    v_mov_b32 v42, 0
    v_mov_b32 v43, 0
    v_mov_b32 v44, 0
    v_mov_b32 v45, 0
    v_mov_b32 v46, 0
    v_mov_b32 v47, 0
    v_mov_b32 v48, 0
    v_mov_b32 v49, 0
    v_mov_b32 v50, 0
    v_mov_b32 v51, 0
    v_mov_b32 v52, 0
    v_mov_b32 v53, 0
    v_mov_b32 v54, 0
    v_mov_b32 v55, 0
    v_mov_b32 v56, 0
    v_mov_b32 v57, 0
    v_mov_b32 v58, 0
    v_mov_b32 v59, 0
    v_mov_b32 v60, 0
    v_mov_b32 v61, 0
    v_mov_b32 v62, 0
    v_mov_b32 v63, 0
    s_mul_i32 s36, s28, 4096
    s_lshl_b32 s37, s28, 12
    s_add_u32 s37, s37, 16384
    s_mov_b32 s38, 0
    s_mov_b32 s39, 0
    s_add_u32 m0, s36, 0
    s_nop 0
    buffer_load_dwordx4 v96, s[8:11], s38 offen lds
    s_add_u32 m0, s36, 1024
    s_nop 0
    buffer_load_dwordx4 v97, s[8:11], s38 offen lds
    s_add_u32 m0, s36, 2048
    s_nop 0
    buffer_load_dwordx4 v98, s[8:11], s38 offen lds
    s_add_u32 m0, s36, 3072
    s_nop 0
    buffer_load_dwordx4 v99, s[8:11], s38 offen lds
    s_add_u32 m0, s37, 0
    s_nop 0
    buffer_load_dwordx4 v100, s[12:15], s39 offen lds
    s_add_u32 m0, s37, 1024
    s_nop 0
    buffer_load_dwordx4 v101, s[12:15], s39 offen lds
    s_add_u32 m0, s37, 2048
    s_nop 0
    buffer_load_dwordx4 v102, s[12:15], s39 offen lds
    s_add_u32 m0, s37, 3072
    s_nop 0
    buffer_load_dwordx4 v103, s[12:15], s39 offen lds
    s_add_u32 s38, s38, 128
    s_add_u32 s39, s39, 524288
    s_waitcnt vmcnt(0)
    s_barrier
    s_add_u32 m0, s36, 32768
    s_nop 0
    buffer_load_dwordx4 v96, s[8:11], s38 offen lds
    s_add_u32 m0, s36, 33792
    s_nop 0
    buffer_load_dwordx4 v97, s[8:11], s38 offen lds
    s_add_u32 m0, s36, 34816
    s_nop 0
    buffer_load_dwordx4 v98, s[8:11], s38 offen lds
    s_add_u32 m0, s36, 35840
    s_nop 0
    buffer_load_dwordx4 v99, s[8:11], s38 offen lds
    s_add_u32 m0, s37, 32768
    s_nop 0
    buffer_load_dwordx4 v100, s[12:15], s39 offen lds
    s_add_u32 m0, s37, 33792
    s_nop 0
    buffer_load_dwordx4 v101, s[12:15], s39 offen lds
    s_add_u32 m0, s37, 34816
    s_nop 0
    buffer_load_dwordx4 v102, s[12:15], s39 offen lds
    s_add_u32 m0, s37, 35840
    s_nop 0
    buffer_load_dwordx4 v103, s[12:15], s39 offen lds
    s_add_u32 s38, s38, 128
    s_add_u32 s39, s39, 524288
    ds_read_b128 v[64:67], v104 offset:0
    ds_read_b128 v[68:71], v104 offset:4096
    ds_read_b64_tr_b16 v[72:73], v108 offset:16384
    ds_read_b64_tr_b16 v[74:75], v108 offset:17408
    ds_read_b64_tr_b16 v[76:77], v109 offset:16384
    ds_read_b64_tr_b16 v[78:79], v109 offset:17408
    ds_read_b128 v[80:83], v105 offset:0
    ds_read_b128 v[84:87], v105 offset:4096
    ds_read_b64_tr_b16 v[88:89], v108 offset:20480
    ds_read_b64_tr_b16 v[90:91], v108 offset:21504
    ds_read_b64_tr_b16 v[92:93], v109 offset:20480
    ds_read_b64_tr_b16 v[94:95], v109 offset:21504
    s_waitcnt lgkmcnt(6)
    v_mfma_f32_32x32x16_bf16 v[0:15], v[72:75], v[64:67], v[0:15]
    v_mfma_f32_32x32x16_bf16 v[16:31], v[76:79], v[64:67], v[16:31]
    v_mfma_f32_32x32x16_bf16 v[32:47], v[72:75], v[68:71], v[32:47]
    v_mfma_f32_32x32x16_bf16 v[48:63], v[76:79], v[68:71], v[48:63]
    ds_read_b128 v[64:67], v106 offset:0
    ds_read_b128 v[68:71], v106 offset:4096
    ds_read_b64_tr_b16 v[72:73], v108 offset:24576
    ds_read_b64_tr_b16 v[74:75], v108 offset:25600
    ds_read_b64_tr_b16 v[76:77], v109 offset:24576
    ds_read_b64_tr_b16 v[78:79], v109 offset:25600
    s_waitcnt lgkmcnt(6)
    v_mfma_f32_32x32x16_bf16 v[0:15], v[88:91], v[80:83], v[0:15]
    v_mfma_f32_32x32x16_bf16 v[16:31], v[92:95], v[80:83], v[16:31]
    v_mfma_f32_32x32x16_bf16 v[32:47], v[88:91], v[84:87], v[32:47]
    v_mfma_f32_32x32x16_bf16 v[48:63], v[92:95], v[84:87], v[48:63]
    ds_read_b128 v[80:83], v107 offset:0
    ds_read_b128 v[84:87], v107 offset:4096
    ds_read_b64_tr_b16 v[88:89], v108 offset:28672
    ds_read_b64_tr_b16 v[90:91], v108 offset:29696
    ds_read_b64_tr_b16 v[92:93], v109 offset:28672
    ds_read_b64_tr_b16 v[94:95], v109 offset:29696
    s_waitcnt lgkmcnt(6)
    v_mfma_f32_32x32x16_bf16 v[0:15], v[72:75], v[64:67], v[0:15]
    v_mfma_f32_32x32x16_bf16 v[16:31], v[76:79], v[64:67], v[16:31]
    v_mfma_f32_32x32x16_bf16 v[32:47], v[72:75], v[68:71], v[32:47]
    v_mfma_f32_32x32x16_bf16 v[48:63], v[76:79], v[68:71], v[48:63]
    s_waitcnt lgkmcnt(0)
    v_mfma_f32_32x32x16_bf16 v[0:15], v[88:91], v[80:83], v[0:15]
    v_mfma_f32_32x32x16_bf16 v[16:31], v[92:95], v[80:83], v[16:31]
    v_mfma_f32_32x32x16_bf16 v[32:47], v[88:91], v[84:87], v[32:47]
    v_mfma_f32_32x32x16_bf16 v[48:63], v[92:95], v[84:87], v[48:63]
    s_waitcnt vmcnt(0)
    s_barrier
    s_add_u32 m0, s36, 0
    s_nop 0
    buffer_load_dwordx4 v96, s[8:11], s38 offen lds
    s_add_u32 m0, s36, 1024
    s_nop 0
    buffer_load_dwordx4 v97, s[8:11], s38 offen lds
    s_add_u32 m0, s36, 2048
    s_nop 0
    buffer_load_dwordx4 v98, s[8:11], s38 offen lds
    s_add_u32 m0, s36, 3072
    s_nop 0
    buffer_load_dwordx4 v99, s[8:11], s38 offen lds
    s_add_u32 m0, s37, 0
    s_nop 0
    buffer_load_dwordx4 v100, s[12:15], s39 offen lds
    s_add_u32 m0, s37, 1024
    s_nop 0
    buffer_load_dwordx4 v101, s[12:15], s39 offen lds
    s_add_u32 m0, s37, 2048
    s_nop 0
    buffer_load_dwordx4 v102, s[12:15], s39 offen lds
    s_add_u32 m0, s37, 3072
    s_nop 0
    buffer_load_dwordx4 v103, s[12:15], s39 offen lds
    s_add_u32 s38, s38, 128
    s_add_u32 s39, s39, 524288
    ds_read_b128 v[64:67], v104 offset:32768
    ds_read_b128 v[68:71], v104 offset:36864
    ds_read_b64_tr_b16 v[72:73], v108 offset:49152
    ds_read_b64_tr_b16 v[74:75], v108 offset:50176
    ds_read_b64_tr_b16 v[76:77], v109 offset:49152
    ds_read_b64_tr_b16 v[78:79], v109 offset:50176
    ds_read_b128 v[80:83], v105 offset:32768
    ds_read_b128 v[84:87], v105 offset:36864
    ds_read_b64_tr_b16 v[88:89], v108 offset:53248
    ds_read_b64_tr_b16 v[90:91], v108 offset:54272
    ds_read_b64_tr_b16 v[92:93], v109 offset:53248
    ds_read_b64_tr_b16 v[94:95], v109 offset:54272
    s_waitcnt lgkmcnt(6)
    v_mfma_f32_32x32x16_bf16 v[0:15], v[72:75], v[64:67], v[0:15]
    v_mfma_f32_32x32x16_bf16 v[16:31], v[76:79], v[64:67], v[16:31]
    v_mfma_f32_32x32x16_bf16 v[32:47], v[72:75], v[68:71], v[32:47]
    v_mfma_f32_32x32x16_bf16 v[48:63], v[76:79], v[68:71], v[48:63]
    ds_read_b128 v[64:67], v106 offset:32768
    ds_read_b128 v[68:71], v106 offset:36864
    ds_read_b64_tr_b16 v[72:73], v108 offset:57344
    ds_read_b64_tr_b16 v[74:75], v108 offset:58368
    ds_read_b64_tr_b16 v[76:77], v109 offset:57344
    ds_read_b64_tr_b16 v[78:79], v109 offset:58368
    s_waitcnt lgkmcnt(6)
    v_mfma_f32_32x32x16_bf16 v[0:15], v[88:91], v[80:83], v[0:15]
    v_mfma_f32_32x32x16_bf16 v[16:31], v[92:95], v[80:83], v[16:31]
    v_mfma_f32_32x32x16_bf16 v[32:47], v[88:91], v[84:87], v[32:47]
    v_mfma_f32_32x32x16_bf16 v[48:63], v[92:95], v[84:87], v[48:63]
    ds_read_b128 v[80:83], v107 offset:32768
    ds_read_b128 v[84:87], v107 offset:36864
    ds_read_b64_tr_b16 v[88:89], v108 offset:61440
    ds_read_b64_tr_b16 v[90:91], v108 offset:62464
    ds_read_b64_tr_b16 v[92:93], v109 offset:61440
    ds_read_b64_tr_b16 v[94:95], v109 offset:62464
    s_waitcnt lgkmcnt(6)
    v_mfma_f32_32x32x16_bf16 v[0:15], v[72:75], v[64:67], v[0:15]
    v_mfma_f32_32x32x16_bf16 v[16:31], v[76:79], v[64:67], v[16:31]
    v_mfma_f32_32x32x16_bf16 v[32:47], v[72:75], v[68:71], v[32:47]
    v_mfma_f32_32x32x16_bf16 v[48:63], v[76:79], v[68:71], v[48:63]
    s_waitcnt lgkmcnt(0)
    v_mfma_f32_32x32x16_bf16 v[0:15], v[88:91], v[80:83], v[0:15]
    v_mfma_f32_32x32x16_bf16 v[16:31], v[92:95], v[80:83], v[16:31]
    v_mfma_f32_32x32x16_bf16 v[32:47], v[88:91], v[84:87], v[32:47]
    v_mfma_f32_32x32x16_bf16 v[48:63], v[92:95], v[84:87], v[48:63]
    s_waitcnt vmcnt(0)
    s_barrier
    s_add_u32 m0, s36, 32768
    s_nop 0
    buffer_load_dwordx4 v96, s[8:11], s38 offen lds
    s_add_u32 m0, s36, 33792
    s_nop 0
    buffer_load_dwordx4 v97, s[8:11], s38 offen lds
    s_add_u32 m0, s36, 34816
    s_nop 0
    buffer_load_dwordx4 v98, s[8:11], s38 offen lds
    s_add_u32 m0, s36, 35840
    s_nop 0
    buffer_load_dwordx4 v99, s[8:11], s38 offen lds
    s_add_u32 m0, s37, 32768
    s_nop 0
    buffer_load_dwordx4 v100, s[12:15], s39 offen lds
    s_add_u32 m0, s37, 33792
    s_nop 0
    buffer_load_dwordx4 v101, s[12:15], s39 offen lds
    s_add_u32 m0, s37, 34816
    s_nop 0
    buffer_load_dwordx4 v102, s[12:15], s39 offen lds
    s_add_u32 m0, s37, 35840
    s_nop 0
    buffer_load_dwordx4 v103, s[12:15], s39 offen lds
    s_add_u32 s38, s38, 128
    s_add_u32 s39, s39, 524288
    ds_read_b128 v[64:67], v104 offset:0
    ds_read_b128 v[68:71], v104 offset:4096
    ds_read_b64_tr_b16 v[72:73], v108 offset:16384
    ds_read_b64_tr_b16 v[74:75], v108 offset:17408
    ds_read_b64_tr_b16 v[76:77], v109 offset:16384
    ds_read_b64_tr_b16 v[78:79], v109 offset:17408
    ds_read_b128 v[80:83], v105 offset:0
    ds_read_b128 v[84:87], v105 offset:4096
    ds_read_b64_tr_b16 v[88:89], v108 offset:20480
    ds_read_b64_tr_b16 v[90:91], v108 offset:21504
    ds_read_b64_tr_b16 v[92:93], v109 offset:20480
    ds_read_b64_tr_b16 v[94:95], v109 offset:21504
    s_waitcnt lgkmcnt(6)
    v_mfma_f32_32x32x16_bf16 v[0:15], v[72:75], v[64:67], v[0:15]
    v_mfma_f32_32x32x16_bf16 v[16:31], v[76:79], v[64:67], v[16:31]
    v_mfma_f32_32x32x16_bf16 v[32:47], v[72:75], v[68:71], v[32:47]
    v_mfma_f32_32x32x16_bf16 v[48:63], v[76:79], v[68:71], v[48:63]
    ds_read_b128 v[64:67], v106 offset:0
    ds_read_b128 v[68:71], v106 offset:4096
    ds_read_b64_tr_b16 v[72:73], v108 offset:24576
    ds_read_b64_tr_b16 v[74:75], v108 offset:25600
    ds_read_b64_tr_b16 v[76:77], v109 offset:24576
    ds_read_b64_tr_b16 v[78:79], v109 offset:25600
    s_waitcnt lgkmcnt(6)
    v_mfma_f32_32x32x16_bf16 v[0:15], v[88:91], v[80:83], v[0:15]
    v_mfma_f32_32x32x16_bf16 v[16:31], v[92:95], v[80:83], v[16:31]
    v_mfma_f32_32x32x16_bf16 v[32:47], v[88:91], v[84:87], v[32:47]
    v_mfma_f32_32x32x16_bf16 v[48:63], v[92:95], v[84:87], v[48:63]
    ds_read_b128 v[80:83], v107 offset:0
    ds_read_b128 v[84:87], v107 offset:4096
    ds_read_b64_tr_b16 v[88:89], v108 offset:28672
    ds_read_b64_tr_b16 v[90:91], v108 offset:29696
    ds_read_b64_tr_b16 v[92:93], v109 offset:28672
    ds_read_b64_tr_b16 v[94:95], v109 offset:29696
    s_waitcnt lgkmcnt(6)
    v_mfma_f32_32x32x16_bf16 v[0:15], v[72:75], v[64:67], v[0:15]
    v_mfma_f32_32x32x16_bf16 v[16:31], v[76:79], v[64:67], v[16:31]
    v_mfma_f32_32x32x16_bf16 v[32:47], v[72:75], v[68:71], v[32:47]
    v_mfma_f32_32x32x16_bf16 v[48:63], v[76:79], v[68:71], v[48:63]
    s_waitcnt lgkmcnt(0)
    v_mfma_f32_32x32x16_bf16 v[0:15], v[88:91], v[80:83], v[0:15]
    v_mfma_f32_32x32x16_bf16 v[16:31], v[92:95], v[80:83], v[16:31]
    v_mfma_f32_32x32x16_bf16 v[32:47], v[88:91], v[84:87], v[32:47]
    v_mfma_f32_32x32x16_bf16 v[48:63], v[92:95], v[84:87], v[48:63]
    s_waitcnt vmcnt(0)
    s_barrier
    s_add_u32 m0, s36, 0
    s_nop 0
    buffer_load_dwordx4 v96, s[8:11], s38 offen lds
    s_add_u32 m0, s36, 1024
    s_nop 0
    buffer_load_dwordx4 v97, s[8:11], s38 offen lds
    s_add_u32 m0, s36, 2048
    s_nop 0
    buffer_load_dwordx4 v98, s[8:11], s38 offen lds
    s_add_u32 m0, s36, 3072
    s_nop 0
    buffer_load_dwordx4 v99, s[8:11], s38 offen lds
    s_add_u32 m0, s37, 0
    s_nop 0
    buffer_load_dwordx4 v100, s[12:15], s39 offen lds
    s_add_u32 m0, s37, 1024
    s_nop 0
    buffer_load_dwordx4 v101, s[12:15], s39 offen lds
    s_add_u32 m0, s37, 2048
    s_nop 0
    buffer_load_dwordx4 v102, s[12:15], s39 offen lds
    s_add_u32 m0, s37, 3072
    s_nop 0
    buffer_load_dwordx4 v103, s[12:15], s39 offen lds
    s_add_u32 s38, s38, 128
    s_add_u32 s39, s39, 524288
    ds_read_b128 v[64:67], v104 offset:32768
    ds_read_b128 v[68:71], v104 offset:36864
    ds_read_b64_tr_b16 v[72:73], v108 offset:49152
    ds_read_b64_tr_b16 v[74:75], v108 offset:50176
    ds_read_b64_tr_b16 v[76:77], v109 offset:49152
    ds_read_b64_tr_b16 v[78:79], v109 offset:50176
    ds_read_b128 v[80:83], v105 offset:32768
    ds_read_b128 v[84:87], v105 offset:36864
    ds_read_b64_tr_b16 v[88:89], v108 offset:53248
    ds_read_b64_tr_b16 v[90:91], v108 offset:54272
    ds_read_b64_tr_b16 v[92:93], v109 offset:53248
    ds_read_b64_tr_b16 v[94:95], v109 offset:54272
    s_waitcnt lgkmcnt(6)
    v_mfma_f32_32x32x16_bf16 v[0:15], v[72:75], v[64:67], v[0:15]
    v_mfma_f32_32x32x16_bf16 v[16:31], v[76:79], v[64:67], v[16:31]
    v_mfma_f32_32x32x16_bf16 v[32:47], v[72:75], v[68:71], v[32:47]
    v_mfma_f32_32x32x16_bf16 v[48:63], v[76:79], v[68:71], v[48:63]
    ds_read_b128 v[64:67], v106 offset:32768
    ds_read_b128 v[68:71], v106 offset:36864
    ds_read_b64_tr_b16 v[72:73], v108 offset:57344
    ds_read_b64_tr_b16 v[74:75], v108 offset:58368
    ds_read_b64_tr_b16 v[76:77], v109 offset:57344
    ds_read_b64_tr_b16 v[78:79], v109 offset:58368
    s_waitcnt lgkmcnt(6)
    v_mfma_f32_32x32x16_bf16 v[0:15], v[88:91], v[80:83], v[0:15]
    v_mfma_f32_32x32x16_bf16 v[16:31], v[92:95], v[80:83], v[16:31]
    v_mfma_f32_32x32x16_bf16 v[32:47], v[88:91], v[84:87], v[32:47]
    v_mfma_f32_32x32x16_bf16 v[48:63], v[92:95], v[84:87], v[48:63]
    ds_read_b128 v[80:83], v107 offset:32768
    ds_read_b128 v[84:87], v107 offset:36864
    ds_read_b64_tr_b16 v[88:89], v108 offset:61440
    ds_read_b64_tr_b16 v[90:91], v108 offset:62464
    ds_read_b64_tr_b16 v[92:93], v109 offset:61440
    ds_read_b64_tr_b16 v[94:95], v109 offset:62464
    s_waitcnt lgkmcnt(6)
    v_mfma_f32_32x32x16_bf16 v[0:15], v[72:75], v[64:67], v[0:15]
    v_mfma_f32_32x32x16_bf16 v[16:31], v[76:79], v[64:67], v[16:31]
    v_mfma_f32_32x32x16_bf16 v[32:47], v[72:75], v[68:71], v[32:47]
    v_mfma_f32_32x32x16_bf16 v[48:63], v[76:79], v[68:71], v[48:63]
    s_waitcnt lgkmcnt(0)
    v_mfma_f32_32x32x16_bf16 v[0:15], v[88:91], v[80:83], v[0:15]
    v_mfma_f32_32x32x16_bf16 v[16:31], v[92:95], v[80:83], v[16:31]
    v_mfma_f32_32x32x16_bf16 v[32:47], v[88:91], v[84:87], v[32:47]
    v_mfma_f32_32x32x16_bf16 v[48:63], v[92:95], v[84:87], v[48:63]
    s_waitcnt vmcnt(0)
    s_barrier
    s_add_u32 m0, s36, 32768
    s_nop 0
    buffer_load_dwordx4 v96, s[8:11], s38 offen lds
    s_add_u32 m0, s36, 33792
    s_nop 0
    buffer_load_dwordx4 v97, s[8:11], s38 offen lds
    s_add_u32 m0, s36, 34816
    s_nop 0
    buffer_load_dwordx4 v98, s[8:11], s38 offen lds
    s_add_u32 m0, s36, 35840
    s_nop 0
    buffer_load_dwordx4 v99, s[8:11], s38 offen lds
    s_add_u32 m0, s37, 32768
    s_nop 0
    buffer_load_dwordx4 v100, s[12:15], s39 offen lds
    s_add_u32 m0, s37, 33792
    s_nop 0
    buffer_load_dwordx4 v101, s[12:15], s39 offen lds
    s_add_u32 m0, s37, 34816
    s_nop 0
    buffer_load_dwordx4 v102, s[12:15], s39 offen lds
    s_add_u32 m0, s37, 35840
    s_nop 0
    buffer_load_dwordx4 v103, s[12:15], s39 offen lds
    s_add_u32 s38, s38, 128
    s_add_u32 s39, s39, 524288
    ds_read_b128 v[64:67], v104 offset:0
    ds_read_b128 v[68:71], v104 offset:4096
    ds_read_b64_tr_b16 v[72:73], v108 offset:16384
    ds_read_b64_tr_b16 v[74:75], v108 offset:17408
    ds_read_b64_tr_b16 v[76:77], v109 offset:16384
    ds_read_b64_tr_b16 v[78:79], v109 offset:17408
    ds_read_b128 v[80:83], v105 offset:0
    ds_read_b128 v[84:87], v105 offset:4096
    ds_read_b64_tr_b16 v[88:89], v108 offset:20480
    ds_read_b64_tr_b16 v[90:91], v108 offset:21504
    ds_read_b64_tr_b16 v[92:93], v109 offset:20480
    ds_read_b64_tr_b16 v[94:95], v109 offset:21504
    s_waitcnt lgkmcnt(6)
    v_mfma_f32_32x32x16_bf16 v[0:15], v[72:75], v[64:67], v[0:15]
    v_mfma_f32_32x32x16_bf16 v[16:31], v[76:79], v[64:67], v[16:31]
    v_mfma_f32_32x32x16_bf16 v[32:47], v[72:75], v[68:71], v[32:47]
    v_mfma_f32_32x32x16_bf16 v[48:63], v[76:79], v[68:71], v[48:63]
    ds_read_b128 v[64:67], v106 offset:0
    ds_read_b128 v[68:71], v106 offset:4096
    ds_read_b64_tr_b16 v[72:73], v108 offset:24576
    ds_read_b64_tr_b16 v[74:75], v108 offset:25600
    ds_read_b64_tr_b16 v[76:77], v109 offset:24576
    ds_read_b64_tr_b16 v[78:79], v109 offset:25600
    s_waitcnt lgkmcnt(6)
    v_mfma_f32_32x32x16_bf16 v[0:15], v[88:91], v[80:83], v[0:15]
    v_mfma_f32_32x32x16_bf16 v[16:31], v[92:95], v[80:83], v[16:31]
    v_mfma_f32_32x32x16_bf16 v[32:47], v[88:91], v[84:87], v[32:47]
    v_mfma_f32_32x32x16_bf16 v[48:63], v[92:95], v[84:87], v[48:63]
    ds_read_b128 v[80:83], v107 offset:0
    ds_read_b128 v[84:87], v107 offset:4096
    ds_read_b64_tr_b16 v[88:89], v108 offset:28672
    ds_read_b64_tr_b16 v[90:91], v108 offset:29696
    ds_read_b64_tr_b16 v[92:93], v109 offset:28672
    ds_read_b64_tr_b16 v[94:95], v109 offset:29696
    s_waitcnt lgkmcnt(6)
    v_mfma_f32_32x32x16_bf16 v[0:15], v[72:75], v[64:67], v[0:15]
    v_mfma_f32_32x32x16_bf16 v[16:31], v[76:79], v[64:67], v[16:31]
    v_mfma_f32_32x32x16_bf16 v[32:47], v[72:75], v[68:71], v[32:47]
    v_mfma_f32_32x32x16_bf16 v[48:63], v[76:79], v[68:71], v[48:63]
    s_waitcnt lgkmcnt(0)
    v_mfma_f32_32x32x16_bf16 v[0:15], v[88:91], v[80:83], v[0:15]
    v_mfma_f32_32x32x16_bf16 v[16:31], v[92:95], v[80:83], v[16:31]
    v_mfma_f32_32x32x16_bf16 v[32:47], v[88:91], v[84:87], v[32:47]
    v_mfma_f32_32x32x16_bf16 v[48:63], v[92:95], v[84:87], v[48:63]
    s_waitcnt vmcnt(0)
    s_barrier
    s_add_u32 m0, s36, 0
    s_nop 0
    buffer_load_dwordx4 v96, s[8:11], s38 offen lds
    s_add_u32 m0, s36, 1024
    s_nop 0
    buffer_load_dwordx4 v97, s[8:11], s38 offen lds
    s_add_u32 m0, s36, 2048
    s_nop 0
    buffer_load_dwordx4 v98, s[8:11], s38 offen lds
    s_add_u32 m0, s36, 3072
    s_nop 0
    buffer_load_dwordx4 v99, s[8:11], s38 offen lds
    s_add_u32 m0, s37, 0
    s_nop 0
    buffer_load_dwordx4 v100, s[12:15], s39 offen lds
    s_add_u32 m0, s37, 1024
    s_nop 0
    buffer_load_dwordx4 v101, s[12:15], s39 offen lds
    s_add_u32 m0, s37, 2048
    s_nop 0
    buffer_load_dwordx4 v102, s[12:15], s39 offen lds
    s_add_u32 m0, s37, 3072
    s_nop 0
    buffer_load_dwordx4 v103, s[12:15], s39 offen lds
    s_add_u32 s38, s38, 128
    s_add_u32 s39, s39, 524288
    ds_read_b128 v[64:67], v104 offset:32768
    ds_read_b128 v[68:71], v104 offset:36864
    ds_read_b64_tr_b16 v[72:73], v108 offset:49152
    ds_read_b64_tr_b16 v[74:75], v108 offset:50176
    ds_read_b64_tr_b16 v[76:77], v109 offset:49152
    ds_read_b64_tr_b16 v[78:79], v109 offset:50176
    ds_read_b128 v[80:83], v105 offset:32768
    ds_read_b128 v[84:87], v105 offset:36864
    ds_read_b64_tr_b16 v[88:89], v108 offset:53248
    ds_read_b64_tr_b16 v[90:91], v108 offset:54272
    ds_read_b64_tr_b16 v[92:93], v109 offset:53248
    ds_read_b64_tr_b16 v[94:95], v109 offset:54272
    s_waitcnt lgkmcnt(6)
    v_mfma_f32_32x32x16_bf16 v[0:15], v[72:75], v[64:67], v[0:15]
    v_mfma_f32_32x32x16_bf16 v[16:31], v[76:79], v[64:67], v[16:31]
    v_mfma_f32_32x32x16_bf16 v[32:47], v[72:75], v[68:71], v[32:47]
    v_mfma_f32_32x32x16_bf16 v[48:63], v[76:79], v[68:71], v[48:63]
    ds_read_b128 v[64:67], v106 offset:32768
    ds_read_b128 v[68:71], v106 offset:36864
    ds_read_b64_tr_b16 v[72:73], v108 offset:57344
    ds_read_b64_tr_b16 v[74:75], v108 offset:58368
    ds_read_b64_tr_b16 v[76:77], v109 offset:57344
    ds_read_b64_tr_b16 v[78:79], v109 offset:58368
    s_waitcnt lgkmcnt(6)
    v_mfma_f32_32x32x16_bf16 v[0:15], v[88:91], v[80:83], v[0:15]
    v_mfma_f32_32x32x16_bf16 v[16:31], v[92:95], v[80:83], v[16:31]
    v_mfma_f32_32x32x16_bf16 v[32:47], v[88:91], v[84:87], v[32:47]
    v_mfma_f32_32x32x16_bf16 v[48:63], v[92:95], v[84:87], v[48:63]
    ds_read_b128 v[80:83], v107 offset:32768
    ds_read_b128 v[84:87], v107 offset:36864
    ds_read_b64_tr_b16 v[88:89], v108 offset:61440
    ds_read_b64_tr_b16 v[90:91], v108 offset:62464
    ds_read_b64_tr_b16 v[92:93], v109 offset:61440
    ds_read_b64_tr_b16 v[94:95], v109 offset:62464
    s_waitcnt lgkmcnt(6)
    v_mfma_f32_32x32x16_bf16 v[0:15], v[72:75], v[64:67], v[0:15]
    v_mfma_f32_32x32x16_bf16 v[16:31], v[76:79], v[64:67], v[16:31]
    v_mfma_f32_32x32x16_bf16 v[32:47], v[72:75], v[68:71], v[32:47]
    v_mfma_f32_32x32x16_bf16 v[48:63], v[76:79], v[68:71], v[48:63]
    s_waitcnt lgkmcnt(0)
    v_mfma_f32_32x32x16_bf16 v[0:15], v[88:91], v[80:83], v[0:15]
    v_mfma_f32_32x32x16_bf16 v[16:31], v[92:95], v[80:83], v[16:31]
    v_mfma_f32_32x32x16_bf16 v[32:47], v[88:91], v[84:87], v[32:47]
    v_mfma_f32_32x32x16_bf16 v[48:63], v[92:95], v[84:87], v[48:63]
    s_waitcnt vmcnt(0)
    s_barrier
    s_add_u32 m0, s36, 32768
    s_nop 0
    buffer_load_dwordx4 v96, s[8:11], s38 offen lds
    s_add_u32 m0, s36, 33792
    s_nop 0
    buffer_load_dwordx4 v97, s[8:11], s38 offen lds
    s_add_u32 m0, s36, 34816
    s_nop 0
    buffer_load_dwordx4 v98, s[8:11], s38 offen lds
    s_add_u32 m0, s36, 35840
    s_nop 0
    buffer_load_dwordx4 v99, s[8:11], s38 offen lds
    s_add_u32 m0, s37, 32768
    s_nop 0
    buffer_load_dwordx4 v100, s[12:15], s39 offen lds
    s_add_u32 m0, s37, 33792
    s_nop 0
    buffer_load_dwordx4 v101, s[12:15], s39 offen lds
    s_add_u32 m0, s37, 34816
    s_nop 0
    buffer_load_dwordx4 v102, s[12:15], s39 offen lds
    s_add_u32 m0, s37, 35840
    s_nop 0
    buffer_load_dwordx4 v103, s[12:15], s39 offen lds
    s_add_u32 s38, s38, 128
    s_add_u32 s39, s39, 524288
    ds_read_b128 v[64:67], v104 offset:0
    ds_read_b128 v[68:71], v104 offset:4096
    ds_read_b64_tr_b16 v[72:73], v108 offset:16384
    ds_read_b64_tr_b16 v[74:75], v108 offset:17408
    ds_read_b64_tr_b16 v[76:77], v109 offset:16384
    ds_read_b64_tr_b16 v[78:79], v109 offset:17408
    ds_read_b128 v[80:83], v105 offset:0
    ds_read_b128 v[84:87], v105 offset:4096
    ds_read_b64_tr_b16 v[88:89], v108 offset:20480
    ds_read_b64_tr_b16 v[90:91], v108 offset:21504
    ds_read_b64_tr_b16 v[92:93], v109 offset:20480
    ds_read_b64_tr_b16 v[94:95], v109 offset:21504
    s_waitcnt lgkmcnt(6)
    v_mfma_f32_32x32x16_bf16 v[0:15], v[72:75], v[64:67], v[0:15]
    v_mfma_f32_32x32x16_bf16 v[16:31], v[76:79], v[64:67], v[16:31]
    v_mfma_f32_32x32x16_bf16 v[32:47], v[72:75], v[68:71], v[32:47]
    v_mfma_f32_32x32x16_bf16 v[48:63], v[76:79], v[68:71], v[48:63]
    ds_read_b128 v[64:67], v106 offset:0
    ds_read_b128 v[68:71], v106 offset:4096
    ds_read_b64_tr_b16 v[72:73], v108 offset:24576
    ds_read_b64_tr_b16 v[74:75], v108 offset:25600
    ds_read_b64_tr_b16 v[76:77], v109 offset:24576
    ds_read_b64_tr_b16 v[78:79], v109 offset:25600
    s_waitcnt lgkmcnt(6)
    v_mfma_f32_32x32x16_bf16 v[0:15], v[88:91], v[80:83], v[0:15]
    v_mfma_f32_32x32x16_bf16 v[16:31], v[92:95], v[80:83], v[16:31]
    v_mfma_f32_32x32x16_bf16 v[32:47], v[88:91], v[84:87], v[32:47]
    v_mfma_f32_32x32x16_bf16 v[48:63], v[92:95], v[84:87], v[48:63]
    ds_read_b128 v[80:83], v107 offset:0
    ds_read_b128 v[84:87], v107 offset:4096
    ds_read_b64_tr_b16 v[88:89], v108 offset:28672
    ds_read_b64_tr_b16 v[90:91], v108 offset:29696
    ds_read_b64_tr_b16 v[92:93], v109 offset:28672
    ds_read_b64_tr_b16 v[94:95], v109 offset:29696
    s_waitcnt lgkmcnt(6)
    v_mfma_f32_32x32x16_bf16 v[0:15], v[72:75], v[64:67], v[0:15]
    v_mfma_f32_32x32x16_bf16 v[16:31], v[76:79], v[64:67], v[16:31]
    v_mfma_f32_32x32x16_bf16 v[32:47], v[72:75], v[68:71], v[32:47]
    v_mfma_f32_32x32x16_bf16 v[48:63], v[76:79], v[68:71], v[48:63]
    s_waitcnt lgkmcnt(0)
    v_mfma_f32_32x32x16_bf16 v[0:15], v[88:91], v[80:83], v[0:15]
    v_mfma_f32_32x32x16_bf16 v[16:31], v[92:95], v[80:83], v[16:31]
    v_mfma_f32_32x32x16_bf16 v[32:47], v[88:91], v[84:87], v[32:47]
    v_mfma_f32_32x32x16_bf16 v[48:63], v[92:95], v[84:87], v[48:63]
    s_waitcnt vmcnt(0)
    s_barrier
    ds_read_b128 v[64:67], v104 offset:32768
    ds_read_b128 v[68:71], v104 offset:36864
    ds_read_b64_tr_b16 v[72:73], v108 offset:49152
    ds_read_b64_tr_b16 v[74:75], v108 offset:50176
    ds_read_b64_tr_b16 v[76:77], v109 offset:49152
    ds_read_b64_tr_b16 v[78:79], v109 offset:50176
    ds_read_b128 v[80:83], v105 offset:32768
    ds_read_b128 v[84:87], v105 offset:36864
    ds_read_b64_tr_b16 v[88:89], v108 offset:53248
    ds_read_b64_tr_b16 v[90:91], v108 offset:54272
    ds_read_b64_tr_b16 v[92:93], v109 offset:53248
    ds_read_b64_tr_b16 v[94:95], v109 offset:54272
    s_waitcnt lgkmcnt(6)
    v_mfma_f32_32x32x16_bf16 v[0:15], v[72:75], v[64:67], v[0:15]
    v_mfma_f32_32x32x16_bf16 v[16:31], v[76:79], v[64:67], v[16:31]
    v_mfma_f32_32x32x16_bf16 v[32:47], v[72:75], v[68:71], v[32:47]
    v_mfma_f32_32x32x16_bf16 v[48:63], v[76:79], v[68:71], v[48:63]
    ds_read_b128 v[64:67], v106 offset:32768
    ds_read_b128 v[68:71], v106 offset:36864
    ds_read_b64_tr_b16 v[72:73], v108 offset:57344
    ds_read_b64_tr_b16 v[74:75], v108 offset:58368
    ds_read_b64_tr_b16 v[76:77], v109 offset:57344
    ds_read_b64_tr_b16 v[78:79], v109 offset:58368
    s_waitcnt lgkmcnt(6)
    v_mfma_f32_32x32x16_bf16 v[0:15], v[88:91], v[80:83], v[0:15]
    v_mfma_f32_32x32x16_bf16 v[16:31], v[92:95], v[80:83], v[16:31]
    v_mfma_f32_32x32x16_bf16 v[32:47], v[88:91], v[84:87], v[32:47]
    v_mfma_f32_32x32x16_bf16 v[48:63], v[92:95], v[84:87], v[48:63]
    ds_read_b128 v[80:83], v107 offset:32768
    ds_read_b128 v[84:87], v107 offset:36864
    ds_read_b64_tr_b16 v[88:89], v108 offset:61440
    ds_read_b64_tr_b16 v[90:91], v108 offset:62464
    ds_read_b64_tr_b16 v[92:93], v109 offset:61440
    ds_read_b64_tr_b16 v[94:95], v109 offset:62464
    s_waitcnt lgkmcnt(6)
    v_mfma_f32_32x32x16_bf16 v[0:15], v[72:75], v[64:67], v[0:15]
    v_mfma_f32_32x32x16_bf16 v[16:31], v[76:79], v[64:67], v[16:31]
    v_mfma_f32_32x32x16_bf16 v[32:47], v[72:75], v[68:71], v[32:47]
    v_mfma_f32_32x32x16_bf16 v[48:63], v[76:79], v[68:71], v[48:63]
    s_waitcnt lgkmcnt(0)
    v_mfma_f32_32x32x16_bf16 v[0:15], v[88:91], v[80:83], v[0:15]
    v_mfma_f32_32x32x16_bf16 v[16:31], v[92:95], v[80:83], v[16:31]
    v_mfma_f32_32x32x16_bf16 v[32:47], v[88:91], v[84:87], v[32:47]
    v_mfma_f32_32x32x16_bf16 v[48:63], v[92:95], v[84:87], v[48:63]
    s_nop 15
    s_nop 3
    s_barrier
    v_and_b32 v110, 31, v118
    s_mul_i32 s32, s34, 64
    v_add_u32 v110, s32, v110
    v_mul_u32_u24 v110, 272, v110
    v_lshrrev_b32 v111, 5, v118
    v_lshl_add_u32 v110, v111, 3, v110
    s_lshl_b32 s32, s35, 7
    v_add_u32 v110, s32, v110
    v_cvt_pk_bf16_f32 v0, v0, v1
    v_cvt_pk_bf16_f32 v1, v2, v3
    ds_write_b64 v110, v[0:1] offset:0
    v_cvt_pk_bf16_f32 v4, v4, v5
    v_cvt_pk_bf16_f32 v5, v6, v7
    ds_write_b64 v110, v[4:5] offset:16
    v_cvt_pk_bf16_f32 v8, v8, v9
    v_cvt_pk_bf16_f32 v9, v10, v11
    ds_write_b64 v110, v[8:9] offset:32
    v_cvt_pk_bf16_f32 v12, v12, v13
    v_cvt_pk_bf16_f32 v13, v14, v15
    ds_write_b64 v110, v[12:13] offset:48
    v_cvt_pk_bf16_f32 v16, v16, v17
    v_cvt_pk_bf16_f32 v17, v18, v19
    ds_write_b64 v110, v[16:17] offset:64
    v_cvt_pk_bf16_f32 v20, v20, v21
    v_cvt_pk_bf16_f32 v21, v22, v23
    ds_write_b64 v110, v[20:21] offset:80
    v_cvt_pk_bf16_f32 v24, v24, v25
    v_cvt_pk_bf16_f32 v25, v26, v27
    ds_write_b64 v110, v[24:25] offset:96
    v_cvt_pk_bf16_f32 v28, v28, v29
    v_cvt_pk_bf16_f32 v29, v30, v31
    ds_write_b64 v110, v[28:29] offset:112
    v_cvt_pk_bf16_f32 v32, v32, v33
    v_cvt_pk_bf16_f32 v33, v34, v35
    ds_write_b64 v110, v[32:33] offset:8704
    v_cvt_pk_bf16_f32 v36, v36, v37
    v_cvt_pk_bf16_f32 v37, v38, v39
    ds_write_b64 v110, v[36:37] offset:8720
    v_cvt_pk_bf16_f32 v40, v40, v41
    v_cvt_pk_bf16_f32 v41, v42, v43
    ds_write_b64 v110, v[40:41] offset:8736
    v_cvt_pk_bf16_f32 v44, v44, v45
    v_cvt_pk_bf16_f32 v45, v46, v47
    ds_write_b64 v110, v[44:45] offset:8752
    v_cvt_pk_bf16_f32 v48, v48, v49
    v_cvt_pk_bf16_f32 v49, v50, v51
    ds_write_b64 v110, v[48:49] offset:8768
    v_cvt_pk_bf16_f32 v52, v52, v53
    v_cvt_pk_bf16_f32 v53, v54, v55
    ds_write_b64 v110, v[52:53] offset:8784
    v_cvt_pk_bf16_f32 v56, v56, v57
    v_cvt_pk_bf16_f32 v57, v58, v59
    ds_write_b64 v110, v[56:57] offset:8800
    v_cvt_pk_bf16_f32 v60, v60, v61
    v_cvt_pk_bf16_f32 v61, v62, v63
    ds_write_b64 v110, v[60:61] offset:8816
    s_waitcnt lgkmcnt(0)
    s_barrier
    s_lshl_b32 s32, s28, 6
    v_add_u32 v116, s32, v118
    v_lshrrev_b32 v110, 4, v116
    v_and_b32 v111, 15, v116
    v_mul_u32_u24 v112, 272, v110
    v_lshl_add_u32 v112, v111, 4, v112
    s_mov_b32 s33, 8192
    v_mul_lo_u32 v113, v110, s33
    v_lshl_add_u32 v113, v111, 4, v113
    ds_read_b128 v[0:3], v112 offset:0
    ds_read_b128 v[4:7], v112 offset:4352
    ds_read_b128 v[8:11], v112 offset:8704
    ds_read_b128 v[12:15], v112 offset:13056
    ds_read_b128 v[16:19], v112 offset:17408
    ds_read_b128 v[20:23], v112 offset:21760
    ds_read_b128 v[24:27], v112 offset:26112
    ds_read_b128 v[28:31], v112 offset:30464
    s_waitcnt vmcnt(0) lgkmcnt(0)
    s_mov_b32 s32, 0
    buffer_store_dwordx4 v[0:3], v113, s[16:19], s32 offen
    s_mov_b32 s32, 131072
    buffer_store_dwordx4 v[4:7], v113, s[16:19], s32 offen
    s_mov_b32 s32, 262144
    buffer_store_dwordx4 v[8:11], v113, s[16:19], s32 offen
    s_mov_b32 s32, 393216
    buffer_store_dwordx4 v[12:15], v113, s[16:19], s32 offen
    s_mov_b32 s32, 524288
    buffer_store_dwordx4 v[16:19], v113, s[16:19], s32 offen
    s_mov_b32 s32, 655360
    buffer_store_dwordx4 v[20:23], v113, s[16:19], s32 offen
    s_mov_b32 s32, 786432
    buffer_store_dwordx4 v[24:27], v113, s[16:19], s32 offen
    s_mov_b32 s32, 917504
    buffer_store_dwordx4 v[28:31], v113, s[16:19], s32 offen
qkv_kernel_done:
    s_endpgm
.section .rodata,"a"
.p2align 6
.amdhsa_kernel qkv_kernel
  .amdhsa_next_free_vgpr 143
  .amdhsa_next_free_sgpr 48
  .amdhsa_accum_offset 144
  .amdhsa_group_segment_fixed_size 0
  .amdhsa_kernarg_size 112
  .amdhsa_user_sgpr_count 2
  .amdhsa_user_sgpr_kernarg_segment_ptr 1
  .amdhsa_system_sgpr_workgroup_id_x 1
.end_amdhsa_kernel
.text
.globl attn_kernel
.p2align 8
.type attn_kernel,@function
attn_kernel:
    s_cmp_ge_u32 s2, 256
    s_cbranch_scc1 attn_kernel_done
    s_load_dwordx2 s[4:5], s[0:1], 104
    v_and_b32 v216, 63, v0
    v_lshrrev_b32 v198, 6, v0
    s_nop 0
    v_readfirstlane_b32 s28, v198
    s_and_b32 s29, s28, 3
    s_lshr_b32 s30, s28, 2
    s_and_b32 s31, s2, 7
    s_lshl_b32 s31, s31, 2
    s_lshr_b32 s32, s2, 6
    s_add_u32 s31, s31, s32
    s_bfe_u32 s32, s2, 0x30003
    s_waitcnt lgkmcnt(0)
    s_lshl_b32 s33, s31, 8
    s_add_u32 s34, s33, 0x1000000
    s_sub_u32 s35, 0x2000000, s34
    s_add_u32 s8, s4, s34
    s_addc_u32 s9, s5, 0
    s_and_b32 s9, s9, 0xffff
    s_mov_b32 s10, s35
    s_mov_b32 s11, 0x00020000
    s_add_u32 s34, s33, 0x2000000
    s_sub_u32 s35, 0x3000000, s34
    s_add_u32 s12, s4, s34
    s_addc_u32 s13, s5, 0
    s_and_b32 s13, s13, 0xffff
    s_mov_b32 s14, s35
    s_mov_b32 s15, 0x00020000
    s_add_u32 s34, s33, 0x3000000
    s_sub_u32 s35, 0x4000000, s34
    s_add_u32 s16, s4, s34
    s_addc_u32 s17, s5, 0
    s_and_b32 s17, s17, 0xffff
    s_mov_b32 s18, s35
    s_mov_b32 s19, 0x00020000
    s_add_u32 s34, s33, 0x4000000
    s_sub_u32 s35, 0x5000000, s34
    s_add_u32 s20, s4, s34
    s_addc_u32 s21, s5, 0
    s_and_b32 s21, s21, 0xffff
    s_mov_b32 s22, s35
    s_mov_b32 s23, 0x00020000
    v_lshrrev_b32 v198, 4, v216
    v_and_b32 v199, 15, v216
    s_lshl_b32 s34, s29, 4
    s_add_u32 s34, s34, 0
    v_add_u32 v200, s34, v198
    v_and_b32 v201, 15, v200
    v_xor_b32 v201, v201, v199
    v_lshlrev_b32 v201, 4, v201
    v_lshl_add_u32 v188, v200, 13, v201
    v_lshlrev_b32 v201, 2, v198
    v_xor_b32 v201, v201, v199
    v_lshlrev_b32 v201, 4, v201
    v_lshl_add_u32 v192, v200, 13, v201
    s_lshl_b32 s34, s29, 4
    s_add_u32 s34, s34, 4
    v_add_u32 v200, s34, v198
    v_and_b32 v201, 15, v200
    v_xor_b32 v201, v201, v199
    v_lshlrev_b32 v201, 4, v201
    v_lshl_add_u32 v189, v200, 13, v201
    v_lshlrev_b32 v201, 2, v198
    v_xor_b32 v201, v201, v199
    v_lshlrev_b32 v201, 4, v201
    v_lshl_add_u32 v193, v200, 13, v201
    s_lshl_b32 s34, s29, 4
    s_add_u32 s34, s34, 8
    v_add_u32 v200, s34, v198
    v_and_b32 v201, 15, v200
    v_xor_b32 v201, v201, v199
    v_lshlrev_b32 v201, 4, v201
    v_lshl_add_u32 v190, v200, 13, v201
    v_lshlrev_b32 v201, 2, v198
    v_xor_b32 v201, v201, v199
    v_lshlrev_b32 v201, 4, v201
    v_lshl_add_u32 v194, v200, 13, v201
    s_lshl_b32 s34, s29, 4
    s_add_u32 s34, s34, 12
    v_add_u32 v200, s34, v198
    v_and_b32 v201, 15, v200
    v_xor_b32 v201, v201, v199
    v_lshlrev_b32 v201, 4, v201
    v_lshl_add_u32 v191, v200, 13, v201
    v_lshlrev_b32 v201, 2, v198
    v_xor_b32 v201, v201, v199
    v_lshlrev_b32 v201, 4, v201
    v_lshl_add_u32 v195, v200, 13, v201
    v_and_b32 v198, 31, v216
    v_lshrrev_b32 v199, 5, v216
    v_and_b32 v200, 15, v198
    v_xor_b32 v200, v200, v199
    v_lshlrev_b32 v200, 4, v200
    v_lshl_add_u32 v176, v198, 8, v200
    s_lshl_b32 s34, s30, 16
    v_add_u32 v176, s34, v176
    v_xor_b32 v177, 32, v176
    v_xor_b32 v178, 64, v176
    v_xor_b32 v179, 96, v176
    v_xor_b32 v180, 128, v176
    v_xor_b32 v181, 160, v176
    v_xor_b32 v182, 192, v176
    v_xor_b32 v183, 224, v176
    v_lshrrev_b32 v198, 5, v216
    v_lshlrev_b32 v198, 2, v198
    v_bfe_u32 v199, v216, 2, 2
    v_add_u32 v198, v198, v199
    v_lshlrev_b32 v198, 8, v198
    v_lshl_add_u32 v198, v199, 6, v198
    v_bfe_u32 v200, v216, 4, 1
    v_lshl_add_u32 v198, v200, 5, v198
    v_and_b32 v200, 3, v216
    v_lshl_add_u32 v198, v200, 3, v198
    s_add_u32 s34, s34, 16384
    v_add_u32 v184, s34, v198
    v_xor_b32 v185, 64, v184
    v_xor_b32 v186, 128, v184
    v_xor_b32 v187, 192, v184
    s_lshl_b32 s37, s30, 16
    s_lshl_b32 s34, s29, 12
    s_add_u32 s37, s37, s34
    s_mov_b32 s40, 0
    s_mov_b32 s44, 0x3e0293ee
    s_sub_u32 s33, 15, s32
attn_kernel_block:
    s_lshl_b32 s34, s33, 7
    s_lshl_b32 s35, s29, 5
    s_add_u32 s34, s34, s35
    v_and_b32 v198, 31, v216
    v_add_u32 v198, s34, v198
    v_lshlrev_b32 v217, 13, v198
    v_lshrrev_b32 v199, 5, v216
    v_lshl_add_u32 v217, v199, 4, v217
    v_lshlrev_b32 v199, 2, v199
    v_sub_u32 v218, v198, v199
    buffer_load_dwordx4 v[96:99], v217, s[8:11], 0 offen offset:0
    buffer_load_dwordx4 v[100:103], v217, s[8:11], 0 offen offset:32
    buffer_load_dwordx4 v[104:107], v217, s[8:11], 0 offen offset:64
    buffer_load_dwordx4 v[108:111], v217, s[8:11], 0 offen offset:96
    buffer_load_dwordx4 v[112:115], v217, s[8:11], 0 offen offset:128
    buffer_load_dwordx4 v[116:119], v217, s[8:11], 0 offen offset:160
    buffer_load_dwordx4 v[120:123], v217, s[8:11], 0 offen offset:192
    buffer_load_dwordx4 v[124:127], v217, s[8:11], 0 offen offset:224
    s_lshl_b32 s36, s30, 19
    s_add_u32 m0, s37, 0
    s_nop 0
    buffer_load_dwordx4 v188, s[12:15], s36 offen lds
    s_add_u32 m0, s37, 1024
    s_nop 0
    buffer_load_dwordx4 v189, s[12:15], s36 offen lds
    s_add_u32 m0, s37, 2048
    s_nop 0
    buffer_load_dwordx4 v190, s[12:15], s36 offen lds
    s_add_u32 m0, s37, 3072
    s_nop 0
    buffer_load_dwordx4 v191, s[12:15], s36 offen lds
    s_add_u32 s36, s36, 0x100000
    s_xor_b32 s37, s37, 0x8000
    v_mov_b32 v0, 0
    v_mov_b32 v1, 0
    v_mov_b32 v2, 0
    v_mov_b32 v3, 0
    v_mov_b32 v4, 0
    v_mov_b32 v5, 0
    v_mov_b32 v6, 0
    v_mov_b32 v7, 0
    v_mov_b32 v8, 0
    v_mov_b32 v9, 0
    v_mov_b32 v10, 0
    v_mov_b32 v11, 0
    v_mov_b32 v12, 0
    v_mov_b32 v13, 0
    v_mov_b32 v14, 0
    v_mov_b32 v15, 0
    v_mov_b32 v16, 0
    v_mov_b32 v17, 0
    v_mov_b32 v18, 0
    v_mov_b32 v19, 0
    v_mov_b32 v20, 0
    v_mov_b32 v21, 0
    v_mov_b32 v22, 0
    v_mov_b32 v23, 0
    v_mov_b32 v24, 0
    v_mov_b32 v25, 0
    v_mov_b32 v26, 0
    v_mov_b32 v27, 0
    v_mov_b32 v28, 0
    v_mov_b32 v29, 0
    v_mov_b32 v30, 0
    v_mov_b32 v31, 0
    v_mov_b32 v32, 0
    v_mov_b32 v33, 0
    v_mov_b32 v34, 0
    v_mov_b32 v35, 0
    v_mov_b32 v36, 0
    v_mov_b32 v37, 0
    v_mov_b32 v38, 0
    v_mov_b32 v39, 0
    v_mov_b32 v40, 0
    v_mov_b32 v41, 0
    v_mov_b32 v42, 0
    v_mov_b32 v43, 0
    v_mov_b32 v44, 0
    v_mov_b32 v45, 0
    v_mov_b32 v46, 0
    v_mov_b32 v47, 0
    v_mov_b32 v48, 0
    v_mov_b32 v49, 0
    v_mov_b32 v50, 0
    v_mov_b32 v51, 0
    v_mov_b32 v52, 0
    v_mov_b32 v53, 0
    v_mov_b32 v54, 0
    v_mov_b32 v55, 0
    v_mov_b32 v56, 0
    v_mov_b32 v57, 0
    v_mov_b32 v58, 0
    v_mov_b32 v59, 0
    v_mov_b32 v60, 0
    v_mov_b32 v61, 0
    v_mov_b32 v62, 0
    v_mov_b32 v63, 0
    v_mov_b32 v196, 0xf149f2ca
    v_mov_b32 v197, 0
    s_mov_b32 s35, s33
    s_mov_b32 s45, 0
    s_cmp_eq_u32 s30, 0
    s_cbranch_scc1 attn_kernel_nostag
    s_barrier
attn_kernel_nostag:
    s_cmp_eq_u32 s35, 0
    s_cbranch_scc1 attn_kernel_lastu
attn_kernel_loop:
    s_waitcnt vmcnt(0)
    s_barrier
    ds_read_b128 v[144:147], v176 offset:0
    ds_read_b128 v[148:151], v177 offset:0
    ds_read_b128 v[152:155], v178 offset:0
    ds_read_b128 v[156:159], v179 offset:0
    s_waitcnt lgkmcnt(3)
    v_mfma_f32_32x32x16_bf16 v[64:79], v[144:147], v[96:99], 0
    ds_read_b128 v[144:147], v180 offset:0
    s_xor_b32 s46, s37, 0x8000
    s_sub_u32 s47, s36, 0x100000
    s_waitcnt lgkmcnt(3)
    v_mfma_f32_32x32x16_bf16 v[64:79], v[148:151], v[100:103], v[64:79]
    ds_read_b128 v[148:151], v181 offset:0
    s_add_u32 m0, s37, 0
    s_nop 0
    buffer_load_dwordx4 v188, s[12:15], s36 offen lds
    s_waitcnt lgkmcnt(3)
    v_mfma_f32_32x32x16_bf16 v[64:79], v[152:155], v[104:107], v[64:79]
    ds_read_b128 v[152:155], v182 offset:0
    s_waitcnt lgkmcnt(3)
    v_mfma_f32_32x32x16_bf16 v[64:79], v[156:159], v[108:111], v[64:79]
    ds_read_b128 v[156:159], v183 offset:0
    s_add_u32 m0, s37, 1024
    s_nop 0
    buffer_load_dwordx4 v189, s[12:15], s36 offen lds
    s_waitcnt lgkmcnt(3)
    v_mfma_f32_32x32x16_bf16 v[64:79], v[144:147], v[112:115], v[64:79]
    ds_read_b128 v[144:147], v176 offset:8192
    s_waitcnt lgkmcnt(3)
    v_mfma_f32_32x32x16_bf16 v[64:79], v[148:151], v[116:119], v[64:79]
    ds_read_b128 v[148:151], v177 offset:8192
    s_add_u32 m0, s37, 2048
    s_nop 0
    buffer_load_dwordx4 v190, s[12:15], s36 offen lds
    s_waitcnt lgkmcnt(3)
    v_mfma_f32_32x32x16_bf16 v[64:79], v[152:155], v[120:123], v[64:79]
    ds_read_b128 v[152:155], v178 offset:8192
    s_waitcnt lgkmcnt(3)
    v_mfma_f32_32x32x16_bf16 v[64:79], v[156:159], v[124:127], v[64:79]
    ds_read_b128 v[156:159], v179 offset:8192
    s_add_u32 m0, s37, 3072
    s_nop 0
    buffer_load_dwordx4 v191, s[12:15], s36 offen lds
    s_waitcnt lgkmcnt(3)
    v_mfma_f32_32x32x16_bf16 v[80:95], v[144:147], v[96:99], 0
    ds_read_b128 v[144:147], v180 offset:8192
    s_waitcnt lgkmcnt(3)
    v_mfma_f32_32x32x16_bf16 v[80:95], v[148:151], v[100:103], v[80:95]
    ds_read_b128 v[148:151], v181 offset:8192
    s_add_u32 m0, s46, 16384
    s_nop 0
    buffer_load_dwordx4 v192, s[16:19], s47 offen lds
    s_waitcnt lgkmcnt(3)
    v_mfma_f32_32x32x16_bf16 v[80:95], v[152:155], v[104:107], v[80:95]
    ds_read_b128 v[152:155], v182 offset:8192
    s_waitcnt lgkmcnt(3)
    v_mfma_f32_32x32x16_bf16 v[80:95], v[156:159], v[108:111], v[80:95]
    ds_read_b128 v[156:159], v183 offset:8192
    s_add_u32 m0, s46, 17408
    s_nop 0
    buffer_load_dwordx4 v193, s[16:19], s47 offen lds
    s_waitcnt lgkmcnt(3)
    v_mfma_f32_32x32x16_bf16 v[80:95], v[144:147], v[112:115], v[80:95]
    s_waitcnt lgkmcnt(2)
    v_mfma_f32_32x32x16_bf16 v[80:95], v[148:151], v[116:119], v[80:95]
    s_add_u32 m0, s46, 18432
    s_nop 0
    buffer_load_dwordx4 v194, s[16:19], s47 offen lds
    s_waitcnt lgkmcnt(1)
    v_mfma_f32_32x32x16_bf16 v[80:95], v[152:155], v[120:123], v[80:95]
    s_waitcnt lgkmcnt(0)
    v_mfma_f32_32x32x16_bf16 v[80:95], v[156:159], v[124:127], v[80:95]
    s_add_u32 m0, s46, 19456
    s_nop 0
    buffer_load_dwordx4 v195, s[16:19], s47 offen lds
    s_add_u32 s36, s36, 0x100000
    s_xor_b32 s37, s37, 0x8000
    v_xor_b32 v176, 0x8000, v176
    v_xor_b32 v177, 0x8000, v177
    v_xor_b32 v178, 0x8000, v178
    v_xor_b32 v179, 0x8000, v179
    v_xor_b32 v180, 0x8000, v180
    v_xor_b32 v181, 0x8000, v181
    v_xor_b32 v182, 0x8000, v182
    v_xor_b32 v183, 0x8000, v183
    s_cmp_eq_u32 s45, 0
    s_cbranch_scc1 attn_kernel_b1_nopv
    ds_read_b64_tr_b16 v[160:161], v184 offset:0
    ds_read_b64_tr_b16 v[162:163], v184 offset:2048
    ds_read_b64_tr_b16 v[164:165], v185 offset:0
    ds_read_b64_tr_b16 v[166:167], v185 offset:2048
    ds_read_b64_tr_b16 v[168:169], v186 offset:0
    ds_read_b64_tr_b16 v[170:171], v186 offset:2048
    ds_read_b64_tr_b16 v[172:173], v187 offset:0
    ds_read_b64_tr_b16 v[174:175], v187 offset:2048
    s_waitcnt lgkmcnt(6)
    v_mfma_f32_32x32x16_bf16 v[0:15], v[160:163], v[128:131], v[0:15]
    ds_read_b64_tr_b16 v[160:161], v184 offset:4096
    ds_read_b64_tr_b16 v[162:163], v184 offset:6144
    s_waitcnt lgkmcnt(6)
    v_mfma_f32_32x32x16_bf16 v[16:31], v[164:167], v[128:131], v[16:31]
    ds_read_b64_tr_b16 v[164:165], v185 offset:4096
    ds_read_b64_tr_b16 v[166:167], v185 offset:6144
    s_waitcnt lgkmcnt(6)
    v_mfma_f32_32x32x16_bf16 v[32:47], v[168:171], v[128:131], v[32:47]
    ds_read_b64_tr_b16 v[168:169], v186 offset:4096
    ds_read_b64_tr_b16 v[170:171], v186 offset:6144
    s_waitcnt lgkmcnt(6)
    v_mfma_f32_32x32x16_bf16 v[48:63], v[172:175], v[128:131], v[48:63]
    ds_read_b64_tr_b16 v[172:173], v187 offset:4096
    ds_read_b64_tr_b16 v[174:175], v187 offset:6144
    s_waitcnt lgkmcnt(6)
    v_mfma_f32_32x32x16_bf16 v[0:15], v[160:163], v[132:135], v[0:15]
    ds_read_b64_tr_b16 v[160:161], v184 offset:8192
    ds_read_b64_tr_b16 v[162:163], v184 offset:10240
    s_waitcnt lgkmcnt(6)
    v_mfma_f32_32x32x16_bf16 v[16:31], v[164:167], v[132:135], v[16:31]
    ds_read_b64_tr_b16 v[164:165], v185 offset:8192
    ds_read_b64_tr_b16 v[166:167], v185 offset:10240
    s_waitcnt lgkmcnt(6)
    v_mfma_f32_32x32x16_bf16 v[32:47], v[168:171], v[132:135], v[32:47]
    ds_read_b64_tr_b16 v[168:169], v186 offset:8192
    ds_read_b64_tr_b16 v[170:171], v186 offset:10240
    s_waitcnt lgkmcnt(6)
    v_mfma_f32_32x32x16_bf16 v[48:63], v[172:175], v[132:135], v[48:63]
    ds_read_b64_tr_b16 v[172:173], v187 offset:8192
    ds_read_b64_tr_b16 v[174:175], v187 offset:10240
    s_waitcnt lgkmcnt(6)
    v_mfma_f32_32x32x16_bf16 v[0:15], v[160:163], v[136:139], v[0:15]
    ds_read_b64_tr_b16 v[160:161], v184 offset:12288
    ds_read_b64_tr_b16 v[162:163], v184 offset:14336
    s_waitcnt lgkmcnt(6)
    v_mfma_f32_32x32x16_bf16 v[16:31], v[164:167], v[136:139], v[16:31]
    ds_read_b64_tr_b16 v[164:165], v185 offset:12288
    ds_read_b64_tr_b16 v[166:167], v185 offset:14336
    s_waitcnt lgkmcnt(6)
    v_mfma_f32_32x32x16_bf16 v[32:47], v[168:171], v[136:139], v[32:47]
    ds_read_b64_tr_b16 v[168:169], v186 offset:12288
    ds_read_b64_tr_b16 v[170:171], v186 offset:14336
    s_waitcnt lgkmcnt(6)
    v_mfma_f32_32x32x16_bf16 v[48:63], v[172:175], v[136:139], v[48:63]
    ds_read_b64_tr_b16 v[172:173], v187 offset:12288
    ds_read_b64_tr_b16 v[174:175], v187 offset:14336
    s_waitcnt lgkmcnt(6)
    v_mfma_f32_32x32x16_bf16 v[0:15], v[160:163], v[140:143], v[0:15]
    s_waitcnt lgkmcnt(4)
    v_mfma_f32_32x32x16_bf16 v[16:31], v[164:167], v[140:143], v[16:31]
    s_waitcnt lgkmcnt(2)
    v_mfma_f32_32x32x16_bf16 v[32:47], v[168:171], v[140:143], v[32:47]
    s_waitcnt lgkmcnt(0)
    v_mfma_f32_32x32x16_bf16 v[48:63], v[172:175], v[140:143], v[48:63]
    v_xor_b32 v184, 0x8000, v184
    v_xor_b32 v185, 0x8000, v185
    v_xor_b32 v186, 0x8000, v186
    v_xor_b32 v187, 0x8000, v187
attn_kernel_b1_nopv:
    s_mov_b32 s45, 1
    s_barrier
    v_max3_f32 v198, v64, v65, v66
    v_max3_f32 v198, v198, v67, v68
    v_max3_f32 v198, v198, v69, v70
    v_max3_f32 v198, v198, v71, v72
    v_max3_f32 v198, v198, v73, v74
    v_max3_f32 v198, v198, v75, v76
    v_max3_f32 v198, v198, v77, v78
    v_max3_f32 v198, v198, v79, v80
    v_max3_f32 v198, v198, v81, v82
    v_max3_f32 v198, v198, v83, v84
    v_max3_f32 v198, v198, v85, v86
    v_max3_f32 v198, v198, v87, v88
    v_max3_f32 v198, v198, v89, v90
    v_max3_f32 v198, v198, v91, v92
    v_max3_f32 v198, v198, v93, v94
    v_max_f32 v198, v198, v95
    v_mov_b32 v199, v198
    s_nop 1
    v_permlane32_swap_b32 v198, v199
    v_max_f32 v198, v198, v199
    v_mul_f32 v198, s44, v198
    v_max_f32 v198, v198, v196
    v_sub_f32 v199, v196, v198
    v_exp_f32 v199, v199
    v_mov_b32 v196, v198
    v_mov_b32 v202, v198
    v_mov_b32 v203, v198
    v_mov_b32 v204, s44
    v_mov_b32 v205, s44
    v_pk_fma_f32 v[64:65], v[64:65], v[204:205], v[202:203] neg_lo:[0,0,1] neg_hi:[0,0,1]
    v_pk_fma_f32 v[66:67], v[66:67], v[204:205], v[202:203] neg_lo:[0,0,1] neg_hi:[0,0,1]
    v_pk_fma_f32 v[68:69], v[68:69], v[204:205], v[202:203] neg_lo:[0,0,1] neg_hi:[0,0,1]
    v_pk_fma_f32 v[70:71], v[70:71], v[204:205], v[202:203] neg_lo:[0,0,1] neg_hi:[0,0,1]
    v_pk_fma_f32 v[72:73], v[72:73], v[204:205], v[202:203] neg_lo:[0,0,1] neg_hi:[0,0,1]
    v_pk_fma_f32 v[74:75], v[74:75], v[204:205], v[202:203] neg_lo:[0,0,1] neg_hi:[0,0,1]
    v_pk_fma_f32 v[76:77], v[76:77], v[204:205], v[202:203] neg_lo:[0,0,1] neg_hi:[0,0,1]
    v_pk_fma_f32 v[78:79], v[78:79], v[204:205], v[202:203] neg_lo:[0,0,1] neg_hi:[0,0,1]
    v_pk_fma_f32 v[80:81], v[80:81], v[204:205], v[202:203] neg_lo:[0,0,1] neg_hi:[0,0,1]
    v_pk_fma_f32 v[82:83], v[82:83], v[204:205], v[202:203] neg_lo:[0,0,1] neg_hi:[0,0,1]
    v_pk_fma_f32 v[84:85], v[84:85], v[204:205], v[202:203] neg_lo:[0,0,1] neg_hi:[0,0,1]
    v_pk_fma_f32 v[86:87], v[86:87], v[204:205], v[202:203] neg_lo:[0,0,1] neg_hi:[0,0,1]
    v_pk_fma_f32 v[88:89], v[88:89], v[204:205], v[202:203] neg_lo:[0,0,1] neg_hi:[0,0,1]
    v_pk_fma_f32 v[90:91], v[90:91], v[204:205], v[202:203] neg_lo:[0,0,1] neg_hi:[0,0,1]
    v_pk_fma_f32 v[92:93], v[92:93], v[204:205], v[202:203] neg_lo:[0,0,1] neg_hi:[0,0,1]
    v_pk_fma_f32 v[94:95], v[94:95], v[204:205], v[202:203] neg_lo:[0,0,1] neg_hi:[0,0,1]
    v_mov_b32 v206, v199
    v_mov_b32 v207, v199
    v_exp_f32 v64, v64
    v_exp_f32 v65, v65
    v_pk_mul_f32 v[0:1], v[0:1], v[206:207]
    v_pk_mul_f32 v[32:33], v[32:33], v[206:207]
    v_exp_f32 v66, v66
    v_exp_f32 v67, v67
    v_pk_mul_f32 v[2:3], v[2:3], v[206:207]
    v_pk_mul_f32 v[34:35], v[34:35], v[206:207]
    v_exp_f32 v68, v68
    v_exp_f32 v69, v69
    v_pk_mul_f32 v[4:5], v[4:5], v[206:207]
    v_pk_mul_f32 v[36:37], v[36:37], v[206:207]
    v_exp_f32 v70, v70
    v_exp_f32 v71, v71
    v_pk_mul_f32 v[6:7], v[6:7], v[206:207]
    v_pk_mul_f32 v[38:39], v[38:39], v[206:207]
    v_exp_f32 v72, v72
    v_exp_f32 v73, v73
    v_pk_mul_f32 v[8:9], v[8:9], v[206:207]
    v_pk_mul_f32 v[40:41], v[40:41], v[206:207]
    v_exp_f32 v74, v74
    v_exp_f32 v75, v75
    v_pk_mul_f32 v[10:11], v[10:11], v[206:207]
    v_pk_mul_f32 v[42:43], v[42:43], v[206:207]
    v_exp_f32 v76, v76
    v_exp_f32 v77, v77
    v_pk_mul_f32 v[12:13], v[12:13], v[206:207]
    v_pk_mul_f32 v[44:45], v[44:45], v[206:207]
    v_exp_f32 v78, v78
    v_exp_f32 v79, v79
    v_pk_mul_f32 v[14:15], v[14:15], v[206:207]
    v_pk_mul_f32 v[46:47], v[46:47], v[206:207]
    v_exp_f32 v80, v80
    v_exp_f32 v81, v81
    v_pk_mul_f32 v[16:17], v[16:17], v[206:207]
    v_pk_mul_f32 v[48:49], v[48:49], v[206:207]
    v_exp_f32 v82, v82
    v_exp_f32 v83, v83
    v_pk_mul_f32 v[18:19], v[18:19], v[206:207]
    v_pk_mul_f32 v[50:51], v[50:51], v[206:207]
    v_exp_f32 v84, v84
    v_exp_f32 v85, v85
    v_pk_mul_f32 v[20:21], v[20:21], v[206:207]
    v_pk_mul_f32 v[52:53], v[52:53], v[206:207]
    v_exp_f32 v86, v86
    v_exp_f32 v87, v87
    v_pk_mul_f32 v[22:23], v[22:23], v[206:207]
    v_pk_mul_f32 v[54:55], v[54:55], v[206:207]
    v_exp_f32 v88, v88
    v_exp_f32 v89, v89
    v_pk_mul_f32 v[24:25], v[24:25], v[206:207]
    v_pk_mul_f32 v[56:57], v[56:57], v[206:207]
    v_exp_f32 v90, v90
    v_exp_f32 v91, v91
    v_pk_mul_f32 v[26:27], v[26:27], v[206:207]
    v_pk_mul_f32 v[58:59], v[58:59], v[206:207]
    v_exp_f32 v92, v92
    v_exp_f32 v93, v93
    v_pk_mul_f32 v[28:29], v[28:29], v[206:207]
    v_pk_mul_f32 v[60:61], v[60:61], v[206:207]
    v_exp_f32 v94, v94
    v_exp_f32 v95, v95
    v_pk_mul_f32 v[30:31], v[30:31], v[206:207]
    v_pk_mul_f32 v[62:63], v[62:63], v[206:207]
    v_pk_add_f32 v[200:201], v[64:65], v[66:67]
    v_pk_add_f32 v[200:201], v[200:201], v[68:69]
    v_pk_add_f32 v[200:201], v[200:201], v[70:71]
    v_pk_add_f32 v[200:201], v[200:201], v[72:73]
    v_pk_add_f32 v[200:201], v[200:201], v[74:75]
    v_pk_add_f32 v[200:201], v[200:201], v[76:77]
    v_pk_add_f32 v[200:201], v[200:201], v[78:79]
    v_pk_add_f32 v[200:201], v[200:201], v[80:81]
    v_pk_add_f32 v[200:201], v[200:201], v[82:83]
    v_pk_add_f32 v[200:201], v[200:201], v[84:85]
    v_pk_add_f32 v[200:201], v[200:201], v[86:87]
    v_pk_add_f32 v[200:201], v[200:201], v[88:89]
    v_pk_add_f32 v[200:201], v[200:201], v[90:91]
    v_pk_add_f32 v[200:201], v[200:201], v[92:93]
    v_pk_add_f32 v[200:201], v[200:201], v[94:95]
    v_add_f32 v200, v200, v201
    v_fma_f32 v197, v197, v199, v200
    v_cvt_pk_bf16_f32 v128, v64, v65
    v_cvt_pk_bf16_f32 v129, v66, v67
    v_cvt_pk_bf16_f32 v130, v68, v69
    v_cvt_pk_bf16_f32 v131, v70, v71
    v_cvt_pk_bf16_f32 v132, v72, v73
    v_cvt_pk_bf16_f32 v133, v74, v75
    v_cvt_pk_bf16_f32 v134, v76, v77
    v_cvt_pk_bf16_f32 v135, v78, v79
    v_cvt_pk_bf16_f32 v136, v80, v81
    v_cvt_pk_bf16_f32 v137, v82, v83
    v_cvt_pk_bf16_f32 v138, v84, v85
    v_cvt_pk_bf16_f32 v139, v86, v87
    v_cvt_pk_bf16_f32 v140, v88, v89
    v_cvt_pk_bf16_f32 v141, v90, v91
    v_cvt_pk_bf16_f32 v142, v92, v93
    v_cvt_pk_bf16_f32 v143, v94, v95
    s_sub_u32 s35, s35, 1
    s_cmp_lg_u32 s35, 0
    s_cbranch_scc1 attn_kernel_loop
attn_kernel_lastu:
    s_waitcnt vmcnt(0)
    s_barrier
    ds_read_b128 v[144:147], v176 offset:0
    ds_read_b128 v[148:151], v177 offset:0
    ds_read_b128 v[152:155], v178 offset:0
    ds_read_b128 v[156:159], v179 offset:0
    s_waitcnt lgkmcnt(3)
    v_mfma_f32_32x32x16_bf16 v[64:79], v[144:147], v[96:99], 0
    ds_read_b128 v[144:147], v180 offset:0
    s_xor_b32 s46, s37, 0x8000
    s_sub_u32 s47, s36, 0x100000
    s_waitcnt lgkmcnt(3)
    v_mfma_f32_32x32x16_bf16 v[64:79], v[148:151], v[100:103], v[64:79]
    ds_read_b128 v[148:151], v181 offset:0
    s_waitcnt lgkmcnt(3)
    v_mfma_f32_32x32x16_bf16 v[64:79], v[152:155], v[104:107], v[64:79]
    ds_read_b128 v[152:155], v182 offset:0
    s_waitcnt lgkmcnt(3)
    v_mfma_f32_32x32x16_bf16 v[64:79], v[156:159], v[108:111], v[64:79]
    ds_read_b128 v[156:159], v183 offset:0
    s_waitcnt lgkmcnt(3)
    v_mfma_f32_32x32x16_bf16 v[64:79], v[144:147], v[112:115], v[64:79]
    ds_read_b128 v[144:147], v176 offset:8192
    s_waitcnt lgkmcnt(3)
    v_mfma_f32_32x32x16_bf16 v[64:79], v[148:151], v[116:119], v[64:79]
    ds_read_b128 v[148:151], v177 offset:8192
    s_waitcnt lgkmcnt(3)
    v_mfma_f32_32x32x16_bf16 v[64:79], v[152:155], v[120:123], v[64:79]
    ds_read_b128 v[152:155], v178 offset:8192
    s_waitcnt lgkmcnt(3)
    v_mfma_f32_32x32x16_bf16 v[64:79], v[156:159], v[124:127], v[64:79]
    ds_read_b128 v[156:159], v179 offset:8192
    s_waitcnt lgkmcnt(3)
    v_mfma_f32_32x32x16_bf16 v[80:95], v[144:147], v[96:99], 0
    ds_read_b128 v[144:147], v180 offset:8192
    s_waitcnt lgkmcnt(3)
    v_mfma_f32_32x32x16_bf16 v[80:95], v[148:151], v[100:103], v[80:95]
    ds_read_b128 v[148:151], v181 offset:8192
    s_add_u32 m0, s46, 16384
    s_nop 0
    buffer_load_dwordx4 v192, s[16:19], s47 offen lds
    s_waitcnt lgkmcnt(3)
    v_mfma_f32_32x32x16_bf16 v[80:95], v[152:155], v[104:107], v[80:95]
    ds_read_b128 v[152:155], v182 offset:8192
    s_waitcnt lgkmcnt(3)
    v_mfma_f32_32x32x16_bf16 v[80:95], v[156:159], v[108:111], v[80:95]
    ds_read_b128 v[156:159], v183 offset:8192
    s_add_u32 m0, s46, 17408
    s_nop 0
    buffer_load_dwordx4 v193, s[16:19], s47 offen lds
    s_waitcnt lgkmcnt(3)
    v_mfma_f32_32x32x16_bf16 v[80:95], v[144:147], v[112:115], v[80:95]
    s_waitcnt lgkmcnt(2)
    v_mfma_f32_32x32x16_bf16 v[80:95], v[148:151], v[116:119], v[80:95]
    s_add_u32 m0, s46, 18432
    s_nop 0
    buffer_load_dwordx4 v194, s[16:19], s47 offen lds
    s_waitcnt lgkmcnt(1)
    v_mfma_f32_32x32x16_bf16 v[80:95], v[152:155], v[120:123], v[80:95]
    s_waitcnt lgkmcnt(0)
    v_mfma_f32_32x32x16_bf16 v[80:95], v[156:159], v[124:127], v[80:95]
    s_add_u32 m0, s46, 19456
    s_nop 0
    buffer_load_dwordx4 v195, s[16:19], s47 offen lds
    v_xor_b32 v176, 0x8000, v176
    v_xor_b32 v177, 0x8000, v177
    v_xor_b32 v178, 0x8000, v178
    v_xor_b32 v179, 0x8000, v179
    v_xor_b32 v180, 0x8000, v180
    v_xor_b32 v181, 0x8000, v181
    v_xor_b32 v182, 0x8000, v182
    v_xor_b32 v183, 0x8000, v183
    s_cmp_eq_u32 s45, 0
    s_cbranch_scc1 attn_kernel_b2_nopv
    ds_read_b64_tr_b16 v[160:161], v184 offset:0
    ds_read_b64_tr_b16 v[162:163], v184 offset:2048
    ds_read_b64_tr_b16 v[164:165], v185 offset:0
    ds_read_b64_tr_b16 v[166:167], v185 offset:2048
    ds_read_b64_tr_b16 v[168:169], v186 offset:0
    ds_read_b64_tr_b16 v[170:171], v186 offset:2048
    ds_read_b64_tr_b16 v[172:173], v187 offset:0
    ds_read_b64_tr_b16 v[174:175], v187 offset:2048
    s_waitcnt lgkmcnt(6)
    v_mfma_f32_32x32x16_bf16 v[0:15], v[160:163], v[128:131], v[0:15]
    ds_read_b64_tr_b16 v[160:161], v184 offset:4096
    ds_read_b64_tr_b16 v[162:163], v184 offset:6144
    s_waitcnt lgkmcnt(6)
    v_mfma_f32_32x32x16_bf16 v[16:31], v[164:167], v[128:131], v[16:31]
    ds_read_b64_tr_b16 v[164:165], v185 offset:4096
    ds_read_b64_tr_b16 v[166:167], v185 offset:6144
    s_waitcnt lgkmcnt(6)
    v_mfma_f32_32x32x16_bf16 v[32:47], v[168:171], v[128:131], v[32:47]
    ds_read_b64_tr_b16 v[168:169], v186 offset:4096
    ds_read_b64_tr_b16 v[170:171], v186 offset:6144
    s_waitcnt lgkmcnt(6)
    v_mfma_f32_32x32x16_bf16 v[48:63], v[172:175], v[128:131], v[48:63]
    ds_read_b64_tr_b16 v[172:173], v187 offset:4096
    ds_read_b64_tr_b16 v[174:175], v187 offset:6144
    s_waitcnt lgkmcnt(6)
    v_mfma_f32_32x32x16_bf16 v[0:15], v[160:163], v[132:135], v[0:15]
    ds_read_b64_tr_b16 v[160:161], v184 offset:8192
    ds_read_b64_tr_b16 v[162:163], v184 offset:10240
    s_waitcnt lgkmcnt(6)
    v_mfma_f32_32x32x16_bf16 v[16:31], v[164:167], v[132:135], v[16:31]
    ds_read_b64_tr_b16 v[164:165], v185 offset:8192
    ds_read_b64_tr_b16 v[166:167], v185 offset:10240
    s_waitcnt lgkmcnt(6)
    v_mfma_f32_32x32x16_bf16 v[32:47], v[168:171], v[132:135], v[32:47]
    ds_read_b64_tr_b16 v[168:169], v186 offset:8192
    ds_read_b64_tr_b16 v[170:171], v186 offset:10240
    s_waitcnt lgkmcnt(6)
    v_mfma_f32_32x32x16_bf16 v[48:63], v[172:175], v[132:135], v[48:63]
    ds_read_b64_tr_b16 v[172:173], v187 offset:8192
    ds_read_b64_tr_b16 v[174:175], v187 offset:10240
    s_waitcnt lgkmcnt(6)
    v_mfma_f32_32x32x16_bf16 v[0:15], v[160:163], v[136:139], v[0:15]
    ds_read_b64_tr_b16 v[160:161], v184 offset:12288
    ds_read_b64_tr_b16 v[162:163], v184 offset:14336
    s_waitcnt lgkmcnt(6)
    v_mfma_f32_32x32x16_bf16 v[16:31], v[164:167], v[136:139], v[16:31]
    ds_read_b64_tr_b16 v[164:165], v185 offset:12288
    ds_read_b64_tr_b16 v[166:167], v185 offset:14336
    s_waitcnt lgkmcnt(6)
    v_mfma_f32_32x32x16_bf16 v[32:47], v[168:171], v[136:139], v[32:47]
    ds_read_b64_tr_b16 v[168:169], v186 offset:12288
    ds_read_b64_tr_b16 v[170:171], v186 offset:14336
    s_waitcnt lgkmcnt(6)
    v_mfma_f32_32x32x16_bf16 v[48:63], v[172:175], v[136:139], v[48:63]
    ds_read_b64_tr_b16 v[172:173], v187 offset:12288
    ds_read_b64_tr_b16 v[174:175], v187 offset:14336
    s_waitcnt lgkmcnt(6)
    v_mfma_f32_32x32x16_bf16 v[0:15], v[160:163], v[140:143], v[0:15]
    s_waitcnt lgkmcnt(4)
    v_mfma_f32_32x32x16_bf16 v[16:31], v[164:167], v[140:143], v[16:31]
    s_waitcnt lgkmcnt(2)
    v_mfma_f32_32x32x16_bf16 v[32:47], v[168:171], v[140:143], v[32:47]
    s_waitcnt lgkmcnt(0)
    v_mfma_f32_32x32x16_bf16 v[48:63], v[172:175], v[140:143], v[48:63]
    v_xor_b32 v184, 0x8000, v184
    v_xor_b32 v185, 0x8000, v185
    v_xor_b32 v186, 0x8000, v186
    v_xor_b32 v187, 0x8000, v187
attn_kernel_b2_nopv:
    s_mov_b32 s45, 1
    s_barrier
    s_lshl_b32 s41, s33, 1
    s_add_u32 s41, s41, s30
    s_lshl_b32 s41, s41, 6
    v_subrev_u32 v198, s41, v218
    v_mov_b32 v199, 0xff800000
    v_cmp_le_i32 vcc, 0, v198
    s_nop 1
    v_cndmask_b32 v64, v199, v64, vcc
    v_cmp_le_i32 vcc, 1, v198
    s_nop 1
    v_cndmask_b32 v65, v199, v65, vcc
    v_cmp_le_i32 vcc, 2, v198
    s_nop 1
    v_cndmask_b32 v66, v199, v66, vcc
    v_cmp_le_i32 vcc, 3, v198
    s_nop 1
    v_cndmask_b32 v67, v199, v67, vcc
    v_cmp_le_i32 vcc, 8, v198
    s_nop 1
    v_cndmask_b32 v68, v199, v68, vcc
    v_cmp_le_i32 vcc, 9, v198
    s_nop 1
    v_cndmask_b32 v69, v199, v69, vcc
    v_cmp_le_i32 vcc, 10, v198
    s_nop 1
    v_cndmask_b32 v70, v199, v70, vcc
    v_cmp_le_i32 vcc, 11, v198
    s_nop 1
    v_cndmask_b32 v71, v199, v71, vcc
    v_cmp_le_i32 vcc, 16, v198
    s_nop 1
    v_cndmask_b32 v72, v199, v72, vcc
    v_cmp_le_i32 vcc, 17, v198
    s_nop 1
    v_cndmask_b32 v73, v199, v73, vcc
    v_cmp_le_i32 vcc, 18, v198
    s_nop 1
    v_cndmask_b32 v74, v199, v74, vcc
    v_cmp_le_i32 vcc, 19, v198
    s_nop 1
    v_cndmask_b32 v75, v199, v75, vcc
    v_cmp_le_i32 vcc, 24, v198
    s_nop 1
    v_cndmask_b32 v76, v199, v76, vcc
    v_cmp_le_i32 vcc, 25, v198
    s_nop 1
    v_cndmask_b32 v77, v199, v77, vcc
    v_cmp_le_i32 vcc, 26, v198
    s_nop 1
    v_cndmask_b32 v78, v199, v78, vcc
    v_cmp_le_i32 vcc, 27, v198
    s_nop 1
    v_cndmask_b32 v79, v199, v79, vcc
    v_cmp_le_i32 vcc, 32, v198
    s_nop 1
    v_cndmask_b32 v80, v199, v80, vcc
    v_cmp_le_i32 vcc, 33, v198
    s_nop 1
    v_cndmask_b32 v81, v199, v81, vcc
    v_cmp_le_i32 vcc, 34, v198
    s_nop 1
    v_cndmask_b32 v82, v199, v82, vcc
    v_cmp_le_i32 vcc, 35, v198
    s_nop 1
    v_cndmask_b32 v83, v199, v83, vcc
    v_cmp_le_i32 vcc, 40, v198
    s_nop 1
    v_cndmask_b32 v84, v199, v84, vcc
    v_cmp_le_i32 vcc, 41, v198
    s_nop 1
    v_cndmask_b32 v85, v199, v85, vcc
    v_cmp_le_i32 vcc, 42, v198
    s_nop 1
    v_cndmask_b32 v86, v199, v86, vcc
    v_cmp_le_i32 vcc, 43, v198
    s_nop 1
    v_cndmask_b32 v87, v199, v87, vcc
    v_cmp_le_i32 vcc, 48, v198
    s_nop 1
    v_cndmask_b32 v88, v199, v88, vcc
    v_cmp_le_i32 vcc, 49, v198
    s_nop 1
    v_cndmask_b32 v89, v199, v89, vcc
    v_cmp_le_i32 vcc, 50, v198
    s_nop 1
    v_cndmask_b32 v90, v199, v90, vcc
    v_cmp_le_i32 vcc, 51, v198
    s_nop 1
    v_cndmask_b32 v91, v199, v91, vcc
    v_cmp_le_i32 vcc, 56, v198
    s_nop 1
    v_cndmask_b32 v92, v199, v92, vcc
    v_cmp_le_i32 vcc, 57, v198
    s_nop 1
    v_cndmask_b32 v93, v199, v93, vcc
    v_cmp_le_i32 vcc, 58, v198
    s_nop 1
    v_cndmask_b32 v94, v199, v94, vcc
    v_cmp_le_i32 vcc, 59, v198
    s_nop 1
    v_cndmask_b32 v95, v199, v95, vcc
    v_max3_f32 v198, v64, v65, v66
    v_max3_f32 v198, v198, v67, v68
    v_max3_f32 v198, v198, v69, v70
    v_max3_f32 v198, v198, v71, v72
    v_max3_f32 v198, v198, v73, v74
    v_max3_f32 v198, v198, v75, v76
    v_max3_f32 v198, v198, v77, v78
    v_max3_f32 v198, v198, v79, v80
    v_max3_f32 v198, v198, v81, v82
    v_max3_f32 v198, v198, v83, v84
    v_max3_f32 v198, v198, v85, v86
    v_max3_f32 v198, v198, v87, v88
    v_max3_f32 v198, v198, v89, v90
    v_max3_f32 v198, v198, v91, v92
    v_max3_f32 v198, v198, v93, v94
    v_max_f32 v198, v198, v95
    v_mov_b32 v199, v198
    s_nop 1
    v_permlane32_swap_b32 v198, v199
    v_max_f32 v198, v198, v199
    v_mul_f32 v198, s44, v198
    v_max_f32 v198, v198, v196
    v_sub_f32 v199, v196, v198
    v_exp_f32 v199, v199
    v_mov_b32 v196, v198
    v_mov_b32 v202, v198
    v_mov_b32 v203, v198
    v_mov_b32 v204, s44
    v_mov_b32 v205, s44
    v_pk_fma_f32 v[64:65], v[64:65], v[204:205], v[202:203] neg_lo:[0,0,1] neg_hi:[0,0,1]
    v_pk_fma_f32 v[66:67], v[66:67], v[204:205], v[202:203] neg_lo:[0,0,1] neg_hi:[0,0,1]
    v_pk_fma_f32 v[68:69], v[68:69], v[204:205], v[202:203] neg_lo:[0,0,1] neg_hi:[0,0,1]
    v_pk_fma_f32 v[70:71], v[70:71], v[204:205], v[202:203] neg_lo:[0,0,1] neg_hi:[0,0,1]
    v_pk_fma_f32 v[72:73], v[72:73], v[204:205], v[202:203] neg_lo:[0,0,1] neg_hi:[0,0,1]
    v_pk_fma_f32 v[74:75], v[74:75], v[204:205], v[202:203] neg_lo:[0,0,1] neg_hi:[0,0,1]
    v_pk_fma_f32 v[76:77], v[76:77], v[204:205], v[202:203] neg_lo:[0,0,1] neg_hi:[0,0,1]
    v_pk_fma_f32 v[78:79], v[78:79], v[204:205], v[202:203] neg_lo:[0,0,1] neg_hi:[0,0,1]
    v_pk_fma_f32 v[80:81], v[80:81], v[204:205], v[202:203] neg_lo:[0,0,1] neg_hi:[0,0,1]
    v_pk_fma_f32 v[82:83], v[82:83], v[204:205], v[202:203] neg_lo:[0,0,1] neg_hi:[0,0,1]
    v_pk_fma_f32 v[84:85], v[84:85], v[204:205], v[202:203] neg_lo:[0,0,1] neg_hi:[0,0,1]
    v_pk_fma_f32 v[86:87], v[86:87], v[204:205], v[202:203] neg_lo:[0,0,1] neg_hi:[0,0,1]
    v_pk_fma_f32 v[88:89], v[88:89], v[204:205], v[202:203] neg_lo:[0,0,1] neg_hi:[0,0,1]
    v_pk_fma_f32 v[90:91], v[90:91], v[204:205], v[202:203] neg_lo:[0,0,1] neg_hi:[0,0,1]
    v_pk_fma_f32 v[92:93], v[92:93], v[204:205], v[202:203] neg_lo:[0,0,1] neg_hi:[0,0,1]
    v_pk_fma_f32 v[94:95], v[94:95], v[204:205], v[202:203] neg_lo:[0,0,1] neg_hi:[0,0,1]
    v_mov_b32 v206, v199
    v_mov_b32 v207, v199
    v_exp_f32 v64, v64
    v_exp_f32 v65, v65
    v_pk_mul_f32 v[0:1], v[0:1], v[206:207]
    v_pk_mul_f32 v[32:33], v[32:33], v[206:207]
    v_exp_f32 v66, v66
    v_exp_f32 v67, v67
    v_pk_mul_f32 v[2:3], v[2:3], v[206:207]
    v_pk_mul_f32 v[34:35], v[34:35], v[206:207]
    v_exp_f32 v68, v68
    v_exp_f32 v69, v69
    v_pk_mul_f32 v[4:5], v[4:5], v[206:207]
    v_pk_mul_f32 v[36:37], v[36:37], v[206:207]
    v_exp_f32 v70, v70
    v_exp_f32 v71, v71
    v_pk_mul_f32 v[6:7], v[6:7], v[206:207]
    v_pk_mul_f32 v[38:39], v[38:39], v[206:207]
    v_exp_f32 v72, v72
    v_exp_f32 v73, v73
    v_pk_mul_f32 v[8:9], v[8:9], v[206:207]
    v_pk_mul_f32 v[40:41], v[40:41], v[206:207]
    v_exp_f32 v74, v74
    v_exp_f32 v75, v75
    v_pk_mul_f32 v[10:11], v[10:11], v[206:207]
    v_pk_mul_f32 v[42:43], v[42:43], v[206:207]
    v_exp_f32 v76, v76
    v_exp_f32 v77, v77
    v_pk_mul_f32 v[12:13], v[12:13], v[206:207]
    v_pk_mul_f32 v[44:45], v[44:45], v[206:207]
    v_exp_f32 v78, v78
    v_exp_f32 v79, v79
    v_pk_mul_f32 v[14:15], v[14:15], v[206:207]
    v_pk_mul_f32 v[46:47], v[46:47], v[206:207]
    v_exp_f32 v80, v80
    v_exp_f32 v81, v81
    v_pk_mul_f32 v[16:17], v[16:17], v[206:207]
    v_pk_mul_f32 v[48:49], v[48:49], v[206:207]
    v_exp_f32 v82, v82
    v_exp_f32 v83, v83
    v_pk_mul_f32 v[18:19], v[18:19], v[206:207]
    v_pk_mul_f32 v[50:51], v[50:51], v[206:207]
    v_exp_f32 v84, v84
    v_exp_f32 v85, v85
    v_pk_mul_f32 v[20:21], v[20:21], v[206:207]
    v_pk_mul_f32 v[52:53], v[52:53], v[206:207]
    v_exp_f32 v86, v86
    v_exp_f32 v87, v87
    v_pk_mul_f32 v[22:23], v[22:23], v[206:207]
    v_pk_mul_f32 v[54:55], v[54:55], v[206:207]
    v_exp_f32 v88, v88
    v_exp_f32 v89, v89
    v_pk_mul_f32 v[24:25], v[24:25], v[206:207]
    v_pk_mul_f32 v[56:57], v[56:57], v[206:207]
    v_exp_f32 v90, v90
    v_exp_f32 v91, v91
    v_pk_mul_f32 v[26:27], v[26:27], v[206:207]
    v_pk_mul_f32 v[58:59], v[58:59], v[206:207]
    v_exp_f32 v92, v92
    v_exp_f32 v93, v93
    v_pk_mul_f32 v[28:29], v[28:29], v[206:207]
    v_pk_mul_f32 v[60:61], v[60:61], v[206:207]
    v_exp_f32 v94, v94
    v_exp_f32 v95, v95
    v_pk_mul_f32 v[30:31], v[30:31], v[206:207]
    v_pk_mul_f32 v[62:63], v[62:63], v[206:207]
    v_pk_add_f32 v[200:201], v[64:65], v[66:67]
    v_pk_add_f32 v[200:201], v[200:201], v[68:69]
    v_pk_add_f32 v[200:201], v[200:201], v[70:71]
    v_pk_add_f32 v[200:201], v[200:201], v[72:73]
    v_pk_add_f32 v[200:201], v[200:201], v[74:75]
    v_pk_add_f32 v[200:201], v[200:201], v[76:77]
    v_pk_add_f32 v[200:201], v[200:201], v[78:79]
    v_pk_add_f32 v[200:201], v[200:201], v[80:81]
    v_pk_add_f32 v[200:201], v[200:201], v[82:83]
    v_pk_add_f32 v[200:201], v[200:201], v[84:85]
    v_pk_add_f32 v[200:201], v[200:201], v[86:87]
    v_pk_add_f32 v[200:201], v[200:201], v[88:89]
    v_pk_add_f32 v[200:201], v[200:201], v[90:91]
    v_pk_add_f32 v[200:201], v[200:201], v[92:93]
    v_pk_add_f32 v[200:201], v[200:201], v[94:95]
    v_add_f32 v200, v200, v201
    v_fma_f32 v197, v197, v199, v200
    v_cvt_pk_bf16_f32 v128, v64, v65
    v_cvt_pk_bf16_f32 v129, v66, v67
    v_cvt_pk_bf16_f32 v130, v68, v69
    v_cvt_pk_bf16_f32 v131, v70, v71
    v_cvt_pk_bf16_f32 v132, v72, v73
    v_cvt_pk_bf16_f32 v133, v74, v75
    v_cvt_pk_bf16_f32 v134, v76, v77
    v_cvt_pk_bf16_f32 v135, v78, v79
    v_cvt_pk_bf16_f32 v136, v80, v81
    v_cvt_pk_bf16_f32 v137, v82, v83
    v_cvt_pk_bf16_f32 v138, v84, v85
    v_cvt_pk_bf16_f32 v139, v86, v87
    v_cvt_pk_bf16_f32 v140, v88, v89
    v_cvt_pk_bf16_f32 v141, v90, v91
    v_cvt_pk_bf16_f32 v142, v92, v93
    v_cvt_pk_bf16_f32 v143, v94, v95
    s_waitcnt vmcnt(0)
    s_barrier
    ds_read_b64_tr_b16 v[160:161], v184 offset:0
    ds_read_b64_tr_b16 v[162:163], v184 offset:2048
    ds_read_b64_tr_b16 v[164:165], v185 offset:0
    ds_read_b64_tr_b16 v[166:167], v185 offset:2048
    ds_read_b64_tr_b16 v[168:169], v186 offset:0
    ds_read_b64_tr_b16 v[170:171], v186 offset:2048
    ds_read_b64_tr_b16 v[172:173], v187 offset:0
    ds_read_b64_tr_b16 v[174:175], v187 offset:2048
    s_waitcnt lgkmcnt(6)
    v_mfma_f32_32x32x16_bf16 v[0:15], v[160:163], v[128:131], v[0:15]
    ds_read_b64_tr_b16 v[160:161], v184 offset:4096
    ds_read_b64_tr_b16 v[162:163], v184 offset:6144
    s_waitcnt lgkmcnt(6)
    v_mfma_f32_32x32x16_bf16 v[16:31], v[164:167], v[128:131], v[16:31]
    ds_read_b64_tr_b16 v[164:165], v185 offset:4096
    ds_read_b64_tr_b16 v[166:167], v185 offset:6144
    s_waitcnt lgkmcnt(6)
    v_mfma_f32_32x32x16_bf16 v[32:47], v[168:171], v[128:131], v[32:47]
    ds_read_b64_tr_b16 v[168:169], v186 offset:4096
    ds_read_b64_tr_b16 v[170:171], v186 offset:6144
    s_waitcnt lgkmcnt(6)
    v_mfma_f32_32x32x16_bf16 v[48:63], v[172:175], v[128:131], v[48:63]
    ds_read_b64_tr_b16 v[172:173], v187 offset:4096
    ds_read_b64_tr_b16 v[174:175], v187 offset:6144
    s_waitcnt lgkmcnt(6)
    v_mfma_f32_32x32x16_bf16 v[0:15], v[160:163], v[132:135], v[0:15]
    ds_read_b64_tr_b16 v[160:161], v184 offset:8192
    ds_read_b64_tr_b16 v[162:163], v184 offset:10240
    s_waitcnt lgkmcnt(6)
    v_mfma_f32_32x32x16_bf16 v[16:31], v[164:167], v[132:135], v[16:31]
    ds_read_b64_tr_b16 v[164:165], v185 offset:8192
    ds_read_b64_tr_b16 v[166:167], v185 offset:10240
    s_waitcnt lgkmcnt(6)
    v_mfma_f32_32x32x16_bf16 v[32:47], v[168:171], v[132:135], v[32:47]
    ds_read_b64_tr_b16 v[168:169], v186 offset:8192
    ds_read_b64_tr_b16 v[170:171], v186 offset:10240
    s_waitcnt lgkmcnt(6)
    v_mfma_f32_32x32x16_bf16 v[48:63], v[172:175], v[132:135], v[48:63]
    ds_read_b64_tr_b16 v[172:173], v187 offset:8192
    ds_read_b64_tr_b16 v[174:175], v187 offset:10240
    s_waitcnt lgkmcnt(6)
    v_mfma_f32_32x32x16_bf16 v[0:15], v[160:163], v[136:139], v[0:15]
    ds_read_b64_tr_b16 v[160:161], v184 offset:12288
    ds_read_b64_tr_b16 v[162:163], v184 offset:14336
    s_waitcnt lgkmcnt(6)
    v_mfma_f32_32x32x16_bf16 v[16:31], v[164:167], v[136:139], v[16:31]
    ds_read_b64_tr_b16 v[164:165], v185 offset:12288
    ds_read_b64_tr_b16 v[166:167], v185 offset:14336
    s_waitcnt lgkmcnt(6)
    v_mfma_f32_32x32x16_bf16 v[32:47], v[168:171], v[136:139], v[32:47]
    ds_read_b64_tr_b16 v[168:169], v186 offset:12288
    ds_read_b64_tr_b16 v[170:171], v186 offset:14336
    s_waitcnt lgkmcnt(6)
    v_mfma_f32_32x32x16_bf16 v[48:63], v[172:175], v[136:139], v[48:63]
    ds_read_b64_tr_b16 v[172:173], v187 offset:12288
    ds_read_b64_tr_b16 v[174:175], v187 offset:14336
    s_waitcnt lgkmcnt(6)
    v_mfma_f32_32x32x16_bf16 v[0:15], v[160:163], v[140:143], v[0:15]
    s_waitcnt lgkmcnt(4)
    v_mfma_f32_32x32x16_bf16 v[16:31], v[164:167], v[140:143], v[16:31]
    s_waitcnt lgkmcnt(2)
    v_mfma_f32_32x32x16_bf16 v[32:47], v[168:171], v[140:143], v[32:47]
    s_waitcnt lgkmcnt(0)
    v_mfma_f32_32x32x16_bf16 v[48:63], v[172:175], v[140:143], v[48:63]
    v_xor_b32 v184, 0x8000, v184
    v_xor_b32 v185, 0x8000, v185
    v_xor_b32 v186, 0x8000, v186
    v_xor_b32 v187, 0x8000, v187
    s_cmp_lg_u32 s30, 0
    s_cbranch_scc1 attn_kernel_nostag2
    s_barrier
attn_kernel_nostag2:
    s_nop 15
    s_barrier
    s_cmp_eq_u32 s30, 0
    s_cbranch_scc1 attn_kernel_mrg0
    v_lshlrev_b32 v198, 4, v216
    s_mul_i32 s34, s29, 17408
    v_add_u32 v198, s34, v198
    ds_write_b128 v198, v[0:3] offset:0
    ds_write_b128 v198, v[4:7] offset:1024
    ds_write_b128 v198, v[8:11] offset:2048
    ds_write_b128 v198, v[12:15] offset:3072
    ds_write_b128 v198, v[16:19] offset:4096
    ds_write_b128 v198, v[20:23] offset:5120
    ds_write_b128 v198, v[24:27] offset:6144
    ds_write_b128 v198, v[28:31] offset:7168
    ds_write_b128 v198, v[32:35] offset:8192
    ds_write_b128 v198, v[36:39] offset:9216
    ds_write_b128 v198, v[40:43] offset:10240
    ds_write_b128 v198, v[44:47] offset:11264
    ds_write_b128 v198, v[48:51] offset:12288
    ds_write_b128 v198, v[52:55] offset:13312
    ds_write_b128 v198, v[56:59] offset:14336
    ds_write_b128 v198, v[60:63] offset:15360
    v_lshlrev_b32 v199, 3, v216
    v_add_u32 v199, s34, v199
    ds_write_b64 v199, v[196:197] offset:16384
    s_waitcnt lgkmcnt(0)
    s_barrier
    s_branch attn_kernel_next
attn_kernel_mrg0:
    s_barrier
    v_lshlrev_b32 v198, 4, v216
    s_mul_i32 s34, s29, 17408
    v_add_u32 v198, s34, v198
    v_lshlrev_b32 v199, 3, v216
    v_add_u32 v199, s34, v199
    ds_read_b64 v[200:201], v199 offset:16384
    ds_read_b128 v[64:67], v198 offset:0
    ds_read_b128 v[68:71], v198 offset:1024
    ds_read_b128 v[72:75], v198 offset:2048
    ds_read_b128 v[76:79], v198 offset:3072
    ds_read_b128 v[80:83], v198 offset:4096
    ds_read_b128 v[84:87], v198 offset:5120
    ds_read_b128 v[88:91], v198 offset:6144
    ds_read_b128 v[92:95], v198 offset:7168
    s_waitcnt lgkmcnt(0)
    v_max_f32 v202, v196, v200
    v_sub_f32 v203, v196, v202
    v_sub_f32 v204, v200, v202
    v_exp_f32 v203, v203
    v_exp_f32 v204, v204
    s_nop 0
    v_mul_f32 v197, v197, v203
    v_fma_f32 v197, v201, v204, v197
    v_mul_f32 v0, v0, v203
    v_fma_f32 v0, v64, v204, v0
    v_mul_f32 v1, v1, v203
    v_fma_f32 v1, v65, v204, v1
    v_mul_f32 v2, v2, v203
    v_fma_f32 v2, v66, v204, v2
    v_mul_f32 v3, v3, v203
    v_fma_f32 v3, v67, v204, v3
    v_mul_f32 v4, v4, v203
    v_fma_f32 v4, v68, v204, v4
    v_mul_f32 v5, v5, v203
    v_fma_f32 v5, v69, v204, v5
    v_mul_f32 v6, v6, v203
    v_fma_f32 v6, v70, v204, v6
    v_mul_f32 v7, v7, v203
    v_fma_f32 v7, v71, v204, v7
    v_mul_f32 v8, v8, v203
    v_fma_f32 v8, v72, v204, v8
    v_mul_f32 v9, v9, v203
    v_fma_f32 v9, v73, v204, v9
    v_mul_f32 v10, v10, v203
    v_fma_f32 v10, v74, v204, v10
    v_mul_f32 v11, v11, v203
    v_fma_f32 v11, v75, v204, v11
    v_mul_f32 v12, v12, v203
    v_fma_f32 v12, v76, v204, v12
    v_mul_f32 v13, v13, v203
    v_fma_f32 v13, v77, v204, v13
    v_mul_f32 v14, v14, v203
    v_fma_f32 v14, v78, v204, v14
    v_mul_f32 v15, v15, v203
    v_fma_f32 v15, v79, v204, v15
    v_mul_f32 v16, v16, v203
    v_fma_f32 v16, v80, v204, v16
    v_mul_f32 v17, v17, v203
    v_fma_f32 v17, v81, v204, v17
    v_mul_f32 v18, v18, v203
    v_fma_f32 v18, v82, v204, v18
    v_mul_f32 v19, v19, v203
    v_fma_f32 v19, v83, v204, v19
    v_mul_f32 v20, v20, v203
    v_fma_f32 v20, v84, v204, v20
    v_mul_f32 v21, v21, v203
    v_fma_f32 v21, v85, v204, v21
    v_mul_f32 v22, v22, v203
    v_fma_f32 v22, v86, v204, v22
    v_mul_f32 v23, v23, v203
    v_fma_f32 v23, v87, v204, v23
    v_mul_f32 v24, v24, v203
    v_fma_f32 v24, v88, v204, v24
    v_mul_f32 v25, v25, v203
    v_fma_f32 v25, v89, v204, v25
    v_mul_f32 v26, v26, v203
    v_fma_f32 v26, v90, v204, v26
    v_mul_f32 v27, v27, v203
    v_fma_f32 v27, v91, v204, v27
    v_mul_f32 v28, v28, v203
    v_fma_f32 v28, v92, v204, v28
    v_mul_f32 v29, v29, v203
    v_fma_f32 v29, v93, v204, v29
    v_mul_f32 v30, v30, v203
    v_fma_f32 v30, v94, v204, v30
    v_mul_f32 v31, v31, v203
    v_fma_f32 v31, v95, v204, v31
    ds_read_b128 v[64:67], v198 offset:8192
    ds_read_b128 v[68:71], v198 offset:9216
    ds_read_b128 v[72:75], v198 offset:10240
    ds_read_b128 v[76:79], v198 offset:11264
    ds_read_b128 v[80:83], v198 offset:12288
    ds_read_b128 v[84:87], v198 offset:13312
    ds_read_b128 v[88:91], v198 offset:14336
    ds_read_b128 v[92:95], v198 offset:15360
    s_waitcnt lgkmcnt(0)
    v_mul_f32 v32, v32, v203
    v_fma_f32 v32, v64, v204, v32
    v_mul_f32 v33, v33, v203
    v_fma_f32 v33, v65, v204, v33
    v_mul_f32 v34, v34, v203
    v_fma_f32 v34, v66, v204, v34
    v_mul_f32 v35, v35, v203
    v_fma_f32 v35, v67, v204, v35
    v_mul_f32 v36, v36, v203
    v_fma_f32 v36, v68, v204, v36
    v_mul_f32 v37, v37, v203
    v_fma_f32 v37, v69, v204, v37
    v_mul_f32 v38, v38, v203
    v_fma_f32 v38, v70, v204, v38
    v_mul_f32 v39, v39, v203
    v_fma_f32 v39, v71, v204, v39
    v_mul_f32 v40, v40, v203
    v_fma_f32 v40, v72, v204, v40
    v_mul_f32 v41, v41, v203
    v_fma_f32 v41, v73, v204, v41
    v_mul_f32 v42, v42, v203
    v_fma_f32 v42, v74, v204, v42
    v_mul_f32 v43, v43, v203
    v_fma_f32 v43, v75, v204, v43
    v_mul_f32 v44, v44, v203
    v_fma_f32 v44, v76, v204, v44
    v_mul_f32 v45, v45, v203
    v_fma_f32 v45, v77, v204, v45
    v_mul_f32 v46, v46, v203
    v_fma_f32 v46, v78, v204, v46
    v_mul_f32 v47, v47, v203
    v_fma_f32 v47, v79, v204, v47
    v_mul_f32 v48, v48, v203
    v_fma_f32 v48, v80, v204, v48
    v_mul_f32 v49, v49, v203
    v_fma_f32 v49, v81, v204, v49
    v_mul_f32 v50, v50, v203
    v_fma_f32 v50, v82, v204, v50
    v_mul_f32 v51, v51, v203
    v_fma_f32 v51, v83, v204, v51
    v_mul_f32 v52, v52, v203
    v_fma_f32 v52, v84, v204, v52
    v_mul_f32 v53, v53, v203
    v_fma_f32 v53, v85, v204, v53
    v_mul_f32 v54, v54, v203
    v_fma_f32 v54, v86, v204, v54
    v_mul_f32 v55, v55, v203
    v_fma_f32 v55, v87, v204, v55
    v_mul_f32 v56, v56, v203
    v_fma_f32 v56, v88, v204, v56
    v_mul_f32 v57, v57, v203
    v_fma_f32 v57, v89, v204, v57
    v_mul_f32 v58, v58, v203
    v_fma_f32 v58, v90, v204, v58
    v_mul_f32 v59, v59, v203
    v_fma_f32 v59, v91, v204, v59
    v_mul_f32 v60, v60, v203
    v_fma_f32 v60, v92, v204, v60
    v_mul_f32 v61, v61, v203
    v_fma_f32 v61, v93, v204, v61
    v_mul_f32 v62, v62, v203
    v_fma_f32 v62, v94, v204, v62
    v_mul_f32 v63, v63, v203
    v_fma_f32 v63, v95, v204, v63
    v_mov_b32 v200, v197
    v_mov_b32 v201, v197
    s_nop 1
    v_permlane32_swap_b32 v200, v201
    v_add_f32 v200, v200, v201
    v_rcp_f32 v200, v200
    s_nop 0
    v_mul_f32 v0, v0, v200
    v_mul_f32 v1, v1, v200
    v_mul_f32 v2, v2, v200
    v_mul_f32 v3, v3, v200
    v_mul_f32 v4, v4, v200
    v_mul_f32 v5, v5, v200
    v_mul_f32 v6, v6, v200
    v_mul_f32 v7, v7, v200
    v_mul_f32 v8, v8, v200
    v_mul_f32 v9, v9, v200
    v_mul_f32 v10, v10, v200
    v_mul_f32 v11, v11, v200
    v_mul_f32 v12, v12, v200
    v_mul_f32 v13, v13, v200
    v_mul_f32 v14, v14, v200
    v_mul_f32 v15, v15, v200
    v_mul_f32 v16, v16, v200
    v_mul_f32 v17, v17, v200
    v_mul_f32 v18, v18, v200
    v_mul_f32 v19, v19, v200
    v_mul_f32 v20, v20, v200
    v_mul_f32 v21, v21, v200
    v_mul_f32 v22, v22, v200
    v_mul_f32 v23, v23, v200
    v_mul_f32 v24, v24, v200
    v_mul_f32 v25, v25, v200
    v_mul_f32 v26, v26, v200
    v_mul_f32 v27, v27, v200
    v_mul_f32 v28, v28, v200
    v_mul_f32 v29, v29, v200
    v_mul_f32 v30, v30, v200
    v_mul_f32 v31, v31, v200
    v_mul_f32 v32, v32, v200
    v_mul_f32 v33, v33, v200
    v_mul_f32 v34, v34, v200
    v_mul_f32 v35, v35, v200
    v_mul_f32 v36, v36, v200
    v_mul_f32 v37, v37, v200
    v_mul_f32 v38, v38, v200
    v_mul_f32 v39, v39, v200
    v_mul_f32 v40, v40, v200
    v_mul_f32 v41, v41, v200
    v_mul_f32 v42, v42, v200
    v_mul_f32 v43, v43, v200
    v_mul_f32 v44, v44, v200
    v_mul_f32 v45, v45, v200
    v_mul_f32 v46, v46, v200
    v_mul_f32 v47, v47, v200
    v_mul_f32 v48, v48, v200
    v_mul_f32 v49, v49, v200
    v_mul_f32 v50, v50, v200
    v_mul_f32 v51, v51, v200
    v_mul_f32 v52, v52, v200
    v_mul_f32 v53, v53, v200
    v_mul_f32 v54, v54, v200
    v_mul_f32 v55, v55, v200
    v_mul_f32 v56, v56, v200
    v_mul_f32 v57, v57, v200
    v_mul_f32 v58, v58, v200
    v_mul_f32 v59, v59, v200
    v_mul_f32 v60, v60, v200
    v_mul_f32 v61, v61, v200
    v_mul_f32 v62, v62, v200
    v_mul_f32 v63, v63, v200
    v_lshrrev_b32 v201, 5, v216
    v_lshlrev_b32 v201, 3, v201
    v_sub_u32 v201, v217, v201
    v_cvt_pk_bf16_f32 v0, v0, v1
    v_cvt_pk_bf16_f32 v1, v2, v3
    buffer_store_dwordx2 v[0:1], v201, s[20:23], 0 offen offset:0
    v_cvt_pk_bf16_f32 v4, v4, v5
    v_cvt_pk_bf16_f32 v5, v6, v7
    buffer_store_dwordx2 v[4:5], v201, s[20:23], 0 offen offset:16
    v_cvt_pk_bf16_f32 v8, v8, v9
    v_cvt_pk_bf16_f32 v9, v10, v11
    buffer_store_dwordx2 v[8:9], v201, s[20:23], 0 offen offset:32
    v_cvt_pk_bf16_f32 v12, v12, v13
    v_cvt_pk_bf16_f32 v13, v14, v15
    buffer_store_dwordx2 v[12:13], v201, s[20:23], 0 offen offset:48
    v_cvt_pk_bf16_f32 v16, v16, v17
    v_cvt_pk_bf16_f32 v17, v18, v19
    buffer_store_dwordx2 v[16:17], v201, s[20:23], 0 offen offset:64
    v_cvt_pk_bf16_f32 v20, v20, v21
    v_cvt_pk_bf16_f32 v21, v22, v23
    buffer_store_dwordx2 v[20:21], v201, s[20:23], 0 offen offset:80
    v_cvt_pk_bf16_f32 v24, v24, v25
    v_cvt_pk_bf16_f32 v25, v26, v27
    buffer_store_dwordx2 v[24:25], v201, s[20:23], 0 offen offset:96
    v_cvt_pk_bf16_f32 v28, v28, v29
    v_cvt_pk_bf16_f32 v29, v30, v31
    buffer_store_dwordx2 v[28:29], v201, s[20:23], 0 offen offset:112
    v_cvt_pk_bf16_f32 v32, v32, v33
    v_cvt_pk_bf16_f32 v33, v34, v35
    buffer_store_dwordx2 v[32:33], v201, s[20:23], 0 offen offset:128
    v_cvt_pk_bf16_f32 v36, v36, v37
    v_cvt_pk_bf16_f32 v37, v38, v39
    buffer_store_dwordx2 v[36:37], v201, s[20:23], 0 offen offset:144
    v_cvt_pk_bf16_f32 v40, v40, v41
    v_cvt_pk_bf16_f32 v41, v42, v43
    buffer_store_dwordx2 v[40:41], v201, s[20:23], 0 offen offset:160
    v_cvt_pk_bf16_f32 v44, v44, v45
    v_cvt_pk_bf16_f32 v45, v46, v47
    buffer_store_dwordx2 v[44:45], v201, s[20:23], 0 offen offset:176
    v_cvt_pk_bf16_f32 v48, v48, v49
    v_cvt_pk_bf16_f32 v49, v50, v51
    buffer_store_dwordx2 v[48:49], v201, s[20:23], 0 offen offset:192
    v_cvt_pk_bf16_f32 v52, v52, v53
    v_cvt_pk_bf16_f32 v53, v54, v55
    buffer_store_dwordx2 v[52:53], v201, s[20:23], 0 offen offset:208
    v_cvt_pk_bf16_f32 v56, v56, v57
    v_cvt_pk_bf16_f32 v57, v58, v59
    buffer_store_dwordx2 v[56:57], v201, s[20:23], 0 offen offset:224
    v_cvt_pk_bf16_f32 v60, v60, v61
    v_cvt_pk_bf16_f32 v61, v62, v63
    buffer_store_dwordx2 v[60:61], v201, s[20:23], 0 offen offset:240
attn_kernel_next:
    s_waitcnt lgkmcnt(0)
    s_barrier
    s_and_b32 s34, s33, 1
    s_cmp_eq_u32 s34, 1
    s_cbranch_scc1 attn_kernel_noflip
    s_xor_b32 s37, s37, 0x8000
    v_xor_b32 v176, 0x8000, v176
    v_xor_b32 v177, 0x8000, v177
    v_xor_b32 v178, 0x8000, v178
    v_xor_b32 v179, 0x8000, v179
    v_xor_b32 v180, 0x8000, v180
    v_xor_b32 v181, 0x8000, v181
    v_xor_b32 v182, 0x8000, v182
    v_xor_b32 v183, 0x8000, v183
    v_xor_b32 v184, 0x8000, v184
    v_xor_b32 v185, 0x8000, v185
    v_xor_b32 v186, 0x8000, v186
    v_xor_b32 v187, 0x8000, v187
attn_kernel_noflip:
    s_add_u32 s40, s40, 1
    s_mov_b32 s33, s32
    s_cmp_eq_u32 s40, 1
    s_cbranch_scc1 attn_kernel_block
attn_kernel_done:
    s_endpgm
.section .rodata,"a"
.p2align 6
.amdhsa_kernel attn_kernel
  .amdhsa_next_free_vgpr 220
  .amdhsa_next_free_sgpr 70
  .amdhsa_accum_offset 220
  .amdhsa_group_segment_fixed_size 0
  .amdhsa_kernarg_size 112
  .amdhsa_user_sgpr_count 2
  .amdhsa_user_sgpr_kernarg_segment_ptr 1
  .amdhsa_system_sgpr_workgroup_id_x 1
.end_amdhsa_kernel
.text
.globl oproj_kernel
.p2align 8
.type oproj_kernel,@function
oproj_kernel:
    s_cmp_ge_u32 s2, 256
    s_cbranch_scc1 oproj_kernel_done
    v_and_b32 v118, 63, v0
    v_lshrrev_b32 v110, 6, v0
    s_nop 0
    v_readfirstlane_b32 s28, v110
    s_lshr_b32 s31, s2, 6
    s_and_b32 s32, s2, 63
    s_lshr_b32 s29, s32, 2
    s_and_b32 s30, s32, 3
    s_load_dwordx2 s[4:5], s[0:1], 104
    s_load_dwordx2 s[6:7], s[0:1], 40
    s_waitcnt lgkmcnt(0)
    s_lshl_b32 s32, s29, 20
    s_mul_i32 s33, s31, 2048
    s_add_u32 s32, s32, s33
    s_add_u32 s32, s32, 0x4000000
    s_sub_u32 s33, 0x5000000, s32
    s_add_u32 s8, s4, s32
    s_addc_u32 s9, s5, 0
    s_and_b32 s9, s9, 0xffff
    s_mov_b32 s10, s33
    s_mov_b32 s11, 0x00020000
    s_mul_i32 s32, s31, 1048576
    s_lshl_b32 s33, s30, 8
    s_add_u32 s32, s32, s33
    s_sub_u32 s33, 0x400000, s32
    s_add_u32 s12, s6, s32
    s_addc_u32 s13, s7, 0
    s_and_b32 s13, s13, 0xffff
    s_mov_b32 s14, s33
    s_mov_b32 s15, 0x00020000
    s_lshl_b32 s32, s31, 22
    s_lshl_b32 s33, s29, 18
    s_add_u32 s32, s32, s33
    s_lshl_b32 s33, s30, 9
    s_add_u32 s32, s32, s33
    s_add_u32 s32, s32, 0x5000000
    s_sub_u32 s33, 0x6000000, s32
    s_add_u32 s16, s4, s32
    s_addc_u32 s17, s5, 0
    s_and_b32 s17, s17, 0xffff
    s_mov_b32 s18, s33
    s_mov_b32 s19, 0x00020000
    s_mul_i32 s32, s28, 4
    s_add_u32 s32, s32, 0
    v_lshrrev_b32 v110, 3, v118
    s_lshl_b32 s33, s32, 3
    v_add_u32 v110, s33, v110
    v_lshrrev_b32 v111, 1, v110
    v_and_b32 v111, 7, v111
    v_and_b32 v112, 7, v118
    v_xor_b32 v111, v111, v112
    v_lshlrev_b32 v111, 4, v111
    s_mov_b32 s33, 8192
    v_mul_lo_u32 v96, v110, s33
    v_add_u32 v96, v96, v111
    s_mul_i32 s32, s28, 4
    s_add_u32 s32, s32, 1
    v_lshrrev_b32 v110, 3, v118
    s_lshl_b32 s33, s32, 3
    v_add_u32 v110, s33, v110
    v_lshrrev_b32 v111, 1, v110
    v_and_b32 v111, 7, v111
    v_and_b32 v112, 7, v118
    v_xor_b32 v111, v111, v112
    v_lshlrev_b32 v111, 4, v111
    s_mov_b32 s33, 8192
    v_mul_lo_u32 v97, v110, s33
    v_add_u32 v97, v97, v111
    s_mul_i32 s32, s28, 4
    s_add_u32 s32, s32, 2
    v_lshrrev_b32 v110, 3, v118
    s_lshl_b32 s33, s32, 3
    v_add_u32 v110, s33, v110
    v_lshrrev_b32 v111, 1, v110
    v_and_b32 v111, 7, v111
    v_and_b32 v112, 7, v118
    v_xor_b32 v111, v111, v112
    v_lshlrev_b32 v111, 4, v111
    s_mov_b32 s33, 8192
    v_mul_lo_u32 v98, v110, s33
    v_add_u32 v98, v98, v111
    s_mul_i32 s32, s28, 4
    s_add_u32 s32, s32, 3
    v_lshrrev_b32 v110, 3, v118
    s_lshl_b32 s33, s32, 3
    v_add_u32 v110, s33, v110
    v_lshrrev_b32 v111, 1, v110
    v_and_b32 v111, 7, v111
    v_and_b32 v112, 7, v118
    v_xor_b32 v111, v111, v112
    v_lshlrev_b32 v111, 4, v111
    s_mov_b32 s33, 8192
    v_mul_lo_u32 v99, v110, s33
    v_add_u32 v99, v99, v111
    s_lshl_b32 s32, s28, 2
    s_add_u32 s32, s32, 0
    v_lshrrev_b32 v110, 4, v118
    v_lshlrev_b32 v111, 2, v110
    s_lshl_b32 s33, s32, 2
    v_add_u32 v110, s33, v110
    v_and_b32 v112, 15, v118
    v_xor_b32 v111, v111, v112
    v_lshlrev_b32 v111, 4, v111
    s_mov_b32 s33, 1024
    v_mul_lo_u32 v100, v110, s33
    v_add_u32 v100, v100, v111
    s_lshl_b32 s32, s28, 2
    s_add_u32 s32, s32, 1
    v_lshrrev_b32 v110, 4, v118
    v_lshlrev_b32 v111, 2, v110
    s_lshl_b32 s33, s32, 2
    v_add_u32 v110, s33, v110
    v_and_b32 v112, 15, v118
    v_xor_b32 v111, v111, v112
    v_lshlrev_b32 v111, 4, v111
    s_mov_b32 s33, 1024
    v_mul_lo_u32 v101, v110, s33
    v_add_u32 v101, v101, v111
    s_lshl_b32 s32, s28, 2
    s_add_u32 s32, s32, 2
    v_lshrrev_b32 v110, 4, v118
    v_lshlrev_b32 v111, 2, v110
    s_lshl_b32 s33, s32, 2
    v_add_u32 v110, s33, v110
    v_and_b32 v112, 15, v118
    v_xor_b32 v111, v111, v112
    v_lshlrev_b32 v111, 4, v111
    s_mov_b32 s33, 1024
    v_mul_lo_u32 v102, v110, s33
    v_add_u32 v102, v102, v111
    s_lshl_b32 s32, s28, 2
    s_add_u32 s32, s32, 3
    v_lshrrev_b32 v110, 4, v118
    v_lshlrev_b32 v111, 2, v110
    s_lshl_b32 s33, s32, 2
    v_add_u32 v110, s33, v110
    v_and_b32 v112, 15, v118
    v_xor_b32 v111, v111, v112
    v_lshlrev_b32 v111, 4, v111
    s_mov_b32 s33, 1024
    v_mul_lo_u32 v103, v110, s33
    v_add_u32 v103, v103, v111
    s_lshr_b32 s34, s28, 1
    s_and_b32 s35, s28, 1
    v_and_b32 v110, 31, v118
    s_mul_i32 s32, s34, 64
    v_add_u32 v110, s32, v110
    v_lshrrev_b32 v111, 1, v110
    v_and_b32 v111, 7, v111
    v_lshrrev_b32 v112, 5, v118
    v_xor_b32 v111, v111, v112
    v_lshlrev_b32 v111, 4, v111
    v_lshl_add_u32 v104, v110, 7, v111
    v_xor_b32 v105, 32, v104
    v_xor_b32 v106, 64, v104
    v_xor_b32 v107, 96, v104
    v_lshrrev_b32 v110, 5, v118
    v_lshlrev_b32 v110, 3, v110
    v_bfe_u32 v111, v118, 2, 2
    v_add_u32 v110, v110, v111
    v_lshlrev_b32 v110, 8, v110
    v_bfe_u32 v112, v118, 4, 1
    v_lshlrev_b32 v112, 5, v112
    v_and_b32 v113, 3, v118
    v_lshl_add_u32 v112, v113, 3, v112
    v_add_u32 v110, v110, v112
    s_lshl_b32 s32, s35, 1
    s_add_u32 s32, s32, 0
    v_xor_b32 v113, s32, v111
    v_lshl_add_u32 v108, v113, 6, v110
    s_lshl_b32 s32, s35, 1
    s_add_u32 s32, s32, 1
    v_xor_b32 v113, s32, v111
    v_lshl_add_u32 v109, v113, 6, v110
    v_mov_b32 v0, 0
    v_mov_b32 v1, 0
    v_mov_b32 v2, 0
    v_mov_b32 v3, 0
    v_mov_b32 v4, 0
    v_mov_b32 v5, 0
    v_mov_b32 v6, 0
    v_mov_b32 v7, 0
    v_mov_b32 v8, 0
    v_mov_b32 v9, 0
    v_mov_b32 v10, 0
    v_mov_b32 v11, 0
    v_mov_b32 v12, 0
    v_mov_b32 v13, 0
    v_mov_b32 v14, 0
    v_mov_b32 v15, 0
    v_mov_b32 v16, 0
    v_mov_b32 v17, 0
    v_mov_b32 v18, 0
    v_mov_b32 v19, 0
    v_mov_b32 v20, 0
    v_mov_b32 v21, 0
    v_mov_b32 v22, 0
    v_mov_b32 v23, 0
    v_mov_b32 v24, 0
    v_mov_b32 v25, 0
    v_mov_b32 v26, 0
    v_mov_b32 v27, 0
    v_mov_b32 v28, 0
    v_mov_b32 v29, 0
    v_mov_b32 v30, 0
    v_mov_b32 v31, 0
    v_mov_b32 v32, 0
    v_mov_b32 v33, 0
    v_mov_b32 v34, 0
    v_mov_b32 v35, 0
    v_mov_b32 v36, 0
    v_mov_b32 v37, 0
    v_mov_b32 v38, 0
    v_mov_b32 v39, 0
    v_mov_b32 v40, 0
    v_mov_b32 v41, 0
    v_mov_b32 v42, 0
    v_mov_b32 v43, 0
    v_mov_b32 v44, 0
    v_mov_b32 v45, 0
    v_mov_b32 v46, 0
    v_mov_b32 v47, 0
    v_mov_b32 v48, 0
    v_mov_b32 v49, 0
    v_mov_b32 v50, 0
    v_mov_b32 v51, 0
    v_mov_b32 v52, 0
    v_mov_b32 v53, 0
    v_mov_b32 v54, 0
    v_mov_b32 v55, 0
    v_mov_b32 v56, 0
    v_mov_b32 v57, 0
    v_mov_b32 v58, 0
    v_mov_b32 v59, 0
    v_mov_b32 v60, 0
    v_mov_b32 v61, 0
    v_mov_b32 v62, 0
    v_mov_b32 v63, 0
    s_mul_i32 s36, s28, 4096
    s_lshl_b32 s37, s28, 12
    s_add_u32 s37, s37, 16384
    s_mov_b32 s38, 0
    s_mov_b32 s39, 0
    s_add_u32 m0, s36, 0
    s_nop 0
    buffer_load_dwordx4 v96, s[8:11], s38 offen lds
    s_add_u32 m0, s36, 1024
    s_nop 0
    buffer_load_dwordx4 v97, s[8:11], s38 offen lds
    s_add_u32 m0, s36, 2048
    s_nop 0
    buffer_load_dwordx4 v98, s[8:11], s38 offen lds
    s_add_u32 m0, s36, 3072
    s_nop 0
    buffer_load_dwordx4 v99, s[8:11], s38 offen lds
    s_add_u32 m0, s37, 0
    s_nop 0
    buffer_load_dwordx4 v100, s[12:15], s39 offen lds
    s_add_u32 m0, s37, 1024
    s_nop 0
    buffer_load_dwordx4 v101, s[12:15], s39 offen lds
    s_add_u32 m0, s37, 2048
    s_nop 0
    buffer_load_dwordx4 v102, s[12:15], s39 offen lds
    s_add_u32 m0, s37, 3072
    s_nop 0
    buffer_load_dwordx4 v103, s[12:15], s39 offen lds
    s_add_u32 s38, s38, 128
    s_add_u32 s39, s39, 65536
    s_waitcnt vmcnt(0)
    s_barrier
    s_add_u32 m0, s36, 32768
    s_nop 0
    buffer_load_dwordx4 v96, s[8:11], s38 offen lds
    s_add_u32 m0, s36, 33792
    s_nop 0
    buffer_load_dwordx4 v97, s[8:11], s38 offen lds
    s_add_u32 m0, s36, 34816
    s_nop 0
    buffer_load_dwordx4 v98, s[8:11], s38 offen lds
    s_add_u32 m0, s36, 35840
    s_nop 0
    buffer_load_dwordx4 v99, s[8:11], s38 offen lds
    s_add_u32 m0, s37, 32768
    s_nop 0
    buffer_load_dwordx4 v100, s[12:15], s39 offen lds
    s_add_u32 m0, s37, 33792
    s_nop 0
    buffer_load_dwordx4 v101, s[12:15], s39 offen lds
    s_add_u32 m0, s37, 34816
    s_nop 0
    buffer_load_dwordx4 v102, s[12:15], s39 offen lds
    s_add_u32 m0, s37, 35840
    s_nop 0
    buffer_load_dwordx4 v103, s[12:15], s39 offen lds
    s_add_u32 s38, s38, 128
    s_add_u32 s39, s39, 65536
    ds_read_b128 v[64:67], v104 offset:0
    ds_read_b128 v[68:71], v104 offset:4096
    ds_read_b64_tr_b16 v[72:73], v108 offset:16384
    ds_read_b64_tr_b16 v[74:75], v108 offset:17408
    ds_read_b64_tr_b16 v[76:77], v109 offset:16384
    ds_read_b64_tr_b16 v[78:79], v109 offset:17408
    ds_read_b128 v[80:83], v105 offset:0
    ds_read_b128 v[84:87], v105 offset:4096
    ds_read_b64_tr_b16 v[88:89], v108 offset:20480
    ds_read_b64_tr_b16 v[90:91], v108 offset:21504
    ds_read_b64_tr_b16 v[92:93], v109 offset:20480
    ds_read_b64_tr_b16 v[94:95], v109 offset:21504
    s_waitcnt lgkmcnt(6)
    v_mfma_f32_32x32x16_bf16 v[0:15], v[72:75], v[64:67], v[0:15]
    v_mfma_f32_32x32x16_bf16 v[16:31], v[76:79], v[64:67], v[16:31]
    v_mfma_f32_32x32x16_bf16 v[32:47], v[72:75], v[68:71], v[32:47]
    v_mfma_f32_32x32x16_bf16 v[48:63], v[76:79], v[68:71], v[48:63]
    ds_read_b128 v[64:67], v106 offset:0
    ds_read_b128 v[68:71], v106 offset:4096
    ds_read_b64_tr_b16 v[72:73], v108 offset:24576
    ds_read_b64_tr_b16 v[74:75], v108 offset:25600
    ds_read_b64_tr_b16 v[76:77], v109 offset:24576
    ds_read_b64_tr_b16 v[78:79], v109 offset:25600
    s_waitcnt lgkmcnt(6)
    v_mfma_f32_32x32x16_bf16 v[0:15], v[88:91], v[80:83], v[0:15]
    v_mfma_f32_32x32x16_bf16 v[16:31], v[92:95], v[80:83], v[16:31]
    v_mfma_f32_32x32x16_bf16 v[32:47], v[88:91], v[84:87], v[32:47]
    v_mfma_f32_32x32x16_bf16 v[48:63], v[92:95], v[84:87], v[48:63]
    ds_read_b128 v[80:83], v107 offset:0
    ds_read_b128 v[84:87], v107 offset:4096
    ds_read_b64_tr_b16 v[88:89], v108 offset:28672
    ds_read_b64_tr_b16 v[90:91], v108 offset:29696
    ds_read_b64_tr_b16 v[92:93], v109 offset:28672
    ds_read_b64_tr_b16 v[94:95], v109 offset:29696
    s_waitcnt lgkmcnt(6)
    v_mfma_f32_32x32x16_bf16 v[0:15], v[72:75], v[64:67], v[0:15]
    v_mfma_f32_32x32x16_bf16 v[16:31], v[76:79], v[64:67], v[16:31]
    v_mfma_f32_32x32x16_bf16 v[32:47], v[72:75], v[68:71], v[32:47]
    v_mfma_f32_32x32x16_bf16 v[48:63], v[76:79], v[68:71], v[48:63]
    s_waitcnt lgkmcnt(0)
    v_mfma_f32_32x32x16_bf16 v[0:15], v[88:91], v[80:83], v[0:15]
    v_mfma_f32_32x32x16_bf16 v[16:31], v[92:95], v[80:83], v[16:31]
    v_mfma_f32_32x32x16_bf16 v[32:47], v[88:91], v[84:87], v[32:47]
    v_mfma_f32_32x32x16_bf16 v[48:63], v[92:95], v[84:87], v[48:63]
    s_waitcnt vmcnt(0)
    s_barrier
    s_add_u32 m0, s36, 0
    s_nop 0
    buffer_load_dwordx4 v96, s[8:11], s38 offen lds
    s_add_u32 m0, s36, 1024
    s_nop 0
    buffer_load_dwordx4 v97, s[8:11], s38 offen lds
    s_add_u32 m0, s36, 2048
    s_nop 0
    buffer_load_dwordx4 v98, s[8:11], s38 offen lds
    s_add_u32 m0, s36, 3072
    s_nop 0
    buffer_load_dwordx4 v99, s[8:11], s38 offen lds
    s_add_u32 m0, s37, 0
    s_nop 0
    buffer_load_dwordx4 v100, s[12:15], s39 offen lds
    s_add_u32 m0, s37, 1024
    s_nop 0
    buffer_load_dwordx4 v101, s[12:15], s39 offen lds
    s_add_u32 m0, s37, 2048
    s_nop 0
    buffer_load_dwordx4 v102, s[12:15], s39 offen lds
    s_add_u32 m0, s37, 3072
    s_nop 0
    buffer_load_dwordx4 v103, s[12:15], s39 offen lds
    s_add_u32 s38, s38, 128
    s_add_u32 s39, s39, 65536
    ds_read_b128 v[64:67], v104 offset:32768
    ds_read_b128 v[68:71], v104 offset:36864
    ds_read_b64_tr_b16 v[72:73], v108 offset:49152
    ds_read_b64_tr_b16 v[74:75], v108 offset:50176
    ds_read_b64_tr_b16 v[76:77], v109 offset:49152
    ds_read_b64_tr_b16 v[78:79], v109 offset:50176
    ds_read_b128 v[80:83], v105 offset:32768
    ds_read_b128 v[84:87], v105 offset:36864
    ds_read_b64_tr_b16 v[88:89], v108 offset:53248
    ds_read_b64_tr_b16 v[90:91], v108 offset:54272
    ds_read_b64_tr_b16 v[92:93], v109 offset:53248
    ds_read_b64_tr_b16 v[94:95], v109 offset:54272
    s_waitcnt lgkmcnt(6)
    v_mfma_f32_32x32x16_bf16 v[0:15], v[72:75], v[64:67], v[0:15]
    v_mfma_f32_32x32x16_bf16 v[16:31], v[76:79], v[64:67], v[16:31]
    v_mfma_f32_32x32x16_bf16 v[32:47], v[72:75], v[68:71], v[32:47]
    v_mfma_f32_32x32x16_bf16 v[48:63], v[76:79], v[68:71], v[48:63]
    ds_read_b128 v[64:67], v106 offset:32768
    ds_read_b128 v[68:71], v106 offset:36864
    ds_read_b64_tr_b16 v[72:73], v108 offset:57344
    ds_read_b64_tr_b16 v[74:75], v108 offset:58368
    ds_read_b64_tr_b16 v[76:77], v109 offset:57344
    ds_read_b64_tr_b16 v[78:79], v109 offset:58368
    s_waitcnt lgkmcnt(6)
    v_mfma_f32_32x32x16_bf16 v[0:15], v[88:91], v[80:83], v[0:15]
    v_mfma_f32_32x32x16_bf16 v[16:31], v[92:95], v[80:83], v[16:31]
    v_mfma_f32_32x32x16_bf16 v[32:47], v[88:91], v[84:87], v[32:47]
    v_mfma_f32_32x32x16_bf16 v[48:63], v[92:95], v[84:87], v[48:63]
    ds_read_b128 v[80:83], v107 offset:32768
    ds_read_b128 v[84:87], v107 offset:36864
    ds_read_b64_tr_b16 v[88:89], v108 offset:61440
    ds_read_b64_tr_b16 v[90:91], v108 offset:62464
    ds_read_b64_tr_b16 v[92:93], v109 offset:61440
    ds_read_b64_tr_b16 v[94:95], v109 offset:62464
    s_waitcnt lgkmcnt(6)
    v_mfma_f32_32x32x16_bf16 v[0:15], v[72:75], v[64:67], v[0:15]
    v_mfma_f32_32x32x16_bf16 v[16:31], v[76:79], v[64:67], v[16:31]
    v_mfma_f32_32x32x16_bf16 v[32:47], v[72:75], v[68:71], v[32:47]
    v_mfma_f32_32x32x16_bf16 v[48:63], v[76:79], v[68:71], v[48:63]
    s_waitcnt lgkmcnt(0)
    v_mfma_f32_32x32x16_bf16 v[0:15], v[88:91], v[80:83], v[0:15]
    v_mfma_f32_32x32x16_bf16 v[16:31], v[92:95], v[80:83], v[16:31]
    v_mfma_f32_32x32x16_bf16 v[32:47], v[88:91], v[84:87], v[32:47]
    v_mfma_f32_32x32x16_bf16 v[48:63], v[92:95], v[84:87], v[48:63]
    s_waitcnt vmcnt(0)
    s_barrier
    s_add_u32 m0, s36, 32768
    s_nop 0
    buffer_load_dwordx4 v96, s[8:11], s38 offen lds
    s_add_u32 m0, s36, 33792
    s_nop 0
    buffer_load_dwordx4 v97, s[8:11], s38 offen lds
    s_add_u32 m0, s36, 34816
    s_nop 0
    buffer_load_dwordx4 v98, s[8:11], s38 offen lds
    s_add_u32 m0, s36, 35840
    s_nop 0
    buffer_load_dwordx4 v99, s[8:11], s38 offen lds
    s_add_u32 m0, s37, 32768
    s_nop 0
    buffer_load_dwordx4 v100, s[12:15], s39 offen lds
    s_add_u32 m0, s37, 33792
    s_nop 0
    buffer_load_dwordx4 v101, s[12:15], s39 offen lds
    s_add_u32 m0, s37, 34816
    s_nop 0
    buffer_load_dwordx4 v102, s[12:15], s39 offen lds
    s_add_u32 m0, s37, 35840
    s_nop 0
    buffer_load_dwordx4 v103, s[12:15], s39 offen lds
    s_add_u32 s38, s38, 128
    s_add_u32 s39, s39, 65536
    ds_read_b128 v[64:67], v104 offset:0
    ds_read_b128 v[68:71], v104 offset:4096
    ds_read_b64_tr_b16 v[72:73], v108 offset:16384
    ds_read_b64_tr_b16 v[74:75], v108 offset:17408
    ds_read_b64_tr_b16 v[76:77], v109 offset:16384
    ds_read_b64_tr_b16 v[78:79], v109 offset:17408
    ds_read_b128 v[80:83], v105 offset:0
    ds_read_b128 v[84:87], v105 offset:4096
    ds_read_b64_tr_b16 v[88:89], v108 offset:20480
    ds_read_b64_tr_b16 v[90:91], v108 offset:21504
    ds_read_b64_tr_b16 v[92:93], v109 offset:20480
    ds_read_b64_tr_b16 v[94:95], v109 offset:21504
    s_waitcnt lgkmcnt(6)
    v_mfma_f32_32x32x16_bf16 v[0:15], v[72:75], v[64:67], v[0:15]
    v_mfma_f32_32x32x16_bf16 v[16:31], v[76:79], v[64:67], v[16:31]
    v_mfma_f32_32x32x16_bf16 v[32:47], v[72:75], v[68:71], v[32:47]
    v_mfma_f32_32x32x16_bf16 v[48:63], v[76:79], v[68:71], v[48:63]
    ds_read_b128 v[64:67], v106 offset:0
    ds_read_b128 v[68:71], v106 offset:4096
    ds_read_b64_tr_b16 v[72:73], v108 offset:24576
    ds_read_b64_tr_b16 v[74:75], v108 offset:25600
    ds_read_b64_tr_b16 v[76:77], v109 offset:24576
    ds_read_b64_tr_b16 v[78:79], v109 offset:25600
    s_waitcnt lgkmcnt(6)
    v_mfma_f32_32x32x16_bf16 v[0:15], v[88:91], v[80:83], v[0:15]
    v_mfma_f32_32x32x16_bf16 v[16:31], v[92:95], v[80:83], v[16:31]
    v_mfma_f32_32x32x16_bf16 v[32:47], v[88:91], v[84:87], v[32:47]
    v_mfma_f32_32x32x16_bf16 v[48:63], v[92:95], v[84:87], v[48:63]
    ds_read_b128 v[80:83], v107 offset:0
    ds_read_b128 v[84:87], v107 offset:4096
    ds_read_b64_tr_b16 v[88:89], v108 offset:28672
    ds_read_b64_tr_b16 v[90:91], v108 offset:29696
    ds_read_b64_tr_b16 v[92:93], v109 offset:28672
    ds_read_b64_tr_b16 v[94:95], v109 offset:29696
    s_waitcnt lgkmcnt(6)
    v_mfma_f32_32x32x16_bf16 v[0:15], v[72:75], v[64:67], v[0:15]
    v_mfma_f32_32x32x16_bf16 v[16:31], v[76:79], v[64:67], v[16:31]
    v_mfma_f32_32x32x16_bf16 v[32:47], v[72:75], v[68:71], v[32:47]
    v_mfma_f32_32x32x16_bf16 v[48:63], v[76:79], v[68:71], v[48:63]
    s_waitcnt lgkmcnt(0)
    v_mfma_f32_32x32x16_bf16 v[0:15], v[88:91], v[80:83], v[0:15]
    v_mfma_f32_32x32x16_bf16 v[16:31], v[92:95], v[80:83], v[16:31]
    v_mfma_f32_32x32x16_bf16 v[32:47], v[88:91], v[84:87], v[32:47]
    v_mfma_f32_32x32x16_bf16 v[48:63], v[92:95], v[84:87], v[48:63]
    s_waitcnt vmcnt(0)
    s_barrier
    s_add_u32 m0, s36, 0
    s_nop 0
    buffer_load_dwordx4 v96, s[8:11], s38 offen lds
    s_add_u32 m0, s36, 1024
    s_nop 0
    buffer_load_dwordx4 v97, s[8:11], s38 offen lds
    s_add_u32 m0, s36, 2048
    s_nop 0
    buffer_load_dwordx4 v98, s[8:11], s38 offen lds
    s_add_u32 m0, s36, 3072
    s_nop 0
    buffer_load_dwordx4 v99, s[8:11], s38 offen lds
    s_add_u32 m0, s37, 0
    s_nop 0
    buffer_load_dwordx4 v100, s[12:15], s39 offen lds
    s_add_u32 m0, s37, 1024
    s_nop 0
    buffer_load_dwordx4 v101, s[12:15], s39 offen lds
    s_add_u32 m0, s37, 2048
    s_nop 0
    buffer_load_dwordx4 v102, s[12:15], s39 offen lds
    s_add_u32 m0, s37, 3072
    s_nop 0
    buffer_load_dwordx4 v103, s[12:15], s39 offen lds
    s_add_u32 s38, s38, 128
    s_add_u32 s39, s39, 65536
    ds_read_b128 v[64:67], v104 offset:32768
    ds_read_b128 v[68:71], v104 offset:36864
    ds_read_b64_tr_b16 v[72:73], v108 offset:49152
    ds_read_b64_tr_b16 v[74:75], v108 offset:50176
    ds_read_b64_tr_b16 v[76:77], v109 offset:49152
    ds_read_b64_tr_b16 v[78:79], v109 offset:50176
    ds_read_b128 v[80:83], v105 offset:32768
    ds_read_b128 v[84:87], v105 offset:36864
    ds_read_b64_tr_b16 v[88:89], v108 offset:53248
    ds_read_b64_tr_b16 v[90:91], v108 offset:54272
    ds_read_b64_tr_b16 v[92:93], v109 offset:53248
    ds_read_b64_tr_b16 v[94:95], v109 offset:54272
    s_waitcnt lgkmcnt(6)
    v_mfma_f32_32x32x16_bf16 v[0:15], v[72:75], v[64:67], v[0:15]
    v_mfma_f32_32x32x16_bf16 v[16:31], v[76:79], v[64:67], v[16:31]
    v_mfma_f32_32x32x16_bf16 v[32:47], v[72:75], v[68:71], v[32:47]
    v_mfma_f32_32x32x16_bf16 v[48:63], v[76:79], v[68:71], v[48:63]
    ds_read_b128 v[64:67], v106 offset:32768
    ds_read_b128 v[68:71], v106 offset:36864
    ds_read_b64_tr_b16 v[72:73], v108 offset:57344
    ds_read_b64_tr_b16 v[74:75], v108 offset:58368
    ds_read_b64_tr_b16 v[76:77], v109 offset:57344
    ds_read_b64_tr_b16 v[78:79], v109 offset:58368
    s_waitcnt lgkmcnt(6)
    v_mfma_f32_32x32x16_bf16 v[0:15], v[88:91], v[80:83], v[0:15]
    v_mfma_f32_32x32x16_bf16 v[16:31], v[92:95], v[80:83], v[16:31]
    v_mfma_f32_32x32x16_bf16 v[32:47], v[88:91], v[84:87], v[32:47]
    v_mfma_f32_32x32x16_bf16 v[48:63], v[92:95], v[84:87], v[48:63]
    ds_read_b128 v[80:83], v107 offset:32768
    ds_read_b128 v[84:87], v107 offset:36864
    ds_read_b64_tr_b16 v[88:89], v108 offset:61440
    ds_read_b64_tr_b16 v[90:91], v108 offset:62464
    ds_read_b64_tr_b16 v[92:93], v109 offset:61440
    ds_read_b64_tr_b16 v[94:95], v109 offset:62464
    s_waitcnt lgkmcnt(6)
    v_mfma_f32_32x32x16_bf16 v[0:15], v[72:75], v[64:67], v[0:15]
    v_mfma_f32_32x32x16_bf16 v[16:31], v[76:79], v[64:67], v[16:31]
    v_mfma_f32_32x32x16_bf16 v[32:47], v[72:75], v[68:71], v[32:47]
    v_mfma_f32_32x32x16_bf16 v[48:63], v[76:79], v[68:71], v[48:63]
    s_waitcnt lgkmcnt(0)
    v_mfma_f32_32x32x16_bf16 v[0:15], v[88:91], v[80:83], v[0:15]
    v_mfma_f32_32x32x16_bf16 v[16:31], v[92:95], v[80:83], v[16:31]
    v_mfma_f32_32x32x16_bf16 v[32:47], v[88:91], v[84:87], v[32:47]
    v_mfma_f32_32x32x16_bf16 v[48:63], v[92:95], v[84:87], v[48:63]
    s_waitcnt vmcnt(0)
    s_barrier
    s_add_u32 m0, s36, 32768
    s_nop 0
    buffer_load_dwordx4 v96, s[8:11], s38 offen lds
    s_add_u32 m0, s36, 33792
    s_nop 0
    buffer_load_dwordx4 v97, s[8:11], s38 offen lds
    s_add_u32 m0, s36, 34816
    s_nop 0
    buffer_load_dwordx4 v98, s[8:11], s38 offen lds
    s_add_u32 m0, s36, 35840
    s_nop 0
    buffer_load_dwordx4 v99, s[8:11], s38 offen lds
    s_add_u32 m0, s37, 32768
    s_nop 0
    buffer_load_dwordx4 v100, s[12:15], s39 offen lds
    s_add_u32 m0, s37, 33792
    s_nop 0
    buffer_load_dwordx4 v101, s[12:15], s39 offen lds
    s_add_u32 m0, s37, 34816
    s_nop 0
    buffer_load_dwordx4 v102, s[12:15], s39 offen lds
    s_add_u32 m0, s37, 35840
    s_nop 0
    buffer_load_dwordx4 v103, s[12:15], s39 offen lds
    s_add_u32 s38, s38, 128
    s_add_u32 s39, s39, 65536
    ds_read_b128 v[64:67], v104 offset:0
    ds_read_b128 v[68:71], v104 offset:4096
    ds_read_b64_tr_b16 v[72:73], v108 offset:16384
    ds_read_b64_tr_b16 v[74:75], v108 offset:17408
    ds_read_b64_tr_b16 v[76:77], v109 offset:16384
    ds_read_b64_tr_b16 v[78:79], v109 offset:17408
    ds_read_b128 v[80:83], v105 offset:0
    ds_read_b128 v[84:87], v105 offset:4096
    ds_read_b64_tr_b16 v[88:89], v108 offset:20480
    ds_read_b64_tr_b16 v[90:91], v108 offset:21504
    ds_read_b64_tr_b16 v[92:93], v109 offset:20480
    ds_read_b64_tr_b16 v[94:95], v109 offset:21504
    s_waitcnt lgkmcnt(6)
    v_mfma_f32_32x32x16_bf16 v[0:15], v[72:75], v[64:67], v[0:15]
    v_mfma_f32_32x32x16_bf16 v[16:31], v[76:79], v[64:67], v[16:31]
    v_mfma_f32_32x32x16_bf16 v[32:47], v[72:75], v[68:71], v[32:47]
    v_mfma_f32_32x32x16_bf16 v[48:63], v[76:79], v[68:71], v[48:63]
    ds_read_b128 v[64:67], v106 offset:0
    ds_read_b128 v[68:71], v106 offset:4096
    ds_read_b64_tr_b16 v[72:73], v108 offset:24576
    ds_read_b64_tr_b16 v[74:75], v108 offset:25600
    ds_read_b64_tr_b16 v[76:77], v109 offset:24576
    ds_read_b64_tr_b16 v[78:79], v109 offset:25600
    s_waitcnt lgkmcnt(6)
    v_mfma_f32_32x32x16_bf16 v[0:15], v[88:91], v[80:83], v[0:15]
    v_mfma_f32_32x32x16_bf16 v[16:31], v[92:95], v[80:83], v[16:31]
    v_mfma_f32_32x32x16_bf16 v[32:47], v[88:91], v[84:87], v[32:47]
    v_mfma_f32_32x32x16_bf16 v[48:63], v[92:95], v[84:87], v[48:63]
    ds_read_b128 v[80:83], v107 offset:0
    ds_read_b128 v[84:87], v107 offset:4096
    ds_read_b64_tr_b16 v[88:89], v108 offset:28672
    ds_read_b64_tr_b16 v[90:91], v108 offset:29696
    ds_read_b64_tr_b16 v[92:93], v109 offset:28672
    ds_read_b64_tr_b16 v[94:95], v109 offset:29696
    s_waitcnt lgkmcnt(6)
    v_mfma_f32_32x32x16_bf16 v[0:15], v[72:75], v[64:67], v[0:15]
    v_mfma_f32_32x32x16_bf16 v[16:31], v[76:79], v[64:67], v[16:31]
    v_mfma_f32_32x32x16_bf16 v[32:47], v[72:75], v[68:71], v[32:47]
    v_mfma_f32_32x32x16_bf16 v[48:63], v[76:79], v[68:71], v[48:63]
    s_waitcnt lgkmcnt(0)
    v_mfma_f32_32x32x16_bf16 v[0:15], v[88:91], v[80:83], v[0:15]
    v_mfma_f32_32x32x16_bf16 v[16:31], v[92:95], v[80:83], v[16:31]
    v_mfma_f32_32x32x16_bf16 v[32:47], v[88:91], v[84:87], v[32:47]
    v_mfma_f32_32x32x16_bf16 v[48:63], v[92:95], v[84:87], v[48:63]
    s_waitcnt vmcnt(0)
    s_barrier
    s_add_u32 m0, s36, 0
    s_nop 0
    buffer_load_dwordx4 v96, s[8:11], s38 offen lds
    s_add_u32 m0, s36, 1024
    s_nop 0
    buffer_load_dwordx4 v97, s[8:11], s38 offen lds
    s_add_u32 m0, s36, 2048
    s_nop 0
    buffer_load_dwordx4 v98, s[8:11], s38 offen lds
    s_add_u32 m0, s36, 3072
    s_nop 0
    buffer_load_dwordx4 v99, s[8:11], s38 offen lds
    s_add_u32 m0, s37, 0
    s_nop 0
    buffer_load_dwordx4 v100, s[12:15], s39 offen lds
    s_add_u32 m0, s37, 1024
    s_nop 0
    buffer_load_dwordx4 v101, s[12:15], s39 offen lds
    s_add_u32 m0, s37, 2048
    s_nop 0
    buffer_load_dwordx4 v102, s[12:15], s39 offen lds
    s_add_u32 m0, s37, 3072
    s_nop 0
    buffer_load_dwordx4 v103, s[12:15], s39 offen lds
    s_add_u32 s38, s38, 128
    s_add_u32 s39, s39, 65536
    ds_read_b128 v[64:67], v104 offset:32768
    ds_read_b128 v[68:71], v104 offset:36864
    ds_read_b64_tr_b16 v[72:73], v108 offset:49152
    ds_read_b64_tr_b16 v[74:75], v108 offset:50176
    ds_read_b64_tr_b16 v[76:77], v109 offset:49152
    ds_read_b64_tr_b16 v[78:79], v109 offset:50176
    ds_read_b128 v[80:83], v105 offset:32768
    ds_read_b128 v[84:87], v105 offset:36864
    ds_read_b64_tr_b16 v[88:89], v108 offset:53248
    ds_read_b64_tr_b16 v[90:91], v108 offset:54272
    ds_read_b64_tr_b16 v[92:93], v109 offset:53248
    ds_read_b64_tr_b16 v[94:95], v109 offset:54272
    s_waitcnt lgkmcnt(6)
    v_mfma_f32_32x32x16_bf16 v[0:15], v[72:75], v[64:67], v[0:15]
    v_mfma_f32_32x32x16_bf16 v[16:31], v[76:79], v[64:67], v[16:31]
    v_mfma_f32_32x32x16_bf16 v[32:47], v[72:75], v[68:71], v[32:47]
    v_mfma_f32_32x32x16_bf16 v[48:63], v[76:79], v[68:71], v[48:63]
    ds_read_b128 v[64:67], v106 offset:32768
    ds_read_b128 v[68:71], v106 offset:36864
    ds_read_b64_tr_b16 v[72:73], v108 offset:57344
    ds_read_b64_tr_b16 v[74:75], v108 offset:58368
    ds_read_b64_tr_b16 v[76:77], v109 offset:57344
    ds_read_b64_tr_b16 v[78:79], v109 offset:58368
    s_waitcnt lgkmcnt(6)
    v_mfma_f32_32x32x16_bf16 v[0:15], v[88:91], v[80:83], v[0:15]
    v_mfma_f32_32x32x16_bf16 v[16:31], v[92:95], v[80:83], v[16:31]
    v_mfma_f32_32x32x16_bf16 v[32:47], v[88:91], v[84:87], v[32:47]
    v_mfma_f32_32x32x16_bf16 v[48:63], v[92:95], v[84:87], v[48:63]
    ds_read_b128 v[80:83], v107 offset:32768
    ds_read_b128 v[84:87], v107 offset:36864
    ds_read_b64_tr_b16 v[88:89], v108 offset:61440
    ds_read_b64_tr_b16 v[90:91], v108 offset:62464
    ds_read_b64_tr_b16 v[92:93], v109 offset:61440
    ds_read_b64_tr_b16 v[94:95], v109 offset:62464
    s_waitcnt lgkmcnt(6)
    v_mfma_f32_32x32x16_bf16 v[0:15], v[72:75], v[64:67], v[0:15]
    v_mfma_f32_32x32x16_bf16 v[16:31], v[76:79], v[64:67], v[16:31]
    v_mfma_f32_32x32x16_bf16 v[32:47], v[72:75], v[68:71], v[32:47]
    v_mfma_f32_32x32x16_bf16 v[48:63], v[76:79], v[68:71], v[48:63]
    s_waitcnt lgkmcnt(0)
    v_mfma_f32_32x32x16_bf16 v[0:15], v[88:91], v[80:83], v[0:15]
    v_mfma_f32_32x32x16_bf16 v[16:31], v[92:95], v[80:83], v[16:31]
    v_mfma_f32_32x32x16_bf16 v[32:47], v[88:91], v[84:87], v[32:47]
    v_mfma_f32_32x32x16_bf16 v[48:63], v[92:95], v[84:87], v[48:63]
    s_waitcnt vmcnt(0)
    s_barrier
    s_add_u32 m0, s36, 32768
    s_nop 0
    buffer_load_dwordx4 v96, s[8:11], s38 offen lds
    s_add_u32 m0, s36, 33792
    s_nop 0
    buffer_load_dwordx4 v97, s[8:11], s38 offen lds
    s_add_u32 m0, s36, 34816
    s_nop 0
    buffer_load_dwordx4 v98, s[8:11], s38 offen lds
    s_add_u32 m0, s36, 35840
    s_nop 0
    buffer_load_dwordx4 v99, s[8:11], s38 offen lds
    s_add_u32 m0, s37, 32768
    s_nop 0
    buffer_load_dwordx4 v100, s[12:15], s39 offen lds
    s_add_u32 m0, s37, 33792
    s_nop 0
    buffer_load_dwordx4 v101, s[12:15], s39 offen lds
    s_add_u32 m0, s37, 34816
    s_nop 0
    buffer_load_dwordx4 v102, s[12:15], s39 offen lds
    s_add_u32 m0, s37, 35840
    s_nop 0
    buffer_load_dwordx4 v103, s[12:15], s39 offen lds
    s_add_u32 s38, s38, 128
    s_add_u32 s39, s39, 65536
    ds_read_b128 v[64:67], v104 offset:0
    ds_read_b128 v[68:71], v104 offset:4096
    ds_read_b64_tr_b16 v[72:73], v108 offset:16384
    ds_read_b64_tr_b16 v[74:75], v108 offset:17408
    ds_read_b64_tr_b16 v[76:77], v109 offset:16384
    ds_read_b64_tr_b16 v[78:79], v109 offset:17408
    ds_read_b128 v[80:83], v105 offset:0
    ds_read_b128 v[84:87], v105 offset:4096
    ds_read_b64_tr_b16 v[88:89], v108 offset:20480
    ds_read_b64_tr_b16 v[90:91], v108 offset:21504
    ds_read_b64_tr_b16 v[92:93], v109 offset:20480
    ds_read_b64_tr_b16 v[94:95], v109 offset:21504
    s_waitcnt lgkmcnt(6)
    v_mfma_f32_32x32x16_bf16 v[0:15], v[72:75], v[64:67], v[0:15]
    v_mfma_f32_32x32x16_bf16 v[16:31], v[76:79], v[64:67], v[16:31]
    v_mfma_f32_32x32x16_bf16 v[32:47], v[72:75], v[68:71], v[32:47]
    v_mfma_f32_32x32x16_bf16 v[48:63], v[76:79], v[68:71], v[48:63]
    ds_read_b128 v[64:67], v106 offset:0
    ds_read_b128 v[68:71], v106 offset:4096
    ds_read_b64_tr_b16 v[72:73], v108 offset:24576
    ds_read_b64_tr_b16 v[74:75], v108 offset:25600
    ds_read_b64_tr_b16 v[76:77], v109 offset:24576
    ds_read_b64_tr_b16 v[78:79], v109 offset:25600
    s_waitcnt lgkmcnt(6)
    v_mfma_f32_32x32x16_bf16 v[0:15], v[88:91], v[80:83], v[0:15]
    v_mfma_f32_32x32x16_bf16 v[16:31], v[92:95], v[80:83], v[16:31]
    v_mfma_f32_32x32x16_bf16 v[32:47], v[88:91], v[84:87], v[32:47]
    v_mfma_f32_32x32x16_bf16 v[48:63], v[92:95], v[84:87], v[48:63]
    ds_read_b128 v[80:83], v107 offset:0
    ds_read_b128 v[84:87], v107 offset:4096
    ds_read_b64_tr_b16 v[88:89], v108 offset:28672
    ds_read_b64_tr_b16 v[90:91], v108 offset:29696
    ds_read_b64_tr_b16 v[92:93], v109 offset:28672
    ds_read_b64_tr_b16 v[94:95], v109 offset:29696
    s_waitcnt lgkmcnt(6)
    v_mfma_f32_32x32x16_bf16 v[0:15], v[72:75], v[64:67], v[0:15]
    v_mfma_f32_32x32x16_bf16 v[16:31], v[76:79], v[64:67], v[16:31]
    v_mfma_f32_32x32x16_bf16 v[32:47], v[72:75], v[68:71], v[32:47]
    v_mfma_f32_32x32x16_bf16 v[48:63], v[76:79], v[68:71], v[48:63]
    s_waitcnt lgkmcnt(0)
    v_mfma_f32_32x32x16_bf16 v[0:15], v[88:91], v[80:83], v[0:15]
    v_mfma_f32_32x32x16_bf16 v[16:31], v[92:95], v[80:83], v[16:31]
    v_mfma_f32_32x32x16_bf16 v[32:47], v[88:91], v[84:87], v[32:47]
    v_mfma_f32_32x32x16_bf16 v[48:63], v[92:95], v[84:87], v[48:63]
    s_waitcnt vmcnt(0)
    s_barrier
    s_add_u32 m0, s36, 0
    s_nop 0
    buffer_load_dwordx4 v96, s[8:11], s38 offen lds
    s_add_u32 m0, s36, 1024
    s_nop 0
    buffer_load_dwordx4 v97, s[8:11], s38 offen lds
    s_add_u32 m0, s36, 2048
    s_nop 0
    buffer_load_dwordx4 v98, s[8:11], s38 offen lds
    s_add_u32 m0, s36, 3072
    s_nop 0
    buffer_load_dwordx4 v99, s[8:11], s38 offen lds
    s_add_u32 m0, s37, 0
    s_nop 0
    buffer_load_dwordx4 v100, s[12:15], s39 offen lds
    s_add_u32 m0, s37, 1024
    s_nop 0
    buffer_load_dwordx4 v101, s[12:15], s39 offen lds
    s_add_u32 m0, s37, 2048
    s_nop 0
    buffer_load_dwordx4 v102, s[12:15], s39 offen lds
    s_add_u32 m0, s37, 3072
    s_nop 0
    buffer_load_dwordx4 v103, s[12:15], s39 offen lds
    s_add_u32 s38, s38, 128
    s_add_u32 s39, s39, 65536
    ds_read_b128 v[64:67], v104 offset:32768
    ds_read_b128 v[68:71], v104 offset:36864
    ds_read_b64_tr_b16 v[72:73], v108 offset:49152
    ds_read_b64_tr_b16 v[74:75], v108 offset:50176
    ds_read_b64_tr_b16 v[76:77], v109 offset:49152
    ds_read_b64_tr_b16 v[78:79], v109 offset:50176
    ds_read_b128 v[80:83], v105 offset:32768
    ds_read_b128 v[84:87], v105 offset:36864
    ds_read_b64_tr_b16 v[88:89], v108 offset:53248
    ds_read_b64_tr_b16 v[90:91], v108 offset:54272
    ds_read_b64_tr_b16 v[92:93], v109 offset:53248
    ds_read_b64_tr_b16 v[94:95], v109 offset:54272
    s_waitcnt lgkmcnt(6)
    v_mfma_f32_32x32x16_bf16 v[0:15], v[72:75], v[64:67], v[0:15]
    v_mfma_f32_32x32x16_bf16 v[16:31], v[76:79], v[64:67], v[16:31]
    v_mfma_f32_32x32x16_bf16 v[32:47], v[72:75], v[68:71], v[32:47]
    v_mfma_f32_32x32x16_bf16 v[48:63], v[76:79], v[68:71], v[48:63]
    ds_read_b128 v[64:67], v106 offset:32768
    ds_read_b128 v[68:71], v106 offset:36864
    ds_read_b64_tr_b16 v[72:73], v108 offset:57344
    ds_read_b64_tr_b16 v[74:75], v108 offset:58368
    ds_read_b64_tr_b16 v[76:77], v109 offset:57344
    ds_read_b64_tr_b16 v[78:79], v109 offset:58368
    s_waitcnt lgkmcnt(6)
    v_mfma_f32_32x32x16_bf16 v[0:15], v[88:91], v[80:83], v[0:15]
    v_mfma_f32_32x32x16_bf16 v[16:31], v[92:95], v[80:83], v[16:31]
    v_mfma_f32_32x32x16_bf16 v[32:47], v[88:91], v[84:87], v[32:47]
    v_mfma_f32_32x32x16_bf16 v[48:63], v[92:95], v[84:87], v[48:63]
    ds_read_b128 v[80:83], v107 offset:32768
    ds_read_b128 v[84:87], v107 offset:36864
    ds_read_b64_tr_b16 v[88:89], v108 offset:61440
    ds_read_b64_tr_b16 v[90:91], v108 offset:62464
    ds_read_b64_tr_b16 v[92:93], v109 offset:61440
    ds_read_b64_tr_b16 v[94:95], v109 offset:62464
    s_waitcnt lgkmcnt(6)
    v_mfma_f32_32x32x16_bf16 v[0:15], v[72:75], v[64:67], v[0:15]
    v_mfma_f32_32x32x16_bf16 v[16:31], v[76:79], v[64:67], v[16:31]
    v_mfma_f32_32x32x16_bf16 v[32:47], v[72:75], v[68:71], v[32:47]
    v_mfma_f32_32x32x16_bf16 v[48:63], v[76:79], v[68:71], v[48:63]
    s_waitcnt lgkmcnt(0)
    v_mfma_f32_32x32x16_bf16 v[0:15], v[88:91], v[80:83], v[0:15]
    v_mfma_f32_32x32x16_bf16 v[16:31], v[92:95], v[80:83], v[16:31]
    v_mfma_f32_32x32x16_bf16 v[32:47], v[88:91], v[84:87], v[32:47]
    v_mfma_f32_32x32x16_bf16 v[48:63], v[92:95], v[84:87], v[48:63]
    s_waitcnt vmcnt(0)
    s_barrier
    s_add_u32 m0, s36, 32768
    s_nop 0
    buffer_load_dwordx4 v96, s[8:11], s38 offen lds
    s_add_u32 m0, s36, 33792
    s_nop 0
    buffer_load_dwordx4 v97, s[8:11], s38 offen lds
    s_add_u32 m0, s36, 34816
    s_nop 0
    buffer_load_dwordx4 v98, s[8:11], s38 offen lds
    s_add_u32 m0, s36, 35840
    s_nop 0
    buffer_load_dwordx4 v99, s[8:11], s38 offen lds
    s_add_u32 m0, s37, 32768
    s_nop 0
    buffer_load_dwordx4 v100, s[12:15], s39 offen lds
    s_add_u32 m0, s37, 33792
    s_nop 0
    buffer_load_dwordx4 v101, s[12:15], s39 offen lds
    s_add_u32 m0, s37, 34816
    s_nop 0
    buffer_load_dwordx4 v102, s[12:15], s39 offen lds
    s_add_u32 m0, s37, 35840
    s_nop 0
    buffer_load_dwordx4 v103, s[12:15], s39 offen lds
    s_add_u32 s38, s38, 128
    s_add_u32 s39, s39, 65536
    ds_read_b128 v[64:67], v104 offset:0
    ds_read_b128 v[68:71], v104 offset:4096
    ds_read_b64_tr_b16 v[72:73], v108 offset:16384
    ds_read_b64_tr_b16 v[74:75], v108 offset:17408
    ds_read_b64_tr_b16 v[76:77], v109 offset:16384
    ds_read_b64_tr_b16 v[78:79], v109 offset:17408
    ds_read_b128 v[80:83], v105 offset:0
    ds_read_b128 v[84:87], v105 offset:4096
    ds_read_b64_tr_b16 v[88:89], v108 offset:20480
    ds_read_b64_tr_b16 v[90:91], v108 offset:21504
    ds_read_b64_tr_b16 v[92:93], v109 offset:20480
    ds_read_b64_tr_b16 v[94:95], v109 offset:21504
    s_waitcnt lgkmcnt(6)
    v_mfma_f32_32x32x16_bf16 v[0:15], v[72:75], v[64:67], v[0:15]
    v_mfma_f32_32x32x16_bf16 v[16:31], v[76:79], v[64:67], v[16:31]
    v_mfma_f32_32x32x16_bf16 v[32:47], v[72:75], v[68:71], v[32:47]
    v_mfma_f32_32x32x16_bf16 v[48:63], v[76:79], v[68:71], v[48:63]
    ds_read_b128 v[64:67], v106 offset:0
    ds_read_b128 v[68:71], v106 offset:4096
    ds_read_b64_tr_b16 v[72:73], v108 offset:24576
    ds_read_b64_tr_b16 v[74:75], v108 offset:25600
    ds_read_b64_tr_b16 v[76:77], v109 offset:24576
    ds_read_b64_tr_b16 v[78:79], v109 offset:25600
    s_waitcnt lgkmcnt(6)
    v_mfma_f32_32x32x16_bf16 v[0:15], v[88:91], v[80:83], v[0:15]
    v_mfma_f32_32x32x16_bf16 v[16:31], v[92:95], v[80:83], v[16:31]
    v_mfma_f32_32x32x16_bf16 v[32:47], v[88:91], v[84:87], v[32:47]
    v_mfma_f32_32x32x16_bf16 v[48:63], v[92:95], v[84:87], v[48:63]
    ds_read_b128 v[80:83], v107 offset:0
    ds_read_b128 v[84:87], v107 offset:4096
    ds_read_b64_tr_b16 v[88:89], v108 offset:28672
    ds_read_b64_tr_b16 v[90:91], v108 offset:29696
    ds_read_b64_tr_b16 v[92:93], v109 offset:28672
    ds_read_b64_tr_b16 v[94:95], v109 offset:29696
    s_waitcnt lgkmcnt(6)
    v_mfma_f32_32x32x16_bf16 v[0:15], v[72:75], v[64:67], v[0:15]
    v_mfma_f32_32x32x16_bf16 v[16:31], v[76:79], v[64:67], v[16:31]
    v_mfma_f32_32x32x16_bf16 v[32:47], v[72:75], v[68:71], v[32:47]
    v_mfma_f32_32x32x16_bf16 v[48:63], v[76:79], v[68:71], v[48:63]
    s_waitcnt lgkmcnt(0)
    v_mfma_f32_32x32x16_bf16 v[0:15], v[88:91], v[80:83], v[0:15]
    v_mfma_f32_32x32x16_bf16 v[16:31], v[92:95], v[80:83], v[16:31]
    v_mfma_f32_32x32x16_bf16 v[32:47], v[88:91], v[84:87], v[32:47]
    v_mfma_f32_32x32x16_bf16 v[48:63], v[92:95], v[84:87], v[48:63]
    s_waitcnt vmcnt(0)
    s_barrier
    s_add_u32 m0, s36, 0
    s_nop 0
    buffer_load_dwordx4 v96, s[8:11], s38 offen lds
    s_add_u32 m0, s36, 1024
    s_nop 0
    buffer_load_dwordx4 v97, s[8:11], s38 offen lds
    s_add_u32 m0, s36, 2048
    s_nop 0
    buffer_load_dwordx4 v98, s[8:11], s38 offen lds
    s_add_u32 m0, s36, 3072
    s_nop 0
    buffer_load_dwordx4 v99, s[8:11], s38 offen lds
    s_add_u32 m0, s37, 0
    s_nop 0
    buffer_load_dwordx4 v100, s[12:15], s39 offen lds
    s_add_u32 m0, s37, 1024
    s_nop 0
    buffer_load_dwordx4 v101, s[12:15], s39 offen lds
    s_add_u32 m0, s37, 2048
    s_nop 0
    buffer_load_dwordx4 v102, s[12:15], s39 offen lds
    s_add_u32 m0, s37, 3072
    s_nop 0
    buffer_load_dwordx4 v103, s[12:15], s39 offen lds
    s_add_u32 s38, s38, 128
    s_add_u32 s39, s39, 65536
    ds_read_b128 v[64:67], v104 offset:32768
    ds_read_b128 v[68:71], v104 offset:36864
    ds_read_b64_tr_b16 v[72:73], v108 offset:49152
    ds_read_b64_tr_b16 v[74:75], v108 offset:50176
    ds_read_b64_tr_b16 v[76:77], v109 offset:49152
    ds_read_b64_tr_b16 v[78:79], v109 offset:50176
    ds_read_b128 v[80:83], v105 offset:32768
    ds_read_b128 v[84:87], v105 offset:36864
    ds_read_b64_tr_b16 v[88:89], v108 offset:53248
    ds_read_b64_tr_b16 v[90:91], v108 offset:54272
    ds_read_b64_tr_b16 v[92:93], v109 offset:53248
    ds_read_b64_tr_b16 v[94:95], v109 offset:54272
    s_waitcnt lgkmcnt(6)
    v_mfma_f32_32x32x16_bf16 v[0:15], v[72:75], v[64:67], v[0:15]
    v_mfma_f32_32x32x16_bf16 v[16:31], v[76:79], v[64:67], v[16:31]
    v_mfma_f32_32x32x16_bf16 v[32:47], v[72:75], v[68:71], v[32:47]
    v_mfma_f32_32x32x16_bf16 v[48:63], v[76:79], v[68:71], v[48:63]
    ds_read_b128 v[64:67], v106 offset:32768
    ds_read_b128 v[68:71], v106 offset:36864
    ds_read_b64_tr_b16 v[72:73], v108 offset:57344
    ds_read_b64_tr_b16 v[74:75], v108 offset:58368
    ds_read_b64_tr_b16 v[76:77], v109 offset:57344
    ds_read_b64_tr_b16 v[78:79], v109 offset:58368
    s_waitcnt lgkmcnt(6)
    v_mfma_f32_32x32x16_bf16 v[0:15], v[88:91], v[80:83], v[0:15]
    v_mfma_f32_32x32x16_bf16 v[16:31], v[92:95], v[80:83], v[16:31]
    v_mfma_f32_32x32x16_bf16 v[32:47], v[88:91], v[84:87], v[32:47]
    v_mfma_f32_32x32x16_bf16 v[48:63], v[92:95], v[84:87], v[48:63]
    ds_read_b128 v[80:83], v107 offset:32768
    ds_read_b128 v[84:87], v107 offset:36864
    ds_read_b64_tr_b16 v[88:89], v108 offset:61440
    ds_read_b64_tr_b16 v[90:91], v108 offset:62464
    ds_read_b64_tr_b16 v[92:93], v109 offset:61440
    ds_read_b64_tr_b16 v[94:95], v109 offset:62464
    s_waitcnt lgkmcnt(6)
    v_mfma_f32_32x32x16_bf16 v[0:15], v[72:75], v[64:67], v[0:15]
    v_mfma_f32_32x32x16_bf16 v[16:31], v[76:79], v[64:67], v[16:31]
    v_mfma_f32_32x32x16_bf16 v[32:47], v[72:75], v[68:71], v[32:47]
    v_mfma_f32_32x32x16_bf16 v[48:63], v[76:79], v[68:71], v[48:63]
    s_waitcnt lgkmcnt(0)
    v_mfma_f32_32x32x16_bf16 v[0:15], v[88:91], v[80:83], v[0:15]
    v_mfma_f32_32x32x16_bf16 v[16:31], v[92:95], v[80:83], v[16:31]
    v_mfma_f32_32x32x16_bf16 v[32:47], v[88:91], v[84:87], v[32:47]
    v_mfma_f32_32x32x16_bf16 v[48:63], v[92:95], v[84:87], v[48:63]
    s_waitcnt vmcnt(0)
    s_barrier
    s_add_u32 m0, s36, 32768
    s_nop 0
    buffer_load_dwordx4 v96, s[8:11], s38 offen lds
    s_add_u32 m0, s36, 33792
    s_nop 0
    buffer_load_dwordx4 v97, s[8:11], s38 offen lds
    s_add_u32 m0, s36, 34816
    s_nop 0
    buffer_load_dwordx4 v98, s[8:11], s38 offen lds
    s_add_u32 m0, s36, 35840
    s_nop 0
    buffer_load_dwordx4 v99, s[8:11], s38 offen lds
    s_add_u32 m0, s37, 32768
    s_nop 0
    buffer_load_dwordx4 v100, s[12:15], s39 offen lds
    s_add_u32 m0, s37, 33792
    s_nop 0
    buffer_load_dwordx4 v101, s[12:15], s39 offen lds
    s_add_u32 m0, s37, 34816
    s_nop 0
    buffer_load_dwordx4 v102, s[12:15], s39 offen lds
    s_add_u32 m0, s37, 35840
    s_nop 0
    buffer_load_dwordx4 v103, s[12:15], s39 offen lds
    s_add_u32 s38, s38, 128
    s_add_u32 s39, s39, 65536
    ds_read_b128 v[64:67], v104 offset:0
    ds_read_b128 v[68:71], v104 offset:4096
    ds_read_b64_tr_b16 v[72:73], v108 offset:16384
    ds_read_b64_tr_b16 v[74:75], v108 offset:17408
    ds_read_b64_tr_b16 v[76:77], v109 offset:16384
    ds_read_b64_tr_b16 v[78:79], v109 offset:17408
    ds_read_b128 v[80:83], v105 offset:0
    ds_read_b128 v[84:87], v105 offset:4096
    ds_read_b64_tr_b16 v[88:89], v108 offset:20480
    ds_read_b64_tr_b16 v[90:91], v108 offset:21504
    ds_read_b64_tr_b16 v[92:93], v109 offset:20480
    ds_read_b64_tr_b16 v[94:95], v109 offset:21504
    s_waitcnt lgkmcnt(6)
    v_mfma_f32_32x32x16_bf16 v[0:15], v[72:75], v[64:67], v[0:15]
    v_mfma_f32_32x32x16_bf16 v[16:31], v[76:79], v[64:67], v[16:31]
    v_mfma_f32_32x32x16_bf16 v[32:47], v[72:75], v[68:71], v[32:47]
    v_mfma_f32_32x32x16_bf16 v[48:63], v[76:79], v[68:71], v[48:63]
    ds_read_b128 v[64:67], v106 offset:0
    ds_read_b128 v[68:71], v106 offset:4096
    ds_read_b64_tr_b16 v[72:73], v108 offset:24576
    ds_read_b64_tr_b16 v[74:75], v108 offset:25600
    ds_read_b64_tr_b16 v[76:77], v109 offset:24576
    ds_read_b64_tr_b16 v[78:79], v109 offset:25600
    s_waitcnt lgkmcnt(6)
    v_mfma_f32_32x32x16_bf16 v[0:15], v[88:91], v[80:83], v[0:15]
    v_mfma_f32_32x32x16_bf16 v[16:31], v[92:95], v[80:83], v[16:31]
    v_mfma_f32_32x32x16_bf16 v[32:47], v[88:91], v[84:87], v[32:47]
    v_mfma_f32_32x32x16_bf16 v[48:63], v[92:95], v[84:87], v[48:63]
    ds_read_b128 v[80:83], v107 offset:0
    ds_read_b128 v[84:87], v107 offset:4096
    ds_read_b64_tr_b16 v[88:89], v108 offset:28672
    ds_read_b64_tr_b16 v[90:91], v108 offset:29696
    ds_read_b64_tr_b16 v[92:93], v109 offset:28672
    ds_read_b64_tr_b16 v[94:95], v109 offset:29696
    s_waitcnt lgkmcnt(6)
    v_mfma_f32_32x32x16_bf16 v[0:15], v[72:75], v[64:67], v[0:15]
    v_mfma_f32_32x32x16_bf16 v[16:31], v[76:79], v[64:67], v[16:31]
    v_mfma_f32_32x32x16_bf16 v[32:47], v[72:75], v[68:71], v[32:47]
    v_mfma_f32_32x32x16_bf16 v[48:63], v[76:79], v[68:71], v[48:63]
    s_waitcnt lgkmcnt(0)
    v_mfma_f32_32x32x16_bf16 v[0:15], v[88:91], v[80:83], v[0:15]
    v_mfma_f32_32x32x16_bf16 v[16:31], v[92:95], v[80:83], v[16:31]
    v_mfma_f32_32x32x16_bf16 v[32:47], v[88:91], v[84:87], v[32:47]
    v_mfma_f32_32x32x16_bf16 v[48:63], v[92:95], v[84:87], v[48:63]
    s_waitcnt vmcnt(0)
    s_barrier
    s_add_u32 m0, s36, 0
    s_nop 0
    buffer_load_dwordx4 v96, s[8:11], s38 offen lds
    s_add_u32 m0, s36, 1024
    s_nop 0
    buffer_load_dwordx4 v97, s[8:11], s38 offen lds
    s_add_u32 m0, s36, 2048
    s_nop 0
    buffer_load_dwordx4 v98, s[8:11], s38 offen lds
    s_add_u32 m0, s36, 3072
    s_nop 0
    buffer_load_dwordx4 v99, s[8:11], s38 offen lds
    s_add_u32 m0, s37, 0
    s_nop 0
    buffer_load_dwordx4 v100, s[12:15], s39 offen lds
    s_add_u32 m0, s37, 1024
    s_nop 0
    buffer_load_dwordx4 v101, s[12:15], s39 offen lds
    s_add_u32 m0, s37, 2048
    s_nop 0
    buffer_load_dwordx4 v102, s[12:15], s39 offen lds
    s_add_u32 m0, s37, 3072
    s_nop 0
    buffer_load_dwordx4 v103, s[12:15], s39 offen lds
    s_add_u32 s38, s38, 128
    s_add_u32 s39, s39, 65536
    ds_read_b128 v[64:67], v104 offset:32768
    ds_read_b128 v[68:71], v104 offset:36864
    ds_read_b64_tr_b16 v[72:73], v108 offset:49152
    ds_read_b64_tr_b16 v[74:75], v108 offset:50176
    ds_read_b64_tr_b16 v[76:77], v109 offset:49152
    ds_read_b64_tr_b16 v[78:79], v109 offset:50176
    ds_read_b128 v[80:83], v105 offset:32768
    ds_read_b128 v[84:87], v105 offset:36864
    ds_read_b64_tr_b16 v[88:89], v108 offset:53248
    ds_read_b64_tr_b16 v[90:91], v108 offset:54272
    ds_read_b64_tr_b16 v[92:93], v109 offset:53248
    ds_read_b64_tr_b16 v[94:95], v109 offset:54272
    s_waitcnt lgkmcnt(6)
    v_mfma_f32_32x32x16_bf16 v[0:15], v[72:75], v[64:67], v[0:15]
    v_mfma_f32_32x32x16_bf16 v[16:31], v[76:79], v[64:67], v[16:31]
    v_mfma_f32_32x32x16_bf16 v[32:47], v[72:75], v[68:71], v[32:47]
    v_mfma_f32_32x32x16_bf16 v[48:63], v[76:79], v[68:71], v[48:63]
    ds_read_b128 v[64:67], v106 offset:32768
    ds_read_b128 v[68:71], v106 offset:36864
    ds_read_b64_tr_b16 v[72:73], v108 offset:57344
    ds_read_b64_tr_b16 v[74:75], v108 offset:58368
    ds_read_b64_tr_b16 v[76:77], v109 offset:57344
    ds_read_b64_tr_b16 v[78:79], v109 offset:58368
    s_waitcnt lgkmcnt(6)
    v_mfma_f32_32x32x16_bf16 v[0:15], v[88:91], v[80:83], v[0:15]
    v_mfma_f32_32x32x16_bf16 v[16:31], v[92:95], v[80:83], v[16:31]
    v_mfma_f32_32x32x16_bf16 v[32:47], v[88:91], v[84:87], v[32:47]
    v_mfma_f32_32x32x16_bf16 v[48:63], v[92:95], v[84:87], v[48:63]
    ds_read_b128 v[80:83], v107 offset:32768
    ds_read_b128 v[84:87], v107 offset:36864
    ds_read_b64_tr_b16 v[88:89], v108 offset:61440
    ds_read_b64_tr_b16 v[90:91], v108 offset:62464
    ds_read_b64_tr_b16 v[92:93], v109 offset:61440
    ds_read_b64_tr_b16 v[94:95], v109 offset:62464
    s_waitcnt lgkmcnt(6)
    v_mfma_f32_32x32x16_bf16 v[0:15], v[72:75], v[64:67], v[0:15]
    v_mfma_f32_32x32x16_bf16 v[16:31], v[76:79], v[64:67], v[16:31]
    v_mfma_f32_32x32x16_bf16 v[32:47], v[72:75], v[68:71], v[32:47]
    v_mfma_f32_32x32x16_bf16 v[48:63], v[76:79], v[68:71], v[48:63]
    s_waitcnt lgkmcnt(0)
    v_mfma_f32_32x32x16_bf16 v[0:15], v[88:91], v[80:83], v[0:15]
    v_mfma_f32_32x32x16_bf16 v[16:31], v[92:95], v[80:83], v[16:31]
    v_mfma_f32_32x32x16_bf16 v[32:47], v[88:91], v[84:87], v[32:47]
    v_mfma_f32_32x32x16_bf16 v[48:63], v[92:95], v[84:87], v[48:63]
    s_waitcnt vmcnt(0)
    s_barrier
    s_add_u32 m0, s36, 32768
    s_nop 0
    buffer_load_dwordx4 v96, s[8:11], s38 offen lds
    s_add_u32 m0, s36, 33792
    s_nop 0
    buffer_load_dwordx4 v97, s[8:11], s38 offen lds
    s_add_u32 m0, s36, 34816
    s_nop 0
    buffer_load_dwordx4 v98, s[8:11], s38 offen lds
    s_add_u32 m0, s36, 35840
    s_nop 0
    buffer_load_dwordx4 v99, s[8:11], s38 offen lds
    s_add_u32 m0, s37, 32768
    s_nop 0
    buffer_load_dwordx4 v100, s[12:15], s39 offen lds
    s_add_u32 m0, s37, 33792
    s_nop 0
    buffer_load_dwordx4 v101, s[12:15], s39 offen lds
    s_add_u32 m0, s37, 34816
    s_nop 0
    buffer_load_dwordx4 v102, s[12:15], s39 offen lds
    s_add_u32 m0, s37, 35840
    s_nop 0
    buffer_load_dwordx4 v103, s[12:15], s39 offen lds
    s_add_u32 s38, s38, 128
    s_add_u32 s39, s39, 65536
    ds_read_b128 v[64:67], v104 offset:0
    ds_read_b128 v[68:71], v104 offset:4096
    ds_read_b64_tr_b16 v[72:73], v108 offset:16384
    ds_read_b64_tr_b16 v[74:75], v108 offset:17408
    ds_read_b64_tr_b16 v[76:77], v109 offset:16384
    ds_read_b64_tr_b16 v[78:79], v109 offset:17408
    ds_read_b128 v[80:83], v105 offset:0
    ds_read_b128 v[84:87], v105 offset:4096
    ds_read_b64_tr_b16 v[88:89], v108 offset:20480
    ds_read_b64_tr_b16 v[90:91], v108 offset:21504
    ds_read_b64_tr_b16 v[92:93], v109 offset:20480
    ds_read_b64_tr_b16 v[94:95], v109 offset:21504
    s_waitcnt lgkmcnt(6)
    v_mfma_f32_32x32x16_bf16 v[0:15], v[72:75], v[64:67], v[0:15]
    v_mfma_f32_32x32x16_bf16 v[16:31], v[76:79], v[64:67], v[16:31]
    v_mfma_f32_32x32x16_bf16 v[32:47], v[72:75], v[68:71], v[32:47]
    v_mfma_f32_32x32x16_bf16 v[48:63], v[76:79], v[68:71], v[48:63]
    ds_read_b128 v[64:67], v106 offset:0
    ds_read_b128 v[68:71], v106 offset:4096
    ds_read_b64_tr_b16 v[72:73], v108 offset:24576
    ds_read_b64_tr_b16 v[74:75], v108 offset:25600
    ds_read_b64_tr_b16 v[76:77], v109 offset:24576
    ds_read_b64_tr_b16 v[78:79], v109 offset:25600
    s_waitcnt lgkmcnt(6)
    v_mfma_f32_32x32x16_bf16 v[0:15], v[88:91], v[80:83], v[0:15]
    v_mfma_f32_32x32x16_bf16 v[16:31], v[92:95], v[80:83], v[16:31]
    v_mfma_f32_32x32x16_bf16 v[32:47], v[88:91], v[84:87], v[32:47]
    v_mfma_f32_32x32x16_bf16 v[48:63], v[92:95], v[84:87], v[48:63]
    ds_read_b128 v[80:83], v107 offset:0
    ds_read_b128 v[84:87], v107 offset:4096
    ds_read_b64_tr_b16 v[88:89], v108 offset:28672
    ds_read_b64_tr_b16 v[90:91], v108 offset:29696
    ds_read_b64_tr_b16 v[92:93], v109 offset:28672
    ds_read_b64_tr_b16 v[94:95], v109 offset:29696
    s_waitcnt lgkmcnt(6)
    v_mfma_f32_32x32x16_bf16 v[0:15], v[72:75], v[64:67], v[0:15]
    v_mfma_f32_32x32x16_bf16 v[16:31], v[76:79], v[64:67], v[16:31]
    v_mfma_f32_32x32x16_bf16 v[32:47], v[72:75], v[68:71], v[32:47]
    v_mfma_f32_32x32x16_bf16 v[48:63], v[76:79], v[68:71], v[48:63]
    s_waitcnt lgkmcnt(0)
    v_mfma_f32_32x32x16_bf16 v[0:15], v[88:91], v[80:83], v[0:15]
    v_mfma_f32_32x32x16_bf16 v[16:31], v[92:95], v[80:83], v[16:31]
    v_mfma_f32_32x32x16_bf16 v[32:47], v[88:91], v[84:87], v[32:47]
    v_mfma_f32_32x32x16_bf16 v[48:63], v[92:95], v[84:87], v[48:63]
    s_waitcnt vmcnt(0)
    s_barrier
    s_add_u32 m0, s36, 0
    s_nop 0
    buffer_load_dwordx4 v96, s[8:11], s38 offen lds
    s_add_u32 m0, s36, 1024
    s_nop 0
    buffer_load_dwordx4 v97, s[8:11], s38 offen lds
    s_add_u32 m0, s36, 2048
    s_nop 0
    buffer_load_dwordx4 v98, s[8:11], s38 offen lds
    s_add_u32 m0, s36, 3072
    s_nop 0
    buffer_load_dwordx4 v99, s[8:11], s38 offen lds
    s_add_u32 m0, s37, 0
    s_nop 0
    buffer_load_dwordx4 v100, s[12:15], s39 offen lds
    s_add_u32 m0, s37, 1024
    s_nop 0
    buffer_load_dwordx4 v101, s[12:15], s39 offen lds
    s_add_u32 m0, s37, 2048
    s_nop 0
    buffer_load_dwordx4 v102, s[12:15], s39 offen lds
    s_add_u32 m0, s37, 3072
    s_nop 0
    buffer_load_dwordx4 v103, s[12:15], s39 offen lds
    s_add_u32 s38, s38, 128
    s_add_u32 s39, s39, 65536
    ds_read_b128 v[64:67], v104 offset:32768
    ds_read_b128 v[68:71], v104 offset:36864
    ds_read_b64_tr_b16 v[72:73], v108 offset:49152
    ds_read_b64_tr_b16 v[74:75], v108 offset:50176
    ds_read_b64_tr_b16 v[76:77], v109 offset:49152
    ds_read_b64_tr_b16 v[78:79], v109 offset:50176
    ds_read_b128 v[80:83], v105 offset:32768
    ds_read_b128 v[84:87], v105 offset:36864
    ds_read_b64_tr_b16 v[88:89], v108 offset:53248
    ds_read_b64_tr_b16 v[90:91], v108 offset:54272
    ds_read_b64_tr_b16 v[92:93], v109 offset:53248
    ds_read_b64_tr_b16 v[94:95], v109 offset:54272
    s_waitcnt lgkmcnt(6)
    v_mfma_f32_32x32x16_bf16 v[0:15], v[72:75], v[64:67], v[0:15]
    v_mfma_f32_32x32x16_bf16 v[16:31], v[76:79], v[64:67], v[16:31]
    v_mfma_f32_32x32x16_bf16 v[32:47], v[72:75], v[68:71], v[32:47]
    v_mfma_f32_32x32x16_bf16 v[48:63], v[76:79], v[68:71], v[48:63]
    ds_read_b128 v[64:67], v106 offset:32768
    ds_read_b128 v[68:71], v106 offset:36864
    ds_read_b64_tr_b16 v[72:73], v108 offset:57344
    ds_read_b64_tr_b16 v[74:75], v108 offset:58368
    ds_read_b64_tr_b16 v[76:77], v109 offset:57344
    ds_read_b64_tr_b16 v[78:79], v109 offset:58368
    s_waitcnt lgkmcnt(6)
    v_mfma_f32_32x32x16_bf16 v[0:15], v[88:91], v[80:83], v[0:15]
    v_mfma_f32_32x32x16_bf16 v[16:31], v[92:95], v[80:83], v[16:31]
    v_mfma_f32_32x32x16_bf16 v[32:47], v[88:91], v[84:87], v[32:47]
    v_mfma_f32_32x32x16_bf16 v[48:63], v[92:95], v[84:87], v[48:63]
    ds_read_b128 v[80:83], v107 offset:32768
    ds_read_b128 v[84:87], v107 offset:36864
    ds_read_b64_tr_b16 v[88:89], v108 offset:61440
    ds_read_b64_tr_b16 v[90:91], v108 offset:62464
    ds_read_b64_tr_b16 v[92:93], v109 offset:61440
    ds_read_b64_tr_b16 v[94:95], v109 offset:62464
    s_waitcnt lgkmcnt(6)
    v_mfma_f32_32x32x16_bf16 v[0:15], v[72:75], v[64:67], v[0:15]
    v_mfma_f32_32x32x16_bf16 v[16:31], v[76:79], v[64:67], v[16:31]
    v_mfma_f32_32x32x16_bf16 v[32:47], v[72:75], v[68:71], v[32:47]
    v_mfma_f32_32x32x16_bf16 v[48:63], v[76:79], v[68:71], v[48:63]
    s_waitcnt lgkmcnt(0)
    v_mfma_f32_32x32x16_bf16 v[0:15], v[88:91], v[80:83], v[0:15]
    v_mfma_f32_32x32x16_bf16 v[16:31], v[92:95], v[80:83], v[16:31]
    v_mfma_f32_32x32x16_bf16 v[32:47], v[88:91], v[84:87], v[32:47]
    v_mfma_f32_32x32x16_bf16 v[48:63], v[92:95], v[84:87], v[48:63]
    s_waitcnt vmcnt(0)
    s_barrier
    s_add_u32 m0, s36, 32768
    s_nop 0
    buffer_load_dwordx4 v96, s[8:11], s38 offen lds
    s_add_u32 m0, s36, 33792
    s_nop 0
    buffer_load_dwordx4 v97, s[8:11], s38 offen lds
    s_add_u32 m0, s36, 34816
    s_nop 0
    buffer_load_dwordx4 v98, s[8:11], s38 offen lds
    s_add_u32 m0, s36, 35840
    s_nop 0
    buffer_load_dwordx4 v99, s[8:11], s38 offen lds
    s_add_u32 m0, s37, 32768
    s_nop 0
    buffer_load_dwordx4 v100, s[12:15], s39 offen lds
    s_add_u32 m0, s37, 33792
    s_nop 0
    buffer_load_dwordx4 v101, s[12:15], s39 offen lds
    s_add_u32 m0, s37, 34816
    s_nop 0
    buffer_load_dwordx4 v102, s[12:15], s39 offen lds
    s_add_u32 m0, s37, 35840
    s_nop 0
    buffer_load_dwordx4 v103, s[12:15], s39 offen lds
    s_add_u32 s38, s38, 128
    s_add_u32 s39, s39, 65536
    ds_read_b128 v[64:67], v104 offset:0
    ds_read_b128 v[68:71], v104 offset:4096
    ds_read_b64_tr_b16 v[72:73], v108 offset:16384
    ds_read_b64_tr_b16 v[74:75], v108 offset:17408
    ds_read_b64_tr_b16 v[76:77], v109 offset:16384
    ds_read_b64_tr_b16 v[78:79], v109 offset:17408
    ds_read_b128 v[80:83], v105 offset:0
    ds_read_b128 v[84:87], v105 offset:4096
    ds_read_b64_tr_b16 v[88:89], v108 offset:20480
    ds_read_b64_tr_b16 v[90:91], v108 offset:21504
    ds_read_b64_tr_b16 v[92:93], v109 offset:20480
    ds_read_b64_tr_b16 v[94:95], v109 offset:21504
    s_waitcnt lgkmcnt(6)
    v_mfma_f32_32x32x16_bf16 v[0:15], v[72:75], v[64:67], v[0:15]
    v_mfma_f32_32x32x16_bf16 v[16:31], v[76:79], v[64:67], v[16:31]
    v_mfma_f32_32x32x16_bf16 v[32:47], v[72:75], v[68:71], v[32:47]
    v_mfma_f32_32x32x16_bf16 v[48:63], v[76:79], v[68:71], v[48:63]
    ds_read_b128 v[64:67], v106 offset:0
    ds_read_b128 v[68:71], v106 offset:4096
    ds_read_b64_tr_b16 v[72:73], v108 offset:24576
    ds_read_b64_tr_b16 v[74:75], v108 offset:25600
    ds_read_b64_tr_b16 v[76:77], v109 offset:24576
    ds_read_b64_tr_b16 v[78:79], v109 offset:25600
    s_waitcnt lgkmcnt(6)
    v_mfma_f32_32x32x16_bf16 v[0:15], v[88:91], v[80:83], v[0:15]
    v_mfma_f32_32x32x16_bf16 v[16:31], v[92:95], v[80:83], v[16:31]
    v_mfma_f32_32x32x16_bf16 v[32:47], v[88:91], v[84:87], v[32:47]
    v_mfma_f32_32x32x16_bf16 v[48:63], v[92:95], v[84:87], v[48:63]
    ds_read_b128 v[80:83], v107 offset:0
    ds_read_b128 v[84:87], v107 offset:4096
    ds_read_b64_tr_b16 v[88:89], v108 offset:28672
    ds_read_b64_tr_b16 v[90:91], v108 offset:29696
    ds_read_b64_tr_b16 v[92:93], v109 offset:28672
    ds_read_b64_tr_b16 v[94:95], v109 offset:29696
    s_waitcnt lgkmcnt(6)
    v_mfma_f32_32x32x16_bf16 v[0:15], v[72:75], v[64:67], v[0:15]
    v_mfma_f32_32x32x16_bf16 v[16:31], v[76:79], v[64:67], v[16:31]
    v_mfma_f32_32x32x16_bf16 v[32:47], v[72:75], v[68:71], v[32:47]
    v_mfma_f32_32x32x16_bf16 v[48:63], v[76:79], v[68:71], v[48:63]
    s_waitcnt lgkmcnt(0)
    v_mfma_f32_32x32x16_bf16 v[0:15], v[88:91], v[80:83], v[0:15]
    v_mfma_f32_32x32x16_bf16 v[16:31], v[92:95], v[80:83], v[16:31]
    v_mfma_f32_32x32x16_bf16 v[32:47], v[88:91], v[84:87], v[32:47]
    v_mfma_f32_32x32x16_bf16 v[48:63], v[92:95], v[84:87], v[48:63]
    s_waitcnt vmcnt(0)
    s_barrier
    ds_read_b128 v[64:67], v104 offset:32768
    ds_read_b128 v[68:71], v104 offset:36864
    ds_read_b64_tr_b16 v[72:73], v108 offset:49152
    ds_read_b64_tr_b16 v[74:75], v108 offset:50176
    ds_read_b64_tr_b16 v[76:77], v109 offset:49152
    ds_read_b64_tr_b16 v[78:79], v109 offset:50176
    ds_read_b128 v[80:83], v105 offset:32768
    ds_read_b128 v[84:87], v105 offset:36864
    ds_read_b64_tr_b16 v[88:89], v108 offset:53248
    ds_read_b64_tr_b16 v[90:91], v108 offset:54272
    ds_read_b64_tr_b16 v[92:93], v109 offset:53248
    ds_read_b64_tr_b16 v[94:95], v109 offset:54272
    s_waitcnt lgkmcnt(6)
    v_mfma_f32_32x32x16_bf16 v[0:15], v[72:75], v[64:67], v[0:15]
    v_mfma_f32_32x32x16_bf16 v[16:31], v[76:79], v[64:67], v[16:31]
    v_mfma_f32_32x32x16_bf16 v[32:47], v[72:75], v[68:71], v[32:47]
    v_mfma_f32_32x32x16_bf16 v[48:63], v[76:79], v[68:71], v[48:63]
    ds_read_b128 v[64:67], v106 offset:32768
    ds_read_b128 v[68:71], v106 offset:36864
    ds_read_b64_tr_b16 v[72:73], v108 offset:57344
    ds_read_b64_tr_b16 v[74:75], v108 offset:58368
    ds_read_b64_tr_b16 v[76:77], v109 offset:57344
    ds_read_b64_tr_b16 v[78:79], v109 offset:58368
    s_waitcnt lgkmcnt(6)
    v_mfma_f32_32x32x16_bf16 v[0:15], v[88:91], v[80:83], v[0:15]
    v_mfma_f32_32x32x16_bf16 v[16:31], v[92:95], v[80:83], v[16:31]
    v_mfma_f32_32x32x16_bf16 v[32:47], v[88:91], v[84:87], v[32:47]
    v_mfma_f32_32x32x16_bf16 v[48:63], v[92:95], v[84:87], v[48:63]
    ds_read_b128 v[80:83], v107 offset:32768
    ds_read_b128 v[84:87], v107 offset:36864
    ds_read_b64_tr_b16 v[88:89], v108 offset:61440
    ds_read_b64_tr_b16 v[90:91], v108 offset:62464
    ds_read_b64_tr_b16 v[92:93], v109 offset:61440
    ds_read_b64_tr_b16 v[94:95], v109 offset:62464
    s_waitcnt lgkmcnt(6)
    v_mfma_f32_32x32x16_bf16 v[0:15], v[72:75], v[64:67], v[0:15]
    v_mfma_f32_32x32x16_bf16 v[16:31], v[76:79], v[64:67], v[16:31]
    v_mfma_f32_32x32x16_bf16 v[32:47], v[72:75], v[68:71], v[32:47]
    v_mfma_f32_32x32x16_bf16 v[48:63], v[76:79], v[68:71], v[48:63]
    s_waitcnt lgkmcnt(0)
    v_mfma_f32_32x32x16_bf16 v[0:15], v[88:91], v[80:83], v[0:15]
    v_mfma_f32_32x32x16_bf16 v[16:31], v[92:95], v[80:83], v[16:31]
    v_mfma_f32_32x32x16_bf16 v[32:47], v[88:91], v[84:87], v[32:47]
    v_mfma_f32_32x32x16_bf16 v[48:63], v[92:95], v[84:87], v[48:63]
    s_nop 15
    s_nop 3
    v_and_b32 v110, 31, v118
    s_mul_i32 s32, s34, 64
    v_add_u32 v110, s32, v110
    s_mov_b32 s33, 2048
    v_mul_lo_u32 v110, v110, s33
    v_lshrrev_b32 v111, 5, v118
    v_lshl_add_u32 v110, v111, 4, v110
    s_lshl_b32 s32, s35, 8
    v_add_u32 v110, s32, v110
    buffer_store_dwordx4 v[0:3], v110, s[16:19], 0 offen offset:0
    buffer_store_dwordx4 v[4:7], v110, s[16:19], 0 offen offset:32
    buffer_store_dwordx4 v[8:11], v110, s[16:19], 0 offen offset:64
    buffer_store_dwordx4 v[12:15], v110, s[16:19], 0 offen offset:96
    buffer_store_dwordx4 v[16:19], v110, s[16:19], 0 offen offset:128
    buffer_store_dwordx4 v[20:23], v110, s[16:19], 0 offen offset:160
    buffer_store_dwordx4 v[24:27], v110, s[16:19], 0 offen offset:192
    buffer_store_dwordx4 v[28:31], v110, s[16:19], 0 offen offset:224
    v_add_u32 v110, 65536, v110
    buffer_store_dwordx4 v[32:35], v110, s[16:19], 0 offen offset:0
    buffer_store_dwordx4 v[36:39], v110, s[16:19], 0 offen offset:32
    buffer_store_dwordx4 v[40:43], v110, s[16:19], 0 offen offset:64
    buffer_store_dwordx4 v[44:47], v110, s[16:19], 0 offen offset:96
    buffer_store_dwordx4 v[48:51], v110, s[16:19], 0 offen offset:128
    buffer_store_dwordx4 v[52:55], v110, s[16:19], 0 offen offset:160
    buffer_store_dwordx4 v[56:59], v110, s[16:19], 0 offen offset:192
    buffer_store_dwordx4 v[60:63], v110, s[16:19], 0 offen offset:224
oproj_kernel_done:
    s_endpgm
.section .rodata,"a"
.p2align 6
.amdhsa_kernel oproj_kernel
  .amdhsa_next_free_vgpr 143
  .amdhsa_next_free_sgpr 48
  .amdhsa_accum_offset 144
  .amdhsa_group_segment_fixed_size 0
  .amdhsa_kernarg_size 112
  .amdhsa_user_sgpr_count 2
  .amdhsa_user_sgpr_kernarg_segment_ptr 1
  .amdhsa_system_sgpr_workgroup_id_x 1
.end_amdhsa_kernel
.text
.globl ln2_kernel
.p2align 8
.type ln2_kernel,@function
ln2_kernel:
    s_cmp_ge_u32 s2, 512
    s_cbranch_scc1 ln2_kernel_done
    s_load_dwordx2 s[4:5], s[0:1], 0
    s_load_dwordx2 s[6:7], s[0:1], 104
    v_lshrrev_b32 v1, 6, v0
    v_and_b32 v2, 63, v0
    s_lshl_b32 s3, s2, 2
    v_add_u32 v1, s3, v1
    v_lshlrev_b32 v3, 10, v1
    v_lshl_add_u32 v3, v2, 4, v3
    v_xor_b32 v48, 1, v2
    v_lshlrev_b32 v48, 2, v48
    v_xor_b32 v49, 2, v2
    v_lshlrev_b32 v49, 2, v49
    v_xor_b32 v50, 4, v2
    v_lshlrev_b32 v50, 2, v50
    v_xor_b32 v51, 8, v2
    v_lshlrev_b32 v51, 2, v51
    v_xor_b32 v52, 16, v2
    v_lshlrev_b32 v52, 2, v52
    v_xor_b32 v53, 32, v2
    v_lshlrev_b32 v53, 2, v53
    s_waitcnt lgkmcnt(0)
    s_mov_b32 s8, s4
    s_and_b32 s9, s5, 0xffff
    s_mov_b32 s10, 0x200000
    s_mov_b32 s11, 0x00020000
    s_add_u32 s12, s6, 0x200000
    s_addc_u32 s13, s7, 0
    s_and_b32 s13, s13, 0xffff
    s_mov_b32 s14, 0x200000
    s_mov_b32 s15, 0x00020000
    s_add_u32 s16, s6, 0x400000
    s_addc_u32 s17, s7, 0
    s_and_b32 s17, s17, 0xffff
    s_mov_b32 s18, 0x200000
    s_mov_b32 s19, 0x00020000
    s_add_u32 s20, s6, 0x5000000
    s_addc_u32 s21, s7, 0
    s_and_b32 s21, s21, 0xffff
    s_mov_b32 s22, 0x1000000
    s_mov_b32 s23, 0x00020000
    buffer_load_dwordx4 v[4:7], v3, s[8:11], 0 offen
    v_lshlrev_b32 v54, 11, v1
    v_lshl_add_u32 v54, v2, 5, v54
    s_mov_b32 s24, 0x0
    buffer_load_dwordx4 v[16:19], v54, s[20:23], s24 offen
    buffer_load_dwordx4 v[20:23], v54, s[20:23], s24 offen offset:16
    s_mov_b32 s24, 0x400000
    buffer_load_dwordx4 v[24:27], v54, s[20:23], s24 offen
    buffer_load_dwordx4 v[28:31], v54, s[20:23], s24 offen offset:16
    s_mov_b32 s24, 0x800000
    buffer_load_dwordx4 v[32:35], v54, s[20:23], s24 offen
    buffer_load_dwordx4 v[36:39], v54, s[20:23], s24 offen offset:16
    s_mov_b32 s24, 0xc00000
    buffer_load_dwordx4 v[40:43], v54, s[20:23], s24 offen
    buffer_load_dwordx4 v[44:47], v54, s[20:23], s24 offen offset:16
    s_waitcnt vmcnt(0)
    v_lshlrev_b32 v8, 16, v4
    v_and_b32 v9, 0xffff0000, v4
    v_lshlrev_b32 v10, 16, v5
    v_and_b32 v11, 0xffff0000, v5
    v_lshlrev_b32 v12, 16, v6
    v_and_b32 v13, 0xffff0000, v6
    v_lshlrev_b32 v14, 16, v7
    v_and_b32 v15, 0xffff0000, v7
    v_add_f32 v16, v16, v24
    v_add_f32 v32, v32, v40
    v_add_f32 v17, v17, v25
    v_add_f32 v33, v33, v41
    v_add_f32 v18, v18, v26
    v_add_f32 v34, v34, v42
    v_add_f32 v19, v19, v27
    v_add_f32 v35, v35, v43
    v_add_f32 v20, v20, v28
    v_add_f32 v36, v36, v44
    v_add_f32 v21, v21, v29
    v_add_f32 v37, v37, v45
    v_add_f32 v22, v22, v30
    v_add_f32 v38, v38, v46
    v_add_f32 v23, v23, v31
    v_add_f32 v39, v39, v47
    v_add_f32 v16, v16, v32
    v_add_f32 v17, v17, v33
    v_add_f32 v18, v18, v34
    v_add_f32 v19, v19, v35
    v_add_f32 v20, v20, v36
    v_add_f32 v21, v21, v37
    v_add_f32 v22, v22, v38
    v_add_f32 v23, v23, v39
    v_cvt_pk_bf16_f32 v55, v16, v17
    v_lshlrev_b32 v16, 16, v55
    v_and_b32 v17, 0xffff0000, v55
    v_cvt_pk_bf16_f32 v55, v18, v19
    v_lshlrev_b32 v18, 16, v55
    v_and_b32 v19, 0xffff0000, v55
    v_cvt_pk_bf16_f32 v55, v20, v21
    v_lshlrev_b32 v20, 16, v55
    v_and_b32 v21, 0xffff0000, v55
    v_cvt_pk_bf16_f32 v55, v22, v23
    v_lshlrev_b32 v22, 16, v55
    v_and_b32 v23, 0xffff0000, v55
    v_add_f32 v8, v8, v16
    v_add_f32 v9, v9, v17
    v_add_f32 v10, v10, v18
    v_add_f32 v11, v11, v19
    v_add_f32 v12, v12, v20
    v_add_f32 v13, v13, v21
    v_add_f32 v14, v14, v22
    v_add_f32 v15, v15, v23
    v_cvt_pk_bf16_f32 v4, v8, v9
    v_cvt_pk_bf16_f32 v5, v10, v11
    v_cvt_pk_bf16_f32 v6, v12, v13
    v_cvt_pk_bf16_f32 v7, v14, v15
    v_lshlrev_b32 v8, 16, v4
    v_and_b32 v9, 0xffff0000, v4
    v_lshlrev_b32 v10, 16, v5
    v_and_b32 v11, 0xffff0000, v5
    v_lshlrev_b32 v12, 16, v6
    v_and_b32 v13, 0xffff0000, v6
    v_lshlrev_b32 v14, 16, v7
    v_and_b32 v15, 0xffff0000, v7
    buffer_store_dwordx4 v[4:7], v3, s[16:19], 0 offen
    v_add_f32 v16, v8, v9
    v_add_f32 v16, v16, v10
    v_add_f32 v16, v16, v11
    v_add_f32 v16, v16, v12
    v_add_f32 v16, v16, v13
    v_add_f32 v16, v16, v14
    v_add_f32 v16, v16, v15
    ds_bpermute_b32 v17, v48, v16
    s_waitcnt lgkmcnt(0)
    v_add_f32 v16, v16, v17
    ds_bpermute_b32 v17, v49, v16
    s_waitcnt lgkmcnt(0)
    v_add_f32 v16, v16, v17
    ds_bpermute_b32 v17, v50, v16
    s_waitcnt lgkmcnt(0)
    v_add_f32 v16, v16, v17
    ds_bpermute_b32 v17, v51, v16
    s_waitcnt lgkmcnt(0)
    v_add_f32 v16, v16, v17
    ds_bpermute_b32 v17, v52, v16
    s_waitcnt lgkmcnt(0)
    v_add_f32 v16, v16, v17
    ds_bpermute_b32 v17, v53, v16
    s_waitcnt lgkmcnt(0)
    v_add_f32 v16, v16, v17
    s_mov_b32 s24, 0x3b000000
    v_mul_f32 v16, s24, v16
    v_sub_f32 v18, v8, v16
    v_mul_f32 v19, v18, v18
    v_sub_f32 v18, v9, v16
    v_fma_f32 v19, v18, v18, v19
    v_sub_f32 v18, v10, v16
    v_fma_f32 v19, v18, v18, v19
    v_sub_f32 v18, v11, v16
    v_fma_f32 v19, v18, v18, v19
    v_sub_f32 v18, v12, v16
    v_fma_f32 v19, v18, v18, v19
    v_sub_f32 v18, v13, v16
    v_fma_f32 v19, v18, v18, v19
    v_sub_f32 v18, v14, v16
    v_fma_f32 v19, v18, v18, v19
    v_sub_f32 v18, v15, v16
    v_fma_f32 v19, v18, v18, v19
    ds_bpermute_b32 v17, v48, v19
    s_waitcnt lgkmcnt(0)
    v_add_f32 v19, v19, v17
    ds_bpermute_b32 v17, v49, v19
    s_waitcnt lgkmcnt(0)
    v_add_f32 v19, v19, v17
    ds_bpermute_b32 v17, v50, v19
    s_waitcnt lgkmcnt(0)
    v_add_f32 v19, v19, v17
    ds_bpermute_b32 v17, v51, v19
    s_waitcnt lgkmcnt(0)
    v_add_f32 v19, v19, v17
    ds_bpermute_b32 v17, v52, v19
    s_waitcnt lgkmcnt(0)
    v_add_f32 v19, v19, v17
    ds_bpermute_b32 v17, v53, v19
    s_waitcnt lgkmcnt(0)
    v_add_f32 v19, v19, v17
    v_mul_f32 v19, s24, v19
    v_cvt_pk_bf16_f32 v16, v16, v16
    v_lshlrev_b32 v16, 16, v16
    v_cvt_pk_bf16_f32 v19, v19, v19
    v_lshlrev_b32 v19, 16, v19
    s_mov_b32 s25, 0x3727c5ac
    v_add_f32 v19, s25, v19
    v_cvt_pk_bf16_f32 v19, v19, v19
    v_lshlrev_b32 v19, 16, v19
    v_sqrt_f32 v19, v19
    s_nop 0
    v_cvt_pk_bf16_f32 v19, v19, v19
    v_lshlrev_b32 v19, 16, v19
    v_rcp_f32 v19, v19
    v_sub_f32 v8, v8, v16
    v_sub_f32 v9, v9, v16
    v_cvt_pk_bf16_f32 v17, v8, v9
    v_lshlrev_b32 v8, 16, v17
    v_and_b32 v9, 0xffff0000, v17
    v_mul_f32 v8, v8, v19
    v_mul_f32 v9, v9, v19
    v_cvt_pk_bf16_f32 v4, v8, v9
    v_sub_f32 v10, v10, v16
    v_sub_f32 v11, v11, v16
    v_cvt_pk_bf16_f32 v17, v10, v11
    v_lshlrev_b32 v10, 16, v17
    v_and_b32 v11, 0xffff0000, v17
    v_mul_f32 v10, v10, v19
    v_mul_f32 v11, v11, v19
    v_cvt_pk_bf16_f32 v5, v10, v11
    v_sub_f32 v12, v12, v16
    v_sub_f32 v13, v13, v16
    v_cvt_pk_bf16_f32 v17, v12, v13
    v_lshlrev_b32 v12, 16, v17
    v_and_b32 v13, 0xffff0000, v17
    v_mul_f32 v12, v12, v19
    v_mul_f32 v13, v13, v19
    v_cvt_pk_bf16_f32 v6, v12, v13
    v_sub_f32 v14, v14, v16
    v_sub_f32 v15, v15, v16
    v_cvt_pk_bf16_f32 v17, v14, v15
    v_lshlrev_b32 v14, 16, v17
    v_and_b32 v15, 0xffff0000, v17
    v_mul_f32 v14, v14, v19
    v_mul_f32 v15, v15, v19
    v_cvt_pk_bf16_f32 v7, v14, v15
    buffer_store_dwordx4 v[4:7], v3, s[12:15], 0 offen
ln2_kernel_done:
    s_endpgm
.section .rodata,"a"
.p2align 6
.amdhsa_kernel ln2_kernel
  .amdhsa_next_free_vgpr 64
  .amdhsa_next_free_sgpr 32
  .amdhsa_accum_offset 64
  .amdhsa_group_segment_fixed_size 0
  .amdhsa_kernarg_size 112
  .amdhsa_user_sgpr_count 2
  .amdhsa_user_sgpr_kernarg_segment_ptr 1
  .amdhsa_system_sgpr_workgroup_id_x 1
.end_amdhsa_kernel
.text
.globl ffn1_kernel
.p2align 8
.type ffn1_kernel,@function
ffn1_kernel:
    s_cmp_ge_u32 s2, 176
    s_cbranch_scc1 ffn1_kernel_done
    v_and_b32 v118, 63, v0
    v_lshrrev_b32 v110, 6, v0
    s_nop 0
    v_readfirstlane_b32 s28, v110
    s_mov_b32 s31, 0
    s_mul_hi_u32 s30, s2, 0x10000000
    s_lshr_b32 s30, s2, 4
    s_and_b32 s29, s2, 15
    s_load_dwordx2 s[4:5], s[0:1], 104
    s_load_dwordx2 s[6:7], s[0:1], 56
    s_load_dwordx2 s[42:43], s[0:1], 64
    s_waitcnt lgkmcnt(0)
    s_lshl_b32 s32, s29, 17
    s_add_u32 s32, s32, 0x200000
    s_sub_u32 s33, 0x400000, s32
    s_add_u32 s8, s4, s32
    s_addc_u32 s9, s5, 0
    s_and_b32 s9, s9, 0xffff
    s_mov_b32 s10, s33
    s_mov_b32 s11, 0x00020000
    s_lshl_b32 s32, s30, 8
    s_sub_u32 s33, 0x158000, s32
    s_add_u32 s12, s6, s32
    s_addc_u32 s13, s7, 0
    s_and_b32 s13, s13, 0xffff
    s_mov_b32 s14, s33
    s_mov_b32 s15, 0x00020000
    s_mul_i32 s32, s29, 352256
    s_lshl_b32 s33, s30, 8
    s_add_u32 s32, s32, s33
    s_add_u32 s32, s32, 0x600000
    s_sub_u32 s33, 0xb60000, s32
    s_add_u32 s16, s4, s32
    s_addc_u32 s17, s5, 0
    s_and_b32 s17, s17, 0xffff
    s_mov_b32 s18, s33
    s_mov_b32 s19, 0x00020000
    s_lshl_b32 s32, s30, 8
    s_sub_u32 s33, 0xac0, s32
    s_add_u32 s20, s42, s32
    s_addc_u32 s21, s43, 0
    s_and_b32 s21, s21, 0xffff
    s_mov_b32 s22, s33
    s_mov_b32 s23, 0x00020000
    s_mul_i32 s32, s28, 4
    s_add_u32 s32, s32, 0
    v_lshrrev_b32 v110, 3, v118
    s_lshl_b32 s33, s32, 3
    v_add_u32 v110, s33, v110
    v_lshrrev_b32 v111, 1, v110
    v_and_b32 v111, 7, v111
    v_and_b32 v112, 7, v118
    v_xor_b32 v111, v111, v112
    v_lshlrev_b32 v111, 4, v111
    s_mov_b32 s33, 1024
    v_mul_lo_u32 v96, v110, s33
    v_add_u32 v96, v96, v111
    s_mul_i32 s32, s28, 4
    s_add_u32 s32, s32, 1
    v_lshrrev_b32 v110, 3, v118
    s_lshl_b32 s33, s32, 3
    v_add_u32 v110, s33, v110
    v_lshrrev_b32 v111, 1, v110
    v_and_b32 v111, 7, v111
    v_and_b32 v112, 7, v118
    v_xor_b32 v111, v111, v112
    v_lshlrev_b32 v111, 4, v111
    s_mov_b32 s33, 1024
    v_mul_lo_u32 v97, v110, s33
    v_add_u32 v97, v97, v111
    s_mul_i32 s32, s28, 4
    s_add_u32 s32, s32, 2
    v_lshrrev_b32 v110, 3, v118
    s_lshl_b32 s33, s32, 3
    v_add_u32 v110, s33, v110
    v_lshrrev_b32 v111, 1, v110
    v_and_b32 v111, 7, v111
    v_and_b32 v112, 7, v118
    v_xor_b32 v111, v111, v112
    v_lshlrev_b32 v111, 4, v111
    s_mov_b32 s33, 1024
    v_mul_lo_u32 v98, v110, s33
    v_add_u32 v98, v98, v111
    s_mul_i32 s32, s28, 4
    s_add_u32 s32, s32, 3
    v_lshrrev_b32 v110, 3, v118
    s_lshl_b32 s33, s32, 3
    v_add_u32 v110, s33, v110
    v_lshrrev_b32 v111, 1, v110
    v_and_b32 v111, 7, v111
    v_and_b32 v112, 7, v118
    v_xor_b32 v111, v111, v112
    v_lshlrev_b32 v111, 4, v111
    s_mov_b32 s33, 1024
    v_mul_lo_u32 v99, v110, s33
    v_add_u32 v99, v99, v111
    s_lshl_b32 s32, s28, 2
    s_add_u32 s32, s32, 0
    v_lshrrev_b32 v110, 4, v118
    v_lshlrev_b32 v111, 2, v110
    s_lshl_b32 s33, s32, 2
    v_add_u32 v110, s33, v110
    v_and_b32 v112, 15, v118
    v_xor_b32 v111, v111, v112
    v_lshlrev_b32 v111, 4, v111
    s_mov_b32 s33, 2752
    v_mul_lo_u32 v100, v110, s33
    v_add_u32 v100, v100, v111
    s_lshl_b32 s32, s28, 2
    s_add_u32 s32, s32, 1
    v_lshrrev_b32 v110, 4, v118
    v_lshlrev_b32 v111, 2, v110
    s_lshl_b32 s33, s32, 2
    v_add_u32 v110, s33, v110
    v_and_b32 v112, 15, v118
    v_xor_b32 v111, v111, v112
    v_lshlrev_b32 v111, 4, v111
    s_mov_b32 s33, 2752
    v_mul_lo_u32 v101, v110, s33
    v_add_u32 v101, v101, v111
    s_lshl_b32 s32, s28, 2
    s_add_u32 s32, s32, 2
    v_lshrrev_b32 v110, 4, v118
    v_lshlrev_b32 v111, 2, v110
    s_lshl_b32 s33, s32, 2
    v_add_u32 v110, s33, v110
    v_and_b32 v112, 15, v118
    v_xor_b32 v111, v111, v112
    v_lshlrev_b32 v111, 4, v111
    s_mov_b32 s33, 2752
    v_mul_lo_u32 v102, v110, s33
    v_add_u32 v102, v102, v111
    s_lshl_b32 s32, s28, 2
    s_add_u32 s32, s32, 3
    v_lshrrev_b32 v110, 4, v118
    v_lshlrev_b32 v111, 2, v110
    s_lshl_b32 s33, s32, 2
    v_add_u32 v110, s33, v110
    v_and_b32 v112, 15, v118
    v_xor_b32 v111, v111, v112
    v_lshlrev_b32 v111, 4, v111
    s_mov_b32 s33, 2752
    v_mul_lo_u32 v103, v110, s33
    v_add_u32 v103, v103, v111
    s_lshr_b32 s34, s28, 1
    s_and_b32 s35, s28, 1
    v_and_b32 v110, 31, v118
    s_mul_i32 s32, s34, 64
    v_add_u32 v110, s32, v110
    v_lshrrev_b32 v111, 1, v110
    v_and_b32 v111, 7, v111
    v_lshrrev_b32 v112, 5, v118
    v_xor_b32 v111, v111, v112
    v_lshlrev_b32 v111, 4, v111
    v_lshl_add_u32 v104, v110, 7, v111
    v_xor_b32 v105, 32, v104
    v_xor_b32 v106, 64, v104
    v_xor_b32 v107, 96, v104
    v_lshrrev_b32 v110, 5, v118
    v_lshlrev_b32 v110, 3, v110
    v_bfe_u32 v111, v118, 2, 2
    v_add_u32 v110, v110, v111
    v_lshlrev_b32 v110, 8, v110
    v_bfe_u32 v112, v118, 4, 1
    v_lshlrev_b32 v112, 5, v112
    v_and_b32 v113, 3, v118
    v_lshl_add_u32 v112, v113, 3, v112
    v_add_u32 v110, v110, v112
    s_lshl_b32 s32, s35, 1
    s_add_u32 s32, s32, 0
    v_xor_b32 v113, s32, v111
    v_lshl_add_u32 v108, v113, 6, v110
    s_lshl_b32 s32, s35, 1
    s_add_u32 s32, s32, 1
    v_xor_b32 v113, s32, v111
    v_lshl_add_u32 v109, v113, 6, v110
    v_mov_b32 v0, 0
    v_mov_b32 v1, 0
    v_mov_b32 v2, 0
    v_mov_b32 v3, 0
    v_mov_b32 v4, 0
    v_mov_b32 v5, 0
    v_mov_b32 v6, 0
    v_mov_b32 v7, 0
    v_mov_b32 v8, 0
    v_mov_b32 v9, 0
    v_mov_b32 v10, 0
    v_mov_b32 v11, 0
    v_mov_b32 v12, 0
    v_mov_b32 v13, 0
    v_mov_b32 v14, 0
    v_mov_b32 v15, 0
    v_mov_b32 v16, 0
    v_mov_b32 v17, 0
    v_mov_b32 v18, 0
    v_mov_b32 v19, 0
    v_mov_b32 v20, 0
    v_mov_b32 v21, 0
    v_mov_b32 v22, 0
    v_mov_b32 v23, 0
    v_mov_b32 v24, 0
    v_mov_b32 v25, 0
    v_mov_b32 v26, 0
    v_mov_b32 v27, 0
    v_mov_b32 v28, 0
    v_mov_b32 v29, 0
    v_mov_b32 v30, 0
    v_mov_b32 v31, 0
    v_mov_b32 v32, 0
    v_mov_b32 v33, 0
    v_mov_b32 v34, 0
    v_mov_b32 v35, 0
    v_mov_b32 v36, 0
    v_mov_b32 v37, 0
    v_mov_b32 v38, 0
    v_mov_b32 v39, 0
    v_mov_b32 v40, 0
    v_mov_b32 v41, 0
    v_mov_b32 v42, 0
    v_mov_b32 v43, 0
    v_mov_b32 v44, 0
    v_mov_b32 v45, 0
    v_mov_b32 v46, 0
    v_mov_b32 v47, 0
    v_mov_b32 v48, 0
    v_mov_b32 v49, 0
    v_mov_b32 v50, 0
    v_mov_b32 v51, 0
    v_mov_b32 v52, 0
    v_mov_b32 v53, 0
    v_mov_b32 v54, 0
    v_mov_b32 v55, 0
    v_mov_b32 v56, 0
    v_mov_b32 v57, 0
    v_mov_b32 v58, 0
    v_mov_b32 v59, 0
    v_mov_b32 v60, 0
    v_mov_b32 v61, 0
    v_mov_b32 v62, 0
    v_mov_b32 v63, 0
    s_mul_i32 s36, s28, 4096
    s_lshl_b32 s37, s28, 12
    s_add_u32 s37, s37, 16384
    s_mov_b32 s38, 0
    s_mov_b32 s39, 0
    s_add_u32 m0, s36, 0
    s_nop 0
    buffer_load_dwordx4 v96, s[8:11], s38 offen lds
    s_add_u32 m0, s36, 1024
    s_nop 0
    buffer_load_dwordx4 v97, s[8:11], s38 offen lds
    s_add_u32 m0, s36, 2048
    s_nop 0
    buffer_load_dwordx4 v98, s[8:11], s38 offen lds
    s_add_u32 m0, s36, 3072
    s_nop 0
    buffer_load_dwordx4 v99, s[8:11], s38 offen lds
    s_add_u32 m0, s37, 0
    s_nop 0
    buffer_load_dwordx4 v100, s[12:15], s39 offen lds
    s_add_u32 m0, s37, 1024
    s_nop 0
    buffer_load_dwordx4 v101, s[12:15], s39 offen lds
    s_add_u32 m0, s37, 2048
    s_nop 0
    buffer_load_dwordx4 v102, s[12:15], s39 offen lds
    s_add_u32 m0, s37, 3072
    s_nop 0
    buffer_load_dwordx4 v103, s[12:15], s39 offen lds
    s_add_u32 s38, s38, 128
    s_add_u32 s39, s39, 176128
    s_waitcnt vmcnt(0)
    s_barrier
    s_add_u32 m0, s36, 32768
    s_nop 0
    buffer_load_dwordx4 v96, s[8:11], s38 offen lds
    s_add_u32 m0, s36, 33792
    s_nop 0
    buffer_load_dwordx4 v97, s[8:11], s38 offen lds
    s_add_u32 m0, s36, 34816
    s_nop 0
    buffer_load_dwordx4 v98, s[8:11], s38 offen lds
    s_add_u32 m0, s36, 35840
    s_nop 0
    buffer_load_dwordx4 v99, s[8:11], s38 offen lds
    s_add_u32 m0, s37, 32768
    s_nop 0
    buffer_load_dwordx4 v100, s[12:15], s39 offen lds
    s_add_u32 m0, s37, 33792
    s_nop 0
    buffer_load_dwordx4 v101, s[12:15], s39 offen lds
    s_add_u32 m0, s37, 34816
    s_nop 0
    buffer_load_dwordx4 v102, s[12:15], s39 offen lds
    s_add_u32 m0, s37, 35840
    s_nop 0
    buffer_load_dwordx4 v103, s[12:15], s39 offen lds
    s_add_u32 s38, s38, 128
    s_add_u32 s39, s39, 176128
    ds_read_b128 v[64:67], v104 offset:0
    ds_read_b128 v[68:71], v104 offset:4096
    ds_read_b64_tr_b16 v[72:73], v108 offset:16384
    ds_read_b64_tr_b16 v[74:75], v108 offset:17408
    ds_read_b64_tr_b16 v[76:77], v109 offset:16384
    ds_read_b64_tr_b16 v[78:79], v109 offset:17408
    ds_read_b128 v[80:83], v105 offset:0
    ds_read_b128 v[84:87], v105 offset:4096
    ds_read_b64_tr_b16 v[88:89], v108 offset:20480
    ds_read_b64_tr_b16 v[90:91], v108 offset:21504
    ds_read_b64_tr_b16 v[92:93], v109 offset:20480
    ds_read_b64_tr_b16 v[94:95], v109 offset:21504
    s_waitcnt lgkmcnt(6)
    v_mfma_f32_32x32x16_bf16 v[0:15], v[72:75], v[64:67], v[0:15]
    v_mfma_f32_32x32x16_bf16 v[16:31], v[76:79], v[64:67], v[16:31]
    v_mfma_f32_32x32x16_bf16 v[32:47], v[72:75], v[68:71], v[32:47]
    v_mfma_f32_32x32x16_bf16 v[48:63], v[76:79], v[68:71], v[48:63]
    ds_read_b128 v[64:67], v106 offset:0
    ds_read_b128 v[68:71], v106 offset:4096
    ds_read_b64_tr_b16 v[72:73], v108 offset:24576
    ds_read_b64_tr_b16 v[74:75], v108 offset:25600
    ds_read_b64_tr_b16 v[76:77], v109 offset:24576
    ds_read_b64_tr_b16 v[78:79], v109 offset:25600
    s_waitcnt lgkmcnt(6)
    v_mfma_f32_32x32x16_bf16 v[0:15], v[88:91], v[80:83], v[0:15]
    v_mfma_f32_32x32x16_bf16 v[16:31], v[92:95], v[80:83], v[16:31]
    v_mfma_f32_32x32x16_bf16 v[32:47], v[88:91], v[84:87], v[32:47]
    v_mfma_f32_32x32x16_bf16 v[48:63], v[92:95], v[84:87], v[48:63]
    ds_read_b128 v[80:83], v107 offset:0
    ds_read_b128 v[84:87], v107 offset:4096
    ds_read_b64_tr_b16 v[88:89], v108 offset:28672
    ds_read_b64_tr_b16 v[90:91], v108 offset:29696
    ds_read_b64_tr_b16 v[92:93], v109 offset:28672
    ds_read_b64_tr_b16 v[94:95], v109 offset:29696
    s_waitcnt lgkmcnt(6)
    v_mfma_f32_32x32x16_bf16 v[0:15], v[72:75], v[64:67], v[0:15]
    v_mfma_f32_32x32x16_bf16 v[16:31], v[76:79], v[64:67], v[16:31]
    v_mfma_f32_32x32x16_bf16 v[32:47], v[72:75], v[68:71], v[32:47]
    v_mfma_f32_32x32x16_bf16 v[48:63], v[76:79], v[68:71], v[48:63]
    s_waitcnt lgkmcnt(0)
    v_mfma_f32_32x32x16_bf16 v[0:15], v[88:91], v[80:83], v[0:15]
    v_mfma_f32_32x32x16_bf16 v[16:31], v[92:95], v[80:83], v[16:31]
    v_mfma_f32_32x32x16_bf16 v[32:47], v[88:91], v[84:87], v[32:47]
    v_mfma_f32_32x32x16_bf16 v[48:63], v[92:95], v[84:87], v[48:63]
    s_waitcnt vmcnt(0)
    s_barrier
    s_add_u32 m0, s36, 0
    s_nop 0
    buffer_load_dwordx4 v96, s[8:11], s38 offen lds
    s_add_u32 m0, s36, 1024
    s_nop 0
    buffer_load_dwordx4 v97, s[8:11], s38 offen lds
    s_add_u32 m0, s36, 2048
    s_nop 0
    buffer_load_dwordx4 v98, s[8:11], s38 offen lds
    s_add_u32 m0, s36, 3072
    s_nop 0
    buffer_load_dwordx4 v99, s[8:11], s38 offen lds
    s_add_u32 m0, s37, 0
    s_nop 0
    buffer_load_dwordx4 v100, s[12:15], s39 offen lds
    s_add_u32 m0, s37, 1024
    s_nop 0
    buffer_load_dwordx4 v101, s[12:15], s39 offen lds
    s_add_u32 m0, s37, 2048
    s_nop 0
    buffer_load_dwordx4 v102, s[12:15], s39 offen lds
    s_add_u32 m0, s37, 3072
    s_nop 0
    buffer_load_dwordx4 v103, s[12:15], s39 offen lds
    s_add_u32 s38, s38, 128
    s_add_u32 s39, s39, 176128
    ds_read_b128 v[64:67], v104 offset:32768
    ds_read_b128 v[68:71], v104 offset:36864
    ds_read_b64_tr_b16 v[72:73], v108 offset:49152
    ds_read_b64_tr_b16 v[74:75], v108 offset:50176
    ds_read_b64_tr_b16 v[76:77], v109 offset:49152
    ds_read_b64_tr_b16 v[78:79], v109 offset:50176
    ds_read_b128 v[80:83], v105 offset:32768
    ds_read_b128 v[84:87], v105 offset:36864
    ds_read_b64_tr_b16 v[88:89], v108 offset:53248
    ds_read_b64_tr_b16 v[90:91], v108 offset:54272
    ds_read_b64_tr_b16 v[92:93], v109 offset:53248
    ds_read_b64_tr_b16 v[94:95], v109 offset:54272
    s_waitcnt lgkmcnt(6)
    v_mfma_f32_32x32x16_bf16 v[0:15], v[72:75], v[64:67], v[0:15]
    v_mfma_f32_32x32x16_bf16 v[16:31], v[76:79], v[64:67], v[16:31]
    v_mfma_f32_32x32x16_bf16 v[32:47], v[72:75], v[68:71], v[32:47]
    v_mfma_f32_32x32x16_bf16 v[48:63], v[76:79], v[68:71], v[48:63]
    ds_read_b128 v[64:67], v106 offset:32768
    ds_read_b128 v[68:71], v106 offset:36864
    ds_read_b64_tr_b16 v[72:73], v108 offset:57344
    ds_read_b64_tr_b16 v[74:75], v108 offset:58368
    ds_read_b64_tr_b16 v[76:77], v109 offset:57344
    ds_read_b64_tr_b16 v[78:79], v109 offset:58368
    s_waitcnt lgkmcnt(6)
    v_mfma_f32_32x32x16_bf16 v[0:15], v[88:91], v[80:83], v[0:15]
    v_mfma_f32_32x32x16_bf16 v[16:31], v[92:95], v[80:83], v[16:31]
    v_mfma_f32_32x32x16_bf16 v[32:47], v[88:91], v[84:87], v[32:47]
    v_mfma_f32_32x32x16_bf16 v[48:63], v[92:95], v[84:87], v[48:63]
    ds_read_b128 v[80:83], v107 offset:32768
    ds_read_b128 v[84:87], v107 offset:36864
    ds_read_b64_tr_b16 v[88:89], v108 offset:61440
    ds_read_b64_tr_b16 v[90:91], v108 offset:62464
    ds_read_b64_tr_b16 v[92:93], v109 offset:61440
    ds_read_b64_tr_b16 v[94:95], v109 offset:62464
    s_waitcnt lgkmcnt(6)
    v_mfma_f32_32x32x16_bf16 v[0:15], v[72:75], v[64:67], v[0:15]
    v_mfma_f32_32x32x16_bf16 v[16:31], v[76:79], v[64:67], v[16:31]
    v_mfma_f32_32x32x16_bf16 v[32:47], v[72:75], v[68:71], v[32:47]
    v_mfma_f32_32x32x16_bf16 v[48:63], v[76:79], v[68:71], v[48:63]
    s_waitcnt lgkmcnt(0)
    v_mfma_f32_32x32x16_bf16 v[0:15], v[88:91], v[80:83], v[0:15]
    v_mfma_f32_32x32x16_bf16 v[16:31], v[92:95], v[80:83], v[16:31]
    v_mfma_f32_32x32x16_bf16 v[32:47], v[88:91], v[84:87], v[32:47]
    v_mfma_f32_32x32x16_bf16 v[48:63], v[92:95], v[84:87], v[48:63]
    s_waitcnt vmcnt(0)
    s_barrier
    s_add_u32 m0, s36, 32768
    s_nop 0
    buffer_load_dwordx4 v96, s[8:11], s38 offen lds
    s_add_u32 m0, s36, 33792
    s_nop 0
    buffer_load_dwordx4 v97, s[8:11], s38 offen lds
    s_add_u32 m0, s36, 34816
    s_nop 0
    buffer_load_dwordx4 v98, s[8:11], s38 offen lds
    s_add_u32 m0, s36, 35840
    s_nop 0
    buffer_load_dwordx4 v99, s[8:11], s38 offen lds
    s_add_u32 m0, s37, 32768
    s_nop 0
    buffer_load_dwordx4 v100, s[12:15], s39 offen lds
    s_add_u32 m0, s37, 33792
    s_nop 0
    buffer_load_dwordx4 v101, s[12:15], s39 offen lds
    s_add_u32 m0, s37, 34816
    s_nop 0
    buffer_load_dwordx4 v102, s[12:15], s39 offen lds
    s_add_u32 m0, s37, 35840
    s_nop 0
    buffer_load_dwordx4 v103, s[12:15], s39 offen lds
    s_add_u32 s38, s38, 128
    s_add_u32 s39, s39, 176128
    ds_read_b128 v[64:67], v104 offset:0
    ds_read_b128 v[68:71], v104 offset:4096
    ds_read_b64_tr_b16 v[72:73], v108 offset:16384
    ds_read_b64_tr_b16 v[74:75], v108 offset:17408
    ds_read_b64_tr_b16 v[76:77], v109 offset:16384
    ds_read_b64_tr_b16 v[78:79], v109 offset:17408
    ds_read_b128 v[80:83], v105 offset:0
    ds_read_b128 v[84:87], v105 offset:4096
    ds_read_b64_tr_b16 v[88:89], v108 offset:20480
    ds_read_b64_tr_b16 v[90:91], v108 offset:21504
    ds_read_b64_tr_b16 v[92:93], v109 offset:20480
    ds_read_b64_tr_b16 v[94:95], v109 offset:21504
    s_waitcnt lgkmcnt(6)
    v_mfma_f32_32x32x16_bf16 v[0:15], v[72:75], v[64:67], v[0:15]
    v_mfma_f32_32x32x16_bf16 v[16:31], v[76:79], v[64:67], v[16:31]
    v_mfma_f32_32x32x16_bf16 v[32:47], v[72:75], v[68:71], v[32:47]
    v_mfma_f32_32x32x16_bf16 v[48:63], v[76:79], v[68:71], v[48:63]
    ds_read_b128 v[64:67], v106 offset:0
    ds_read_b128 v[68:71], v106 offset:4096
    ds_read_b64_tr_b16 v[72:73], v108 offset:24576
    ds_read_b64_tr_b16 v[74:75], v108 offset:25600
    ds_read_b64_tr_b16 v[76:77], v109 offset:24576
    ds_read_b64_tr_b16 v[78:79], v109 offset:25600
    s_waitcnt lgkmcnt(6)
    v_mfma_f32_32x32x16_bf16 v[0:15], v[88:91], v[80:83], v[0:15]
    v_mfma_f32_32x32x16_bf16 v[16:31], v[92:95], v[80:83], v[16:31]
    v_mfma_f32_32x32x16_bf16 v[32:47], v[88:91], v[84:87], v[32:47]
    v_mfma_f32_32x32x16_bf16 v[48:63], v[92:95], v[84:87], v[48:63]
    ds_read_b128 v[80:83], v107 offset:0
    ds_read_b128 v[84:87], v107 offset:4096
    ds_read_b64_tr_b16 v[88:89], v108 offset:28672
    ds_read_b64_tr_b16 v[90:91], v108 offset:29696
    ds_read_b64_tr_b16 v[92:93], v109 offset:28672
    ds_read_b64_tr_b16 v[94:95], v109 offset:29696
    s_waitcnt lgkmcnt(6)
    v_mfma_f32_32x32x16_bf16 v[0:15], v[72:75], v[64:67], v[0:15]
    v_mfma_f32_32x32x16_bf16 v[16:31], v[76:79], v[64:67], v[16:31]
    v_mfma_f32_32x32x16_bf16 v[32:47], v[72:75], v[68:71], v[32:47]
    v_mfma_f32_32x32x16_bf16 v[48:63], v[76:79], v[68:71], v[48:63]
    s_waitcnt lgkmcnt(0)
    v_mfma_f32_32x32x16_bf16 v[0:15], v[88:91], v[80:83], v[0:15]
    v_mfma_f32_32x32x16_bf16 v[16:31], v[92:95], v[80:83], v[16:31]
    v_mfma_f32_32x32x16_bf16 v[32:47], v[88:91], v[84:87], v[32:47]
    v_mfma_f32_32x32x16_bf16 v[48:63], v[92:95], v[84:87], v[48:63]
    s_waitcnt vmcnt(0)
    s_barrier
    s_add_u32 m0, s36, 0
    s_nop 0
    buffer_load_dwordx4 v96, s[8:11], s38 offen lds
    s_add_u32 m0, s36, 1024
    s_nop 0
    buffer_load_dwordx4 v97, s[8:11], s38 offen lds
    s_add_u32 m0, s36, 2048
    s_nop 0
    buffer_load_dwordx4 v98, s[8:11], s38 offen lds
    s_add_u32 m0, s36, 3072
    s_nop 0
    buffer_load_dwordx4 v99, s[8:11], s38 offen lds
    s_add_u32 m0, s37, 0
    s_nop 0
    buffer_load_dwordx4 v100, s[12:15], s39 offen lds
    s_add_u32 m0, s37, 1024
    s_nop 0
    buffer_load_dwordx4 v101, s[12:15], s39 offen lds
    s_add_u32 m0, s37, 2048
    s_nop 0
    buffer_load_dwordx4 v102, s[12:15], s39 offen lds
    s_add_u32 m0, s37, 3072
    s_nop 0
    buffer_load_dwordx4 v103, s[12:15], s39 offen lds
    s_add_u32 s38, s38, 128
    s_add_u32 s39, s39, 176128
    ds_read_b128 v[64:67], v104 offset:32768
    ds_read_b128 v[68:71], v104 offset:36864
    ds_read_b64_tr_b16 v[72:73], v108 offset:49152
    ds_read_b64_tr_b16 v[74:75], v108 offset:50176
    ds_read_b64_tr_b16 v[76:77], v109 offset:49152
    ds_read_b64_tr_b16 v[78:79], v109 offset:50176
    ds_read_b128 v[80:83], v105 offset:32768
    ds_read_b128 v[84:87], v105 offset:36864
    ds_read_b64_tr_b16 v[88:89], v108 offset:53248
    ds_read_b64_tr_b16 v[90:91], v108 offset:54272
    ds_read_b64_tr_b16 v[92:93], v109 offset:53248
    ds_read_b64_tr_b16 v[94:95], v109 offset:54272
    s_waitcnt lgkmcnt(6)
    v_mfma_f32_32x32x16_bf16 v[0:15], v[72:75], v[64:67], v[0:15]
    v_mfma_f32_32x32x16_bf16 v[16:31], v[76:79], v[64:67], v[16:31]
    v_mfma_f32_32x32x16_bf16 v[32:47], v[72:75], v[68:71], v[32:47]
    v_mfma_f32_32x32x16_bf16 v[48:63], v[76:79], v[68:71], v[48:63]
    ds_read_b128 v[64:67], v106 offset:32768
    ds_read_b128 v[68:71], v106 offset:36864
    ds_read_b64_tr_b16 v[72:73], v108 offset:57344
    ds_read_b64_tr_b16 v[74:75], v108 offset:58368
    ds_read_b64_tr_b16 v[76:77], v109 offset:57344
    ds_read_b64_tr_b16 v[78:79], v109 offset:58368
    s_waitcnt lgkmcnt(6)
    v_mfma_f32_32x32x16_bf16 v[0:15], v[88:91], v[80:83], v[0:15]
    v_mfma_f32_32x32x16_bf16 v[16:31], v[92:95], v[80:83], v[16:31]
    v_mfma_f32_32x32x16_bf16 v[32:47], v[88:91], v[84:87], v[32:47]
    v_mfma_f32_32x32x16_bf16 v[48:63], v[92:95], v[84:87], v[48:63]
    ds_read_b128 v[80:83], v107 offset:32768
    ds_read_b128 v[84:87], v107 offset:36864
    ds_read_b64_tr_b16 v[88:89], v108 offset:61440
    ds_read_b64_tr_b16 v[90:91], v108 offset:62464
    ds_read_b64_tr_b16 v[92:93], v109 offset:61440
    ds_read_b64_tr_b16 v[94:95], v109 offset:62464
    s_waitcnt lgkmcnt(6)
    v_mfma_f32_32x32x16_bf16 v[0:15], v[72:75], v[64:67], v[0:15]
    v_mfma_f32_32x32x16_bf16 v[16:31], v[76:79], v[64:67], v[16:31]
    v_mfma_f32_32x32x16_bf16 v[32:47], v[72:75], v[68:71], v[32:47]
    v_mfma_f32_32x32x16_bf16 v[48:63], v[76:79], v[68:71], v[48:63]
    s_waitcnt lgkmcnt(0)
    v_mfma_f32_32x32x16_bf16 v[0:15], v[88:91], v[80:83], v[0:15]
    v_mfma_f32_32x32x16_bf16 v[16:31], v[92:95], v[80:83], v[16:31]
    v_mfma_f32_32x32x16_bf16 v[32:47], v[88:91], v[84:87], v[32:47]
    v_mfma_f32_32x32x16_bf16 v[48:63], v[92:95], v[84:87], v[48:63]
    s_waitcnt vmcnt(0)
    s_barrier
    s_add_u32 m0, s36, 32768
    s_nop 0
    buffer_load_dwordx4 v96, s[8:11], s38 offen lds
    s_add_u32 m0, s36, 33792
    s_nop 0
    buffer_load_dwordx4 v97, s[8:11], s38 offen lds
    s_add_u32 m0, s36, 34816
    s_nop 0
    buffer_load_dwordx4 v98, s[8:11], s38 offen lds
    s_add_u32 m0, s36, 35840
    s_nop 0
    buffer_load_dwordx4 v99, s[8:11], s38 offen lds
    s_add_u32 m0, s37, 32768
    s_nop 0
    buffer_load_dwordx4 v100, s[12:15], s39 offen lds
    s_add_u32 m0, s37, 33792
    s_nop 0
    buffer_load_dwordx4 v101, s[12:15], s39 offen lds
    s_add_u32 m0, s37, 34816
    s_nop 0
    buffer_load_dwordx4 v102, s[12:15], s39 offen lds
    s_add_u32 m0, s37, 35840
    s_nop 0
    buffer_load_dwordx4 v103, s[12:15], s39 offen lds
    s_add_u32 s38, s38, 128
    s_add_u32 s39, s39, 176128
    ds_read_b128 v[64:67], v104 offset:0
    ds_read_b128 v[68:71], v104 offset:4096
    ds_read_b64_tr_b16 v[72:73], v108 offset:16384
    ds_read_b64_tr_b16 v[74:75], v108 offset:17408
    ds_read_b64_tr_b16 v[76:77], v109 offset:16384
    ds_read_b64_tr_b16 v[78:79], v109 offset:17408
    ds_read_b128 v[80:83], v105 offset:0
    ds_read_b128 v[84:87], v105 offset:4096
    ds_read_b64_tr_b16 v[88:89], v108 offset:20480
    ds_read_b64_tr_b16 v[90:91], v108 offset:21504
    ds_read_b64_tr_b16 v[92:93], v109 offset:20480
    ds_read_b64_tr_b16 v[94:95], v109 offset:21504
    s_waitcnt lgkmcnt(6)
    v_mfma_f32_32x32x16_bf16 v[0:15], v[72:75], v[64:67], v[0:15]
    v_mfma_f32_32x32x16_bf16 v[16:31], v[76:79], v[64:67], v[16:31]
    v_mfma_f32_32x32x16_bf16 v[32:47], v[72:75], v[68:71], v[32:47]
    v_mfma_f32_32x32x16_bf16 v[48:63], v[76:79], v[68:71], v[48:63]
    ds_read_b128 v[64:67], v106 offset:0
    ds_read_b128 v[68:71], v106 offset:4096
    ds_read_b64_tr_b16 v[72:73], v108 offset:24576
    ds_read_b64_tr_b16 v[74:75], v108 offset:25600
    ds_read_b64_tr_b16 v[76:77], v109 offset:24576
    ds_read_b64_tr_b16 v[78:79], v109 offset:25600
    s_waitcnt lgkmcnt(6)
    v_mfma_f32_32x32x16_bf16 v[0:15], v[88:91], v[80:83], v[0:15]
    v_mfma_f32_32x32x16_bf16 v[16:31], v[92:95], v[80:83], v[16:31]
    v_mfma_f32_32x32x16_bf16 v[32:47], v[88:91], v[84:87], v[32:47]
    v_mfma_f32_32x32x16_bf16 v[48:63], v[92:95], v[84:87], v[48:63]
    ds_read_b128 v[80:83], v107 offset:0
    ds_read_b128 v[84:87], v107 offset:4096
    ds_read_b64_tr_b16 v[88:89], v108 offset:28672
    ds_read_b64_tr_b16 v[90:91], v108 offset:29696
    ds_read_b64_tr_b16 v[92:93], v109 offset:28672
    ds_read_b64_tr_b16 v[94:95], v109 offset:29696
    s_waitcnt lgkmcnt(6)
    v_mfma_f32_32x32x16_bf16 v[0:15], v[72:75], v[64:67], v[0:15]
    v_mfma_f32_32x32x16_bf16 v[16:31], v[76:79], v[64:67], v[16:31]
    v_mfma_f32_32x32x16_bf16 v[32:47], v[72:75], v[68:71], v[32:47]
    v_mfma_f32_32x32x16_bf16 v[48:63], v[76:79], v[68:71], v[48:63]
    s_waitcnt lgkmcnt(0)
    v_mfma_f32_32x32x16_bf16 v[0:15], v[88:91], v[80:83], v[0:15]
    v_mfma_f32_32x32x16_bf16 v[16:31], v[92:95], v[80:83], v[16:31]
    v_mfma_f32_32x32x16_bf16 v[32:47], v[88:91], v[84:87], v[32:47]
    v_mfma_f32_32x32x16_bf16 v[48:63], v[92:95], v[84:87], v[48:63]
    s_waitcnt vmcnt(0)
    s_barrier
    s_add_u32 m0, s36, 0
    s_nop 0
    buffer_load_dwordx4 v96, s[8:11], s38 offen lds
    s_add_u32 m0, s36, 1024
    s_nop 0
    buffer_load_dwordx4 v97, s[8:11], s38 offen lds
    s_add_u32 m0, s36, 2048
    s_nop 0
    buffer_load_dwordx4 v98, s[8:11], s38 offen lds
    s_add_u32 m0, s36, 3072
    s_nop 0
    buffer_load_dwordx4 v99, s[8:11], s38 offen lds
    s_add_u32 m0, s37, 0
    s_nop 0
    buffer_load_dwordx4 v100, s[12:15], s39 offen lds
    s_add_u32 m0, s37, 1024
    s_nop 0
    buffer_load_dwordx4 v101, s[12:15], s39 offen lds
    s_add_u32 m0, s37, 2048
    s_nop 0
    buffer_load_dwordx4 v102, s[12:15], s39 offen lds
    s_add_u32 m0, s37, 3072
    s_nop 0
    buffer_load_dwordx4 v103, s[12:15], s39 offen lds
    s_add_u32 s38, s38, 128
    s_add_u32 s39, s39, 176128
    ds_read_b128 v[64:67], v104 offset:32768
    ds_read_b128 v[68:71], v104 offset:36864
    ds_read_b64_tr_b16 v[72:73], v108 offset:49152
    ds_read_b64_tr_b16 v[74:75], v108 offset:50176
    ds_read_b64_tr_b16 v[76:77], v109 offset:49152
    ds_read_b64_tr_b16 v[78:79], v109 offset:50176
    ds_read_b128 v[80:83], v105 offset:32768
    ds_read_b128 v[84:87], v105 offset:36864
    ds_read_b64_tr_b16 v[88:89], v108 offset:53248
    ds_read_b64_tr_b16 v[90:91], v108 offset:54272
    ds_read_b64_tr_b16 v[92:93], v109 offset:53248
    ds_read_b64_tr_b16 v[94:95], v109 offset:54272
    s_waitcnt lgkmcnt(6)
    v_mfma_f32_32x32x16_bf16 v[0:15], v[72:75], v[64:67], v[0:15]
    v_mfma_f32_32x32x16_bf16 v[16:31], v[76:79], v[64:67], v[16:31]
    v_mfma_f32_32x32x16_bf16 v[32:47], v[72:75], v[68:71], v[32:47]
    v_mfma_f32_32x32x16_bf16 v[48:63], v[76:79], v[68:71], v[48:63]
    ds_read_b128 v[64:67], v106 offset:32768
    ds_read_b128 v[68:71], v106 offset:36864
    ds_read_b64_tr_b16 v[72:73], v108 offset:57344
    ds_read_b64_tr_b16 v[74:75], v108 offset:58368
    ds_read_b64_tr_b16 v[76:77], v109 offset:57344
    ds_read_b64_tr_b16 v[78:79], v109 offset:58368
    s_waitcnt lgkmcnt(6)
    v_mfma_f32_32x32x16_bf16 v[0:15], v[88:91], v[80:83], v[0:15]
    v_mfma_f32_32x32x16_bf16 v[16:31], v[92:95], v[80:83], v[16:31]
    v_mfma_f32_32x32x16_bf16 v[32:47], v[88:91], v[84:87], v[32:47]
    v_mfma_f32_32x32x16_bf16 v[48:63], v[92:95], v[84:87], v[48:63]
    ds_read_b128 v[80:83], v107 offset:32768
    ds_read_b128 v[84:87], v107 offset:36864
    ds_read_b64_tr_b16 v[88:89], v108 offset:61440
    ds_read_b64_tr_b16 v[90:91], v108 offset:62464
    ds_read_b64_tr_b16 v[92:93], v109 offset:61440
    ds_read_b64_tr_b16 v[94:95], v109 offset:62464
    s_waitcnt lgkmcnt(6)
    v_mfma_f32_32x32x16_bf16 v[0:15], v[72:75], v[64:67], v[0:15]
    v_mfma_f32_32x32x16_bf16 v[16:31], v[76:79], v[64:67], v[16:31]
    v_mfma_f32_32x32x16_bf16 v[32:47], v[72:75], v[68:71], v[32:47]
    v_mfma_f32_32x32x16_bf16 v[48:63], v[76:79], v[68:71], v[48:63]
    s_waitcnt lgkmcnt(0)
    v_mfma_f32_32x32x16_bf16 v[0:15], v[88:91], v[80:83], v[0:15]
    v_mfma_f32_32x32x16_bf16 v[16:31], v[92:95], v[80:83], v[16:31]
    v_mfma_f32_32x32x16_bf16 v[32:47], v[88:91], v[84:87], v[32:47]
    v_mfma_f32_32x32x16_bf16 v[48:63], v[92:95], v[84:87], v[48:63]
    s_waitcnt vmcnt(0)
    s_barrier
    s_add_u32 m0, s36, 32768
    s_nop 0
    buffer_load_dwordx4 v96, s[8:11], s38 offen lds
    s_add_u32 m0, s36, 33792
    s_nop 0
    buffer_load_dwordx4 v97, s[8:11], s38 offen lds
    s_add_u32 m0, s36, 34816
    s_nop 0
    buffer_load_dwordx4 v98, s[8:11], s38 offen lds
    s_add_u32 m0, s36, 35840
    s_nop 0
    buffer_load_dwordx4 v99, s[8:11], s38 offen lds
    s_add_u32 m0, s37, 32768
    s_nop 0
    buffer_load_dwordx4 v100, s[12:15], s39 offen lds
    s_add_u32 m0, s37, 33792
    s_nop 0
    buffer_load_dwordx4 v101, s[12:15], s39 offen lds
    s_add_u32 m0, s37, 34816
    s_nop 0
    buffer_load_dwordx4 v102, s[12:15], s39 offen lds
    s_add_u32 m0, s37, 35840
    s_nop 0
    buffer_load_dwordx4 v103, s[12:15], s39 offen lds
    s_add_u32 s38, s38, 128
    s_add_u32 s39, s39, 176128
    ds_read_b128 v[64:67], v104 offset:0
    ds_read_b128 v[68:71], v104 offset:4096
    ds_read_b64_tr_b16 v[72:73], v108 offset:16384
    ds_read_b64_tr_b16 v[74:75], v108 offset:17408
    ds_read_b64_tr_b16 v[76:77], v109 offset:16384
    ds_read_b64_tr_b16 v[78:79], v109 offset:17408
    ds_read_b128 v[80:83], v105 offset:0
    ds_read_b128 v[84:87], v105 offset:4096
    ds_read_b64_tr_b16 v[88:89], v108 offset:20480
    ds_read_b64_tr_b16 v[90:91], v108 offset:21504
    ds_read_b64_tr_b16 v[92:93], v109 offset:20480
    ds_read_b64_tr_b16 v[94:95], v109 offset:21504
    s_waitcnt lgkmcnt(6)
    v_mfma_f32_32x32x16_bf16 v[0:15], v[72:75], v[64:67], v[0:15]
    v_mfma_f32_32x32x16_bf16 v[16:31], v[76:79], v[64:67], v[16:31]
    v_mfma_f32_32x32x16_bf16 v[32:47], v[72:75], v[68:71], v[32:47]
    v_mfma_f32_32x32x16_bf16 v[48:63], v[76:79], v[68:71], v[48:63]
    ds_read_b128 v[64:67], v106 offset:0
    ds_read_b128 v[68:71], v106 offset:4096
    ds_read_b64_tr_b16 v[72:73], v108 offset:24576
    ds_read_b64_tr_b16 v[74:75], v108 offset:25600
    ds_read_b64_tr_b16 v[76:77], v109 offset:24576
    ds_read_b64_tr_b16 v[78:79], v109 offset:25600
    s_waitcnt lgkmcnt(6)
    v_mfma_f32_32x32x16_bf16 v[0:15], v[88:91], v[80:83], v[0:15]
    v_mfma_f32_32x32x16_bf16 v[16:31], v[92:95], v[80:83], v[16:31]
    v_mfma_f32_32x32x16_bf16 v[32:47], v[88:91], v[84:87], v[32:47]
    v_mfma_f32_32x32x16_bf16 v[48:63], v[92:95], v[84:87], v[48:63]
    ds_read_b128 v[80:83], v107 offset:0
    ds_read_b128 v[84:87], v107 offset:4096
    ds_read_b64_tr_b16 v[88:89], v108 offset:28672
    ds_read_b64_tr_b16 v[90:91], v108 offset:29696
    ds_read_b64_tr_b16 v[92:93], v109 offset:28672
    ds_read_b64_tr_b16 v[94:95], v109 offset:29696
    s_waitcnt lgkmcnt(6)
    v_mfma_f32_32x32x16_bf16 v[0:15], v[72:75], v[64:67], v[0:15]
    v_mfma_f32_32x32x16_bf16 v[16:31], v[76:79], v[64:67], v[16:31]
    v_mfma_f32_32x32x16_bf16 v[32:47], v[72:75], v[68:71], v[32:47]
    v_mfma_f32_32x32x16_bf16 v[48:63], v[76:79], v[68:71], v[48:63]
    s_waitcnt lgkmcnt(0)
    v_mfma_f32_32x32x16_bf16 v[0:15], v[88:91], v[80:83], v[0:15]
    v_mfma_f32_32x32x16_bf16 v[16:31], v[92:95], v[80:83], v[16:31]
    v_mfma_f32_32x32x16_bf16 v[32:47], v[88:91], v[84:87], v[32:47]
    v_mfma_f32_32x32x16_bf16 v[48:63], v[92:95], v[84:87], v[48:63]
    s_waitcnt vmcnt(0)
    s_barrier
    ds_read_b128 v[64:67], v104 offset:32768
    ds_read_b128 v[68:71], v104 offset:36864
    ds_read_b64_tr_b16 v[72:73], v108 offset:49152
    ds_read_b64_tr_b16 v[74:75], v108 offset:50176
    ds_read_b64_tr_b16 v[76:77], v109 offset:49152
    ds_read_b64_tr_b16 v[78:79], v109 offset:50176
    ds_read_b128 v[80:83], v105 offset:32768
    ds_read_b128 v[84:87], v105 offset:36864
    ds_read_b64_tr_b16 v[88:89], v108 offset:53248
    ds_read_b64_tr_b16 v[90:91], v108 offset:54272
    ds_read_b64_tr_b16 v[92:93], v109 offset:53248
    ds_read_b64_tr_b16 v[94:95], v109 offset:54272
    s_waitcnt lgkmcnt(6)
    v_mfma_f32_32x32x16_bf16 v[0:15], v[72:75], v[64:67], v[0:15]
    v_mfma_f32_32x32x16_bf16 v[16:31], v[76:79], v[64:67], v[16:31]
    v_mfma_f32_32x32x16_bf16 v[32:47], v[72:75], v[68:71], v[32:47]
    v_mfma_f32_32x32x16_bf16 v[48:63], v[76:79], v[68:71], v[48:63]
    ds_read_b128 v[64:67], v106 offset:32768
    ds_read_b128 v[68:71], v106 offset:36864
    ds_read_b64_tr_b16 v[72:73], v108 offset:57344
    ds_read_b64_tr_b16 v[74:75], v108 offset:58368
    ds_read_b64_tr_b16 v[76:77], v109 offset:57344
    ds_read_b64_tr_b16 v[78:79], v109 offset:58368
    s_waitcnt lgkmcnt(6)
    v_mfma_f32_32x32x16_bf16 v[0:15], v[88:91], v[80:83], v[0:15]
    v_mfma_f32_32x32x16_bf16 v[16:31], v[92:95], v[80:83], v[16:31]
    v_mfma_f32_32x32x16_bf16 v[32:47], v[88:91], v[84:87], v[32:47]
    v_mfma_f32_32x32x16_bf16 v[48:63], v[92:95], v[84:87], v[48:63]
    ds_read_b128 v[80:83], v107 offset:32768
    ds_read_b128 v[84:87], v107 offset:36864
    ds_read_b64_tr_b16 v[88:89], v108 offset:61440
    ds_read_b64_tr_b16 v[90:91], v108 offset:62464
    ds_read_b64_tr_b16 v[92:93], v109 offset:61440
    ds_read_b64_tr_b16 v[94:95], v109 offset:62464
    s_waitcnt lgkmcnt(6)
    v_mfma_f32_32x32x16_bf16 v[0:15], v[72:75], v[64:67], v[0:15]
    v_mfma_f32_32x32x16_bf16 v[16:31], v[76:79], v[64:67], v[16:31]
    v_mfma_f32_32x32x16_bf16 v[32:47], v[72:75], v[68:71], v[32:47]
    v_mfma_f32_32x32x16_bf16 v[48:63], v[76:79], v[68:71], v[48:63]
    s_waitcnt lgkmcnt(0)
    v_mfma_f32_32x32x16_bf16 v[0:15], v[88:91], v[80:83], v[0:15]
    v_mfma_f32_32x32x16_bf16 v[16:31], v[92:95], v[80:83], v[16:31]
    v_mfma_f32_32x32x16_bf16 v[32:47], v[88:91], v[84:87], v[32:47]
    v_mfma_f32_32x32x16_bf16 v[48:63], v[92:95], v[84:87], v[48:63]
    s_nop 15
    s_nop 3
    s_barrier
    v_lshrrev_b32 v110, 5, v118
    v_lshlrev_b32 v110, 3, v110
    s_lshl_b32 s32, s35, 7
    v_add_u32 v110, s32, v110
    buffer_load_dwordx2 v[64:65], v110, s[20:23], 0 offen offset:0
    buffer_load_dwordx2 v[66:67], v110, s[20:23], 0 offen offset:16
    buffer_load_dwordx2 v[68:69], v110, s[20:23], 0 offen offset:32
    buffer_load_dwordx2 v[70:71], v110, s[20:23], 0 offen offset:48
    buffer_load_dwordx2 v[72:73], v110, s[20:23], 0 offen offset:64
    buffer_load_dwordx2 v[74:75], v110, s[20:23], 0 offen offset:80
    buffer_load_dwordx2 v[76:77], v110, s[20:23], 0 offen offset:96
    buffer_load_dwordx2 v[78:79], v110, s[20:23], 0 offen offset:112
    s_waitcnt vmcnt(0)
    v_and_b32 v110, 31, v118
    s_mul_i32 s32, s34, 64
    v_add_u32 v110, s32, v110
    v_mul_u32_u24 v110, 272, v110
    v_lshrrev_b32 v111, 5, v118
    v_lshl_add_u32 v110, v111, 3, v110
    s_lshl_b32 s32, s35, 7
    v_add_u32 v110, s32, v110
    s_mov_b32 s41, 0xc0135761
    s_mov_b32 s42, 0x3d372713
    v_cvt_pk_bf16_f32 v112, v0, v1
    v_lshlrev_b32 v0, 16, v112
    v_and_b32 v1, 0xffff0000, v112
    v_cvt_pk_bf16_f32 v112, v2, v3
    v_lshlrev_b32 v2, 16, v112
    v_and_b32 v3, 0xffff0000, v112
    v_lshlrev_b32 v112, 16, v64
    v_and_b32 v113, 0xffff0000, v64
    v_lshlrev_b32 v114, 16, v65
    v_and_b32 v115, 0xffff0000, v65
    v_add_f32 v0, v0, v112
    v_add_f32 v1, v1, v113
    v_add_f32 v2, v2, v114
    v_add_f32 v3, v3, v115
    v_cvt_pk_bf16_f32 v112, v0, v1
    v_lshlrev_b32 v0, 16, v112
    v_and_b32 v1, 0xffff0000, v112
    v_cvt_pk_bf16_f32 v112, v2, v3
    v_lshlrev_b32 v2, 16, v112
    v_and_b32 v3, 0xffff0000, v112
    v_mul_f32 v112, v0, v0
    v_fma_f32 v112, v112, s42, 1.0
    v_mul_f32 v112, v112, v0
    v_mul_f32 v112, s41, v112
    v_exp_f32 v112, v112
    v_mul_f32 v113, v1, v1
    v_fma_f32 v113, v113, s42, 1.0
    v_mul_f32 v113, v113, v1
    v_mul_f32 v113, s41, v113
    v_exp_f32 v113, v113
    v_mul_f32 v114, v2, v2
    v_fma_f32 v114, v114, s42, 1.0
    v_mul_f32 v114, v114, v2
    v_mul_f32 v114, s41, v114
    v_exp_f32 v114, v114
    v_mul_f32 v115, v3, v3
    v_fma_f32 v115, v115, s42, 1.0
    v_mul_f32 v115, v115, v3
    v_mul_f32 v115, s41, v115
    v_exp_f32 v115, v115
    s_nop 0
    v_add_f32 v112, 1.0, v112
    v_rcp_f32 v112, v112
    v_add_f32 v113, 1.0, v113
    v_rcp_f32 v113, v113
    v_add_f32 v114, 1.0, v114
    v_rcp_f32 v114, v114
    v_add_f32 v115, 1.0, v115
    v_rcp_f32 v115, v115
    s_nop 0
    v_mul_f32 v0, v0, v112
    v_mul_f32 v1, v1, v113
    v_mul_f32 v2, v2, v114
    v_mul_f32 v3, v3, v115
    v_cvt_pk_bf16_f32 v0, v0, v1
    v_cvt_pk_bf16_f32 v1, v2, v3
    ds_write_b64 v110, v[0:1] offset:0
    v_cvt_pk_bf16_f32 v112, v4, v5
    v_lshlrev_b32 v4, 16, v112
    v_and_b32 v5, 0xffff0000, v112
    v_cvt_pk_bf16_f32 v112, v6, v7
    v_lshlrev_b32 v6, 16, v112
    v_and_b32 v7, 0xffff0000, v112
    v_lshlrev_b32 v112, 16, v66
    v_and_b32 v113, 0xffff0000, v66
    v_lshlrev_b32 v114, 16, v67
    v_and_b32 v115, 0xffff0000, v67
    v_add_f32 v4, v4, v112
    v_add_f32 v5, v5, v113
    v_add_f32 v6, v6, v114
    v_add_f32 v7, v7, v115
    v_cvt_pk_bf16_f32 v112, v4, v5
    v_lshlrev_b32 v4, 16, v112
    v_and_b32 v5, 0xffff0000, v112
    v_cvt_pk_bf16_f32 v112, v6, v7
    v_lshlrev_b32 v6, 16, v112
    v_and_b32 v7, 0xffff0000, v112
    v_mul_f32 v112, v4, v4
    v_fma_f32 v112, v112, s42, 1.0
    v_mul_f32 v112, v112, v4
    v_mul_f32 v112, s41, v112
    v_exp_f32 v112, v112
    v_mul_f32 v113, v5, v5
    v_fma_f32 v113, v113, s42, 1.0
    v_mul_f32 v113, v113, v5
    v_mul_f32 v113, s41, v113
    v_exp_f32 v113, v113
    v_mul_f32 v114, v6, v6
    v_fma_f32 v114, v114, s42, 1.0
    v_mul_f32 v114, v114, v6
    v_mul_f32 v114, s41, v114
    v_exp_f32 v114, v114
    v_mul_f32 v115, v7, v7
    v_fma_f32 v115, v115, s42, 1.0
    v_mul_f32 v115, v115, v7
    v_mul_f32 v115, s41, v115
    v_exp_f32 v115, v115
    s_nop 0
    v_add_f32 v112, 1.0, v112
    v_rcp_f32 v112, v112
    v_add_f32 v113, 1.0, v113
    v_rcp_f32 v113, v113
    v_add_f32 v114, 1.0, v114
    v_rcp_f32 v114, v114
    v_add_f32 v115, 1.0, v115
    v_rcp_f32 v115, v115
    s_nop 0
    v_mul_f32 v4, v4, v112
    v_mul_f32 v5, v5, v113
    v_mul_f32 v6, v6, v114
    v_mul_f32 v7, v7, v115
    v_cvt_pk_bf16_f32 v4, v4, v5
    v_cvt_pk_bf16_f32 v5, v6, v7
    ds_write_b64 v110, v[4:5] offset:16
    v_cvt_pk_bf16_f32 v112, v8, v9
    v_lshlrev_b32 v8, 16, v112
    v_and_b32 v9, 0xffff0000, v112
    v_cvt_pk_bf16_f32 v112, v10, v11
    v_lshlrev_b32 v10, 16, v112
    v_and_b32 v11, 0xffff0000, v112
    v_lshlrev_b32 v112, 16, v68
    v_and_b32 v113, 0xffff0000, v68
    v_lshlrev_b32 v114, 16, v69
    v_and_b32 v115, 0xffff0000, v69
    v_add_f32 v8, v8, v112
    v_add_f32 v9, v9, v113
    v_add_f32 v10, v10, v114
    v_add_f32 v11, v11, v115
    v_cvt_pk_bf16_f32 v112, v8, v9
    v_lshlrev_b32 v8, 16, v112
    v_and_b32 v9, 0xffff0000, v112
    v_cvt_pk_bf16_f32 v112, v10, v11
    v_lshlrev_b32 v10, 16, v112
    v_and_b32 v11, 0xffff0000, v112
    v_mul_f32 v112, v8, v8
    v_fma_f32 v112, v112, s42, 1.0
    v_mul_f32 v112, v112, v8
    v_mul_f32 v112, s41, v112
    v_exp_f32 v112, v112
    v_mul_f32 v113, v9, v9
    v_fma_f32 v113, v113, s42, 1.0
    v_mul_f32 v113, v113, v9
    v_mul_f32 v113, s41, v113
    v_exp_f32 v113, v113
    v_mul_f32 v114, v10, v10
    v_fma_f32 v114, v114, s42, 1.0
    v_mul_f32 v114, v114, v10
    v_mul_f32 v114, s41, v114
    v_exp_f32 v114, v114
    v_mul_f32 v115, v11, v11
    v_fma_f32 v115, v115, s42, 1.0
    v_mul_f32 v115, v115, v11
    v_mul_f32 v115, s41, v115
    v_exp_f32 v115, v115
    s_nop 0
    v_add_f32 v112, 1.0, v112
    v_rcp_f32 v112, v112
    v_add_f32 v113, 1.0, v113
    v_rcp_f32 v113, v113
    v_add_f32 v114, 1.0, v114
    v_rcp_f32 v114, v114
    v_add_f32 v115, 1.0, v115
    v_rcp_f32 v115, v115
    s_nop 0
    v_mul_f32 v8, v8, v112
    v_mul_f32 v9, v9, v113
    v_mul_f32 v10, v10, v114
    v_mul_f32 v11, v11, v115
    v_cvt_pk_bf16_f32 v8, v8, v9
    v_cvt_pk_bf16_f32 v9, v10, v11
    ds_write_b64 v110, v[8:9] offset:32
    v_cvt_pk_bf16_f32 v112, v12, v13
    v_lshlrev_b32 v12, 16, v112
    v_and_b32 v13, 0xffff0000, v112
    v_cvt_pk_bf16_f32 v112, v14, v15
    v_lshlrev_b32 v14, 16, v112
    v_and_b32 v15, 0xffff0000, v112
    v_lshlrev_b32 v112, 16, v70
    v_and_b32 v113, 0xffff0000, v70
    v_lshlrev_b32 v114, 16, v71
    v_and_b32 v115, 0xffff0000, v71
    v_add_f32 v12, v12, v112
    v_add_f32 v13, v13, v113
    v_add_f32 v14, v14, v114
    v_add_f32 v15, v15, v115
    v_cvt_pk_bf16_f32 v112, v12, v13
    v_lshlrev_b32 v12, 16, v112
    v_and_b32 v13, 0xffff0000, v112
    v_cvt_pk_bf16_f32 v112, v14, v15
    v_lshlrev_b32 v14, 16, v112
    v_and_b32 v15, 0xffff0000, v112
    v_mul_f32 v112, v12, v12
    v_fma_f32 v112, v112, s42, 1.0
    v_mul_f32 v112, v112, v12
    v_mul_f32 v112, s41, v112
    v_exp_f32 v112, v112
    v_mul_f32 v113, v13, v13
    v_fma_f32 v113, v113, s42, 1.0
    v_mul_f32 v113, v113, v13
    v_mul_f32 v113, s41, v113
    v_exp_f32 v113, v113
    v_mul_f32 v114, v14, v14
    v_fma_f32 v114, v114, s42, 1.0
    v_mul_f32 v114, v114, v14
    v_mul_f32 v114, s41, v114
    v_exp_f32 v114, v114
    v_mul_f32 v115, v15, v15
    v_fma_f32 v115, v115, s42, 1.0
    v_mul_f32 v115, v115, v15
    v_mul_f32 v115, s41, v115
    v_exp_f32 v115, v115
    s_nop 0
    v_add_f32 v112, 1.0, v112
    v_rcp_f32 v112, v112
    v_add_f32 v113, 1.0, v113
    v_rcp_f32 v113, v113
    v_add_f32 v114, 1.0, v114
    v_rcp_f32 v114, v114
    v_add_f32 v115, 1.0, v115
    v_rcp_f32 v115, v115
    s_nop 0
    v_mul_f32 v12, v12, v112
    v_mul_f32 v13, v13, v113
    v_mul_f32 v14, v14, v114
    v_mul_f32 v15, v15, v115
    v_cvt_pk_bf16_f32 v12, v12, v13
    v_cvt_pk_bf16_f32 v13, v14, v15
    ds_write_b64 v110, v[12:13] offset:48
    v_cvt_pk_bf16_f32 v112, v16, v17
    v_lshlrev_b32 v16, 16, v112
    v_and_b32 v17, 0xffff0000, v112
    v_cvt_pk_bf16_f32 v112, v18, v19
    v_lshlrev_b32 v18, 16, v112
    v_and_b32 v19, 0xffff0000, v112
    v_lshlrev_b32 v112, 16, v72
    v_and_b32 v113, 0xffff0000, v72
    v_lshlrev_b32 v114, 16, v73
    v_and_b32 v115, 0xffff0000, v73
    v_add_f32 v16, v16, v112
    v_add_f32 v17, v17, v113
    v_add_f32 v18, v18, v114
    v_add_f32 v19, v19, v115
    v_cvt_pk_bf16_f32 v112, v16, v17
    v_lshlrev_b32 v16, 16, v112
    v_and_b32 v17, 0xffff0000, v112
    v_cvt_pk_bf16_f32 v112, v18, v19
    v_lshlrev_b32 v18, 16, v112
    v_and_b32 v19, 0xffff0000, v112
    v_mul_f32 v112, v16, v16
    v_fma_f32 v112, v112, s42, 1.0
    v_mul_f32 v112, v112, v16
    v_mul_f32 v112, s41, v112
    v_exp_f32 v112, v112
    v_mul_f32 v113, v17, v17
    v_fma_f32 v113, v113, s42, 1.0
    v_mul_f32 v113, v113, v17
    v_mul_f32 v113, s41, v113
    v_exp_f32 v113, v113
    v_mul_f32 v114, v18, v18
    v_fma_f32 v114, v114, s42, 1.0
    v_mul_f32 v114, v114, v18
    v_mul_f32 v114, s41, v114
    v_exp_f32 v114, v114
    v_mul_f32 v115, v19, v19
    v_fma_f32 v115, v115, s42, 1.0
    v_mul_f32 v115, v115, v19
    v_mul_f32 v115, s41, v115
    v_exp_f32 v115, v115
    s_nop 0
    v_add_f32 v112, 1.0, v112
    v_rcp_f32 v112, v112
    v_add_f32 v113, 1.0, v113
    v_rcp_f32 v113, v113
    v_add_f32 v114, 1.0, v114
    v_rcp_f32 v114, v114
    v_add_f32 v115, 1.0, v115
    v_rcp_f32 v115, v115
    s_nop 0
    v_mul_f32 v16, v16, v112
    v_mul_f32 v17, v17, v113
    v_mul_f32 v18, v18, v114
    v_mul_f32 v19, v19, v115
    v_cvt_pk_bf16_f32 v16, v16, v17
    v_cvt_pk_bf16_f32 v17, v18, v19
    ds_write_b64 v110, v[16:17] offset:64
    v_cvt_pk_bf16_f32 v112, v20, v21
    v_lshlrev_b32 v20, 16, v112
    v_and_b32 v21, 0xffff0000, v112
    v_cvt_pk_bf16_f32 v112, v22, v23
    v_lshlrev_b32 v22, 16, v112
    v_and_b32 v23, 0xffff0000, v112
    v_lshlrev_b32 v112, 16, v74
    v_and_b32 v113, 0xffff0000, v74
    v_lshlrev_b32 v114, 16, v75
    v_and_b32 v115, 0xffff0000, v75
    v_add_f32 v20, v20, v112
    v_add_f32 v21, v21, v113
    v_add_f32 v22, v22, v114
    v_add_f32 v23, v23, v115
    v_cvt_pk_bf16_f32 v112, v20, v21
    v_lshlrev_b32 v20, 16, v112
    v_and_b32 v21, 0xffff0000, v112
    v_cvt_pk_bf16_f32 v112, v22, v23
    v_lshlrev_b32 v22, 16, v112
    v_and_b32 v23, 0xffff0000, v112
    v_mul_f32 v112, v20, v20
    v_fma_f32 v112, v112, s42, 1.0
    v_mul_f32 v112, v112, v20
    v_mul_f32 v112, s41, v112
    v_exp_f32 v112, v112
    v_mul_f32 v113, v21, v21
    v_fma_f32 v113, v113, s42, 1.0
    v_mul_f32 v113, v113, v21
    v_mul_f32 v113, s41, v113
    v_exp_f32 v113, v113
    v_mul_f32 v114, v22, v22
    v_fma_f32 v114, v114, s42, 1.0
    v_mul_f32 v114, v114, v22
    v_mul_f32 v114, s41, v114
    v_exp_f32 v114, v114
    v_mul_f32 v115, v23, v23
    v_fma_f32 v115, v115, s42, 1.0
    v_mul_f32 v115, v115, v23
    v_mul_f32 v115, s41, v115
    v_exp_f32 v115, v115
    s_nop 0
    v_add_f32 v112, 1.0, v112
    v_rcp_f32 v112, v112
    v_add_f32 v113, 1.0, v113
    v_rcp_f32 v113, v113
    v_add_f32 v114, 1.0, v114
    v_rcp_f32 v114, v114
    v_add_f32 v115, 1.0, v115
    v_rcp_f32 v115, v115
    s_nop 0
    v_mul_f32 v20, v20, v112
    v_mul_f32 v21, v21, v113
    v_mul_f32 v22, v22, v114
    v_mul_f32 v23, v23, v115
    v_cvt_pk_bf16_f32 v20, v20, v21
    v_cvt_pk_bf16_f32 v21, v22, v23
    ds_write_b64 v110, v[20:21] offset:80
    v_cvt_pk_bf16_f32 v112, v24, v25
    v_lshlrev_b32 v24, 16, v112
    v_and_b32 v25, 0xffff0000, v112
    v_cvt_pk_bf16_f32 v112, v26, v27
    v_lshlrev_b32 v26, 16, v112
    v_and_b32 v27, 0xffff0000, v112
    v_lshlrev_b32 v112, 16, v76
    v_and_b32 v113, 0xffff0000, v76
    v_lshlrev_b32 v114, 16, v77
    v_and_b32 v115, 0xffff0000, v77
    v_add_f32 v24, v24, v112
    v_add_f32 v25, v25, v113
    v_add_f32 v26, v26, v114
    v_add_f32 v27, v27, v115
    v_cvt_pk_bf16_f32 v112, v24, v25
    v_lshlrev_b32 v24, 16, v112
    v_and_b32 v25, 0xffff0000, v112
    v_cvt_pk_bf16_f32 v112, v26, v27
    v_lshlrev_b32 v26, 16, v112
    v_and_b32 v27, 0xffff0000, v112
    v_mul_f32 v112, v24, v24
    v_fma_f32 v112, v112, s42, 1.0
    v_mul_f32 v112, v112, v24
    v_mul_f32 v112, s41, v112
    v_exp_f32 v112, v112
    v_mul_f32 v113, v25, v25
    v_fma_f32 v113, v113, s42, 1.0
    v_mul_f32 v113, v113, v25
    v_mul_f32 v113, s41, v113
    v_exp_f32 v113, v113
    v_mul_f32 v114, v26, v26
    v_fma_f32 v114, v114, s42, 1.0
    v_mul_f32 v114, v114, v26
    v_mul_f32 v114, s41, v114
    v_exp_f32 v114, v114
    v_mul_f32 v115, v27, v27
    v_fma_f32 v115, v115, s42, 1.0
    v_mul_f32 v115, v115, v27
    v_mul_f32 v115, s41, v115
    v_exp_f32 v115, v115
    s_nop 0
    v_add_f32 v112, 1.0, v112
    v_rcp_f32 v112, v112
    v_add_f32 v113, 1.0, v113
    v_rcp_f32 v113, v113
    v_add_f32 v114, 1.0, v114
    v_rcp_f32 v114, v114
    v_add_f32 v115, 1.0, v115
    v_rcp_f32 v115, v115
    s_nop 0
    v_mul_f32 v24, v24, v112
    v_mul_f32 v25, v25, v113
    v_mul_f32 v26, v26, v114
    v_mul_f32 v27, v27, v115
    v_cvt_pk_bf16_f32 v24, v24, v25
    v_cvt_pk_bf16_f32 v25, v26, v27
    ds_write_b64 v110, v[24:25] offset:96
    v_cvt_pk_bf16_f32 v112, v28, v29
    v_lshlrev_b32 v28, 16, v112
    v_and_b32 v29, 0xffff0000, v112
    v_cvt_pk_bf16_f32 v112, v30, v31
    v_lshlrev_b32 v30, 16, v112
    v_and_b32 v31, 0xffff0000, v112
    v_lshlrev_b32 v112, 16, v78
    v_and_b32 v113, 0xffff0000, v78
    v_lshlrev_b32 v114, 16, v79
    v_and_b32 v115, 0xffff0000, v79
    v_add_f32 v28, v28, v112
    v_add_f32 v29, v29, v113
    v_add_f32 v30, v30, v114
    v_add_f32 v31, v31, v115
    v_cvt_pk_bf16_f32 v112, v28, v29
    v_lshlrev_b32 v28, 16, v112
    v_and_b32 v29, 0xffff0000, v112
    v_cvt_pk_bf16_f32 v112, v30, v31
    v_lshlrev_b32 v30, 16, v112
    v_and_b32 v31, 0xffff0000, v112
    v_mul_f32 v112, v28, v28
    v_fma_f32 v112, v112, s42, 1.0
    v_mul_f32 v112, v112, v28
    v_mul_f32 v112, s41, v112
    v_exp_f32 v112, v112
    v_mul_f32 v113, v29, v29
    v_fma_f32 v113, v113, s42, 1.0
    v_mul_f32 v113, v113, v29
    v_mul_f32 v113, s41, v113
    v_exp_f32 v113, v113
    v_mul_f32 v114, v30, v30
    v_fma_f32 v114, v114, s42, 1.0
    v_mul_f32 v114, v114, v30
    v_mul_f32 v114, s41, v114
    v_exp_f32 v114, v114
    v_mul_f32 v115, v31, v31
    v_fma_f32 v115, v115, s42, 1.0
    v_mul_f32 v115, v115, v31
    v_mul_f32 v115, s41, v115
    v_exp_f32 v115, v115
    s_nop 0
    v_add_f32 v112, 1.0, v112
    v_rcp_f32 v112, v112
    v_add_f32 v113, 1.0, v113
    v_rcp_f32 v113, v113
    v_add_f32 v114, 1.0, v114
    v_rcp_f32 v114, v114
    v_add_f32 v115, 1.0, v115
    v_rcp_f32 v115, v115
    s_nop 0
    v_mul_f32 v28, v28, v112
    v_mul_f32 v29, v29, v113
    v_mul_f32 v30, v30, v114
    v_mul_f32 v31, v31, v115
    v_cvt_pk_bf16_f32 v28, v28, v29
    v_cvt_pk_bf16_f32 v29, v30, v31
    ds_write_b64 v110, v[28:29] offset:112
    v_cvt_pk_bf16_f32 v112, v32, v33
    v_lshlrev_b32 v32, 16, v112
    v_and_b32 v33, 0xffff0000, v112
    v_cvt_pk_bf16_f32 v112, v34, v35
    v_lshlrev_b32 v34, 16, v112
    v_and_b32 v35, 0xffff0000, v112
    v_lshlrev_b32 v112, 16, v64
    v_and_b32 v113, 0xffff0000, v64
    v_lshlrev_b32 v114, 16, v65
    v_and_b32 v115, 0xffff0000, v65
    v_add_f32 v32, v32, v112
    v_add_f32 v33, v33, v113
    v_add_f32 v34, v34, v114
    v_add_f32 v35, v35, v115
    v_cvt_pk_bf16_f32 v112, v32, v33
    v_lshlrev_b32 v32, 16, v112
    v_and_b32 v33, 0xffff0000, v112
    v_cvt_pk_bf16_f32 v112, v34, v35
    v_lshlrev_b32 v34, 16, v112
    v_and_b32 v35, 0xffff0000, v112
    v_mul_f32 v112, v32, v32
    v_fma_f32 v112, v112, s42, 1.0
    v_mul_f32 v112, v112, v32
    v_mul_f32 v112, s41, v112
    v_exp_f32 v112, v112
    v_mul_f32 v113, v33, v33
    v_fma_f32 v113, v113, s42, 1.0
    v_mul_f32 v113, v113, v33
    v_mul_f32 v113, s41, v113
    v_exp_f32 v113, v113
    v_mul_f32 v114, v34, v34
    v_fma_f32 v114, v114, s42, 1.0
    v_mul_f32 v114, v114, v34
    v_mul_f32 v114, s41, v114
    v_exp_f32 v114, v114
    v_mul_f32 v115, v35, v35
    v_fma_f32 v115, v115, s42, 1.0
    v_mul_f32 v115, v115, v35
    v_mul_f32 v115, s41, v115
    v_exp_f32 v115, v115
    s_nop 0
    v_add_f32 v112, 1.0, v112
    v_rcp_f32 v112, v112
    v_add_f32 v113, 1.0, v113
    v_rcp_f32 v113, v113
    v_add_f32 v114, 1.0, v114
    v_rcp_f32 v114, v114
    v_add_f32 v115, 1.0, v115
    v_rcp_f32 v115, v115
    s_nop 0
    v_mul_f32 v32, v32, v112
    v_mul_f32 v33, v33, v113
    v_mul_f32 v34, v34, v114
    v_mul_f32 v35, v35, v115
    v_cvt_pk_bf16_f32 v32, v32, v33
    v_cvt_pk_bf16_f32 v33, v34, v35
    ds_write_b64 v110, v[32:33] offset:8704
    v_cvt_pk_bf16_f32 v112, v36, v37
    v_lshlrev_b32 v36, 16, v112
    v_and_b32 v37, 0xffff0000, v112
    v_cvt_pk_bf16_f32 v112, v38, v39
    v_lshlrev_b32 v38, 16, v112
    v_and_b32 v39, 0xffff0000, v112
    v_lshlrev_b32 v112, 16, v66
    v_and_b32 v113, 0xffff0000, v66
    v_lshlrev_b32 v114, 16, v67
    v_and_b32 v115, 0xffff0000, v67
    v_add_f32 v36, v36, v112
    v_add_f32 v37, v37, v113
    v_add_f32 v38, v38, v114
    v_add_f32 v39, v39, v115
    v_cvt_pk_bf16_f32 v112, v36, v37
    v_lshlrev_b32 v36, 16, v112
    v_and_b32 v37, 0xffff0000, v112
    v_cvt_pk_bf16_f32 v112, v38, v39
    v_lshlrev_b32 v38, 16, v112
    v_and_b32 v39, 0xffff0000, v112
    v_mul_f32 v112, v36, v36
    v_fma_f32 v112, v112, s42, 1.0
    v_mul_f32 v112, v112, v36
    v_mul_f32 v112, s41, v112
    v_exp_f32 v112, v112
    v_mul_f32 v113, v37, v37
    v_fma_f32 v113, v113, s42, 1.0
    v_mul_f32 v113, v113, v37
    v_mul_f32 v113, s41, v113
    v_exp_f32 v113, v113
    v_mul_f32 v114, v38, v38
    v_fma_f32 v114, v114, s42, 1.0
    v_mul_f32 v114, v114, v38
    v_mul_f32 v114, s41, v114
    v_exp_f32 v114, v114
    v_mul_f32 v115, v39, v39
    v_fma_f32 v115, v115, s42, 1.0
    v_mul_f32 v115, v115, v39
    v_mul_f32 v115, s41, v115
    v_exp_f32 v115, v115
    s_nop 0
    v_add_f32 v112, 1.0, v112
    v_rcp_f32 v112, v112
    v_add_f32 v113, 1.0, v113
    v_rcp_f32 v113, v113
    v_add_f32 v114, 1.0, v114
    v_rcp_f32 v114, v114
    v_add_f32 v115, 1.0, v115
    v_rcp_f32 v115, v115
    s_nop 0
    v_mul_f32 v36, v36, v112
    v_mul_f32 v37, v37, v113
    v_mul_f32 v38, v38, v114
    v_mul_f32 v39, v39, v115
    v_cvt_pk_bf16_f32 v36, v36, v37
    v_cvt_pk_bf16_f32 v37, v38, v39
    ds_write_b64 v110, v[36:37] offset:8720
    v_cvt_pk_bf16_f32 v112, v40, v41
    v_lshlrev_b32 v40, 16, v112
    v_and_b32 v41, 0xffff0000, v112
    v_cvt_pk_bf16_f32 v112, v42, v43
    v_lshlrev_b32 v42, 16, v112
    v_and_b32 v43, 0xffff0000, v112
    v_lshlrev_b32 v112, 16, v68
    v_and_b32 v113, 0xffff0000, v68
    v_lshlrev_b32 v114, 16, v69
    v_and_b32 v115, 0xffff0000, v69
    v_add_f32 v40, v40, v112
    v_add_f32 v41, v41, v113
    v_add_f32 v42, v42, v114
    v_add_f32 v43, v43, v115
    v_cvt_pk_bf16_f32 v112, v40, v41
    v_lshlrev_b32 v40, 16, v112
    v_and_b32 v41, 0xffff0000, v112
    v_cvt_pk_bf16_f32 v112, v42, v43
    v_lshlrev_b32 v42, 16, v112
    v_and_b32 v43, 0xffff0000, v112
    v_mul_f32 v112, v40, v40
    v_fma_f32 v112, v112, s42, 1.0
    v_mul_f32 v112, v112, v40
    v_mul_f32 v112, s41, v112
    v_exp_f32 v112, v112
    v_mul_f32 v113, v41, v41
    v_fma_f32 v113, v113, s42, 1.0
    v_mul_f32 v113, v113, v41
    v_mul_f32 v113, s41, v113
    v_exp_f32 v113, v113
    v_mul_f32 v114, v42, v42
    v_fma_f32 v114, v114, s42, 1.0
    v_mul_f32 v114, v114, v42
    v_mul_f32 v114, s41, v114
    v_exp_f32 v114, v114
    v_mul_f32 v115, v43, v43
    v_fma_f32 v115, v115, s42, 1.0
    v_mul_f32 v115, v115, v43
    v_mul_f32 v115, s41, v115
    v_exp_f32 v115, v115
    s_nop 0
    v_add_f32 v112, 1.0, v112
    v_rcp_f32 v112, v112
    v_add_f32 v113, 1.0, v113
    v_rcp_f32 v113, v113
    v_add_f32 v114, 1.0, v114
    v_rcp_f32 v114, v114
    v_add_f32 v115, 1.0, v115
    v_rcp_f32 v115, v115
    s_nop 0
    v_mul_f32 v40, v40, v112
    v_mul_f32 v41, v41, v113
    v_mul_f32 v42, v42, v114
    v_mul_f32 v43, v43, v115
    v_cvt_pk_bf16_f32 v40, v40, v41
    v_cvt_pk_bf16_f32 v41, v42, v43
    ds_write_b64 v110, v[40:41] offset:8736
    v_cvt_pk_bf16_f32 v112, v44, v45
    v_lshlrev_b32 v44, 16, v112
    v_and_b32 v45, 0xffff0000, v112
    v_cvt_pk_bf16_f32 v112, v46, v47
    v_lshlrev_b32 v46, 16, v112
    v_and_b32 v47, 0xffff0000, v112
    v_lshlrev_b32 v112, 16, v70
    v_and_b32 v113, 0xffff0000, v70
    v_lshlrev_b32 v114, 16, v71
    v_and_b32 v115, 0xffff0000, v71
    v_add_f32 v44, v44, v112
    v_add_f32 v45, v45, v113
    v_add_f32 v46, v46, v114
    v_add_f32 v47, v47, v115
    v_cvt_pk_bf16_f32 v112, v44, v45
    v_lshlrev_b32 v44, 16, v112
    v_and_b32 v45, 0xffff0000, v112
    v_cvt_pk_bf16_f32 v112, v46, v47
    v_lshlrev_b32 v46, 16, v112
    v_and_b32 v47, 0xffff0000, v112
    v_mul_f32 v112, v44, v44
    v_fma_f32 v112, v112, s42, 1.0
    v_mul_f32 v112, v112, v44
    v_mul_f32 v112, s41, v112
    v_exp_f32 v112, v112
    v_mul_f32 v113, v45, v45
    v_fma_f32 v113, v113, s42, 1.0
    v_mul_f32 v113, v113, v45
    v_mul_f32 v113, s41, v113
    v_exp_f32 v113, v113
    v_mul_f32 v114, v46, v46
    v_fma_f32 v114, v114, s42, 1.0
    v_mul_f32 v114, v114, v46
    v_mul_f32 v114, s41, v114
    v_exp_f32 v114, v114
    v_mul_f32 v115, v47, v47
    v_fma_f32 v115, v115, s42, 1.0
    v_mul_f32 v115, v115, v47
    v_mul_f32 v115, s41, v115
    v_exp_f32 v115, v115
    s_nop 0
    v_add_f32 v112, 1.0, v112
    v_rcp_f32 v112, v112
    v_add_f32 v113, 1.0, v113
    v_rcp_f32 v113, v113
    v_add_f32 v114, 1.0, v114
    v_rcp_f32 v114, v114
    v_add_f32 v115, 1.0, v115
    v_rcp_f32 v115, v115
    s_nop 0
    v_mul_f32 v44, v44, v112
    v_mul_f32 v45, v45, v113
    v_mul_f32 v46, v46, v114
    v_mul_f32 v47, v47, v115
    v_cvt_pk_bf16_f32 v44, v44, v45
    v_cvt_pk_bf16_f32 v45, v46, v47
    ds_write_b64 v110, v[44:45] offset:8752
    v_cvt_pk_bf16_f32 v112, v48, v49
    v_lshlrev_b32 v48, 16, v112
    v_and_b32 v49, 0xffff0000, v112
    v_cvt_pk_bf16_f32 v112, v50, v51
    v_lshlrev_b32 v50, 16, v112
    v_and_b32 v51, 0xffff0000, v112
    v_lshlrev_b32 v112, 16, v72
    v_and_b32 v113, 0xffff0000, v72
    v_lshlrev_b32 v114, 16, v73
    v_and_b32 v115, 0xffff0000, v73
    v_add_f32 v48, v48, v112
    v_add_f32 v49, v49, v113
    v_add_f32 v50, v50, v114
    v_add_f32 v51, v51, v115
    v_cvt_pk_bf16_f32 v112, v48, v49
    v_lshlrev_b32 v48, 16, v112
    v_and_b32 v49, 0xffff0000, v112
    v_cvt_pk_bf16_f32 v112, v50, v51
    v_lshlrev_b32 v50, 16, v112
    v_and_b32 v51, 0xffff0000, v112
    v_mul_f32 v112, v48, v48
    v_fma_f32 v112, v112, s42, 1.0
    v_mul_f32 v112, v112, v48
    v_mul_f32 v112, s41, v112
    v_exp_f32 v112, v112
    v_mul_f32 v113, v49, v49
    v_fma_f32 v113, v113, s42, 1.0
    v_mul_f32 v113, v113, v49
    v_mul_f32 v113, s41, v113
    v_exp_f32 v113, v113
    v_mul_f32 v114, v50, v50
    v_fma_f32 v114, v114, s42, 1.0
    v_mul_f32 v114, v114, v50
    v_mul_f32 v114, s41, v114
    v_exp_f32 v114, v114
    v_mul_f32 v115, v51, v51
    v_fma_f32 v115, v115, s42, 1.0
    v_mul_f32 v115, v115, v51
    v_mul_f32 v115, s41, v115
    v_exp_f32 v115, v115
    s_nop 0
    v_add_f32 v112, 1.0, v112
    v_rcp_f32 v112, v112
    v_add_f32 v113, 1.0, v113
    v_rcp_f32 v113, v113
    v_add_f32 v114, 1.0, v114
    v_rcp_f32 v114, v114
    v_add_f32 v115, 1.0, v115
    v_rcp_f32 v115, v115
    s_nop 0
    v_mul_f32 v48, v48, v112
    v_mul_f32 v49, v49, v113
    v_mul_f32 v50, v50, v114
    v_mul_f32 v51, v51, v115
    v_cvt_pk_bf16_f32 v48, v48, v49
    v_cvt_pk_bf16_f32 v49, v50, v51
    ds_write_b64 v110, v[48:49] offset:8768
    v_cvt_pk_bf16_f32 v112, v52, v53
    v_lshlrev_b32 v52, 16, v112
    v_and_b32 v53, 0xffff0000, v112
    v_cvt_pk_bf16_f32 v112, v54, v55
    v_lshlrev_b32 v54, 16, v112
    v_and_b32 v55, 0xffff0000, v112
    v_lshlrev_b32 v112, 16, v74
    v_and_b32 v113, 0xffff0000, v74
    v_lshlrev_b32 v114, 16, v75
    v_and_b32 v115, 0xffff0000, v75
    v_add_f32 v52, v52, v112
    v_add_f32 v53, v53, v113
    v_add_f32 v54, v54, v114
    v_add_f32 v55, v55, v115
    v_cvt_pk_bf16_f32 v112, v52, v53
    v_lshlrev_b32 v52, 16, v112
    v_and_b32 v53, 0xffff0000, v112
    v_cvt_pk_bf16_f32 v112, v54, v55
    v_lshlrev_b32 v54, 16, v112
    v_and_b32 v55, 0xffff0000, v112
    v_mul_f32 v112, v52, v52
    v_fma_f32 v112, v112, s42, 1.0
    v_mul_f32 v112, v112, v52
    v_mul_f32 v112, s41, v112
    v_exp_f32 v112, v112
    v_mul_f32 v113, v53, v53
    v_fma_f32 v113, v113, s42, 1.0
    v_mul_f32 v113, v113, v53
    v_mul_f32 v113, s41, v113
    v_exp_f32 v113, v113
    v_mul_f32 v114, v54, v54
    v_fma_f32 v114, v114, s42, 1.0
    v_mul_f32 v114, v114, v54
    v_mul_f32 v114, s41, v114
    v_exp_f32 v114, v114
    v_mul_f32 v115, v55, v55
    v_fma_f32 v115, v115, s42, 1.0
    v_mul_f32 v115, v115, v55
    v_mul_f32 v115, s41, v115
    v_exp_f32 v115, v115
    s_nop 0
    v_add_f32 v112, 1.0, v112
    v_rcp_f32 v112, v112
    v_add_f32 v113, 1.0, v113
    v_rcp_f32 v113, v113
    v_add_f32 v114, 1.0, v114
    v_rcp_f32 v114, v114
    v_add_f32 v115, 1.0, v115
    v_rcp_f32 v115, v115
    s_nop 0
    v_mul_f32 v52, v52, v112
    v_mul_f32 v53, v53, v113
    v_mul_f32 v54, v54, v114
    v_mul_f32 v55, v55, v115
    v_cvt_pk_bf16_f32 v52, v52, v53
    v_cvt_pk_bf16_f32 v53, v54, v55
    ds_write_b64 v110, v[52:53] offset:8784
    v_cvt_pk_bf16_f32 v112, v56, v57
    v_lshlrev_b32 v56, 16, v112
    v_and_b32 v57, 0xffff0000, v112
    v_cvt_pk_bf16_f32 v112, v58, v59
    v_lshlrev_b32 v58, 16, v112
    v_and_b32 v59, 0xffff0000, v112
    v_lshlrev_b32 v112, 16, v76
    v_and_b32 v113, 0xffff0000, v76
    v_lshlrev_b32 v114, 16, v77
    v_and_b32 v115, 0xffff0000, v77
    v_add_f32 v56, v56, v112
    v_add_f32 v57, v57, v113
    v_add_f32 v58, v58, v114
    v_add_f32 v59, v59, v115
    v_cvt_pk_bf16_f32 v112, v56, v57
    v_lshlrev_b32 v56, 16, v112
    v_and_b32 v57, 0xffff0000, v112
    v_cvt_pk_bf16_f32 v112, v58, v59
    v_lshlrev_b32 v58, 16, v112
    v_and_b32 v59, 0xffff0000, v112
    v_mul_f32 v112, v56, v56
    v_fma_f32 v112, v112, s42, 1.0
    v_mul_f32 v112, v112, v56
    v_mul_f32 v112, s41, v112
    v_exp_f32 v112, v112
    v_mul_f32 v113, v57, v57
    v_fma_f32 v113, v113, s42, 1.0
    v_mul_f32 v113, v113, v57
    v_mul_f32 v113, s41, v113
    v_exp_f32 v113, v113
    v_mul_f32 v114, v58, v58
    v_fma_f32 v114, v114, s42, 1.0
    v_mul_f32 v114, v114, v58
    v_mul_f32 v114, s41, v114
    v_exp_f32 v114, v114
    v_mul_f32 v115, v59, v59
    v_fma_f32 v115, v115, s42, 1.0
    v_mul_f32 v115, v115, v59
    v_mul_f32 v115, s41, v115
    v_exp_f32 v115, v115
    s_nop 0
    v_add_f32 v112, 1.0, v112
    v_rcp_f32 v112, v112
    v_add_f32 v113, 1.0, v113
    v_rcp_f32 v113, v113
    v_add_f32 v114, 1.0, v114
    v_rcp_f32 v114, v114
    v_add_f32 v115, 1.0, v115
    v_rcp_f32 v115, v115
    s_nop 0
    v_mul_f32 v56, v56, v112
    v_mul_f32 v57, v57, v113
    v_mul_f32 v58, v58, v114
    v_mul_f32 v59, v59, v115
    v_cvt_pk_bf16_f32 v56, v56, v57
    v_cvt_pk_bf16_f32 v57, v58, v59
    ds_write_b64 v110, v[56:57] offset:8800
    v_cvt_pk_bf16_f32 v112, v60, v61
    v_lshlrev_b32 v60, 16, v112
    v_and_b32 v61, 0xffff0000, v112
    v_cvt_pk_bf16_f32 v112, v62, v63
    v_lshlrev_b32 v62, 16, v112
    v_and_b32 v63, 0xffff0000, v112
    v_lshlrev_b32 v112, 16, v78
    v_and_b32 v113, 0xffff0000, v78
    v_lshlrev_b32 v114, 16, v79
    v_and_b32 v115, 0xffff0000, v79
    v_add_f32 v60, v60, v112
    v_add_f32 v61, v61, v113
    v_add_f32 v62, v62, v114
    v_add_f32 v63, v63, v115
    v_cvt_pk_bf16_f32 v112, v60, v61
    v_lshlrev_b32 v60, 16, v112
    v_and_b32 v61, 0xffff0000, v112
    v_cvt_pk_bf16_f32 v112, v62, v63
    v_lshlrev_b32 v62, 16, v112
    v_and_b32 v63, 0xffff0000, v112
    v_mul_f32 v112, v60, v60
    v_fma_f32 v112, v112, s42, 1.0
    v_mul_f32 v112, v112, v60
    v_mul_f32 v112, s41, v112
    v_exp_f32 v112, v112
    v_mul_f32 v113, v61, v61
    v_fma_f32 v113, v113, s42, 1.0
    v_mul_f32 v113, v113, v61
    v_mul_f32 v113, s41, v113
    v_exp_f32 v113, v113
    v_mul_f32 v114, v62, v62
    v_fma_f32 v114, v114, s42, 1.0
    v_mul_f32 v114, v114, v62
    v_mul_f32 v114, s41, v114
    v_exp_f32 v114, v114
    v_mul_f32 v115, v63, v63
    v_fma_f32 v115, v115, s42, 1.0
    v_mul_f32 v115, v115, v63
    v_mul_f32 v115, s41, v115
    v_exp_f32 v115, v115
    s_nop 0
    v_add_f32 v112, 1.0, v112
    v_rcp_f32 v112, v112
    v_add_f32 v113, 1.0, v113
    v_rcp_f32 v113, v113
    v_add_f32 v114, 1.0, v114
    v_rcp_f32 v114, v114
    v_add_f32 v115, 1.0, v115
    v_rcp_f32 v115, v115
    s_nop 0
    v_mul_f32 v60, v60, v112
    v_mul_f32 v61, v61, v113
    v_mul_f32 v62, v62, v114
    v_mul_f32 v63, v63, v115
    v_cvt_pk_bf16_f32 v60, v60, v61
    v_cvt_pk_bf16_f32 v61, v62, v63
    ds_write_b64 v110, v[60:61] offset:8816
    s_waitcnt lgkmcnt(0)
    s_barrier
    s_lshl_b32 s32, s28, 6
    v_add_u32 v116, s32, v118
    v_lshrrev_b32 v110, 4, v116
    v_and_b32 v111, 15, v116
    v_mul_u32_u24 v112, 272, v110
    v_lshl_add_u32 v112, v111, 4, v112
    s_mov_b32 s33, 2752
    v_mul_lo_u32 v113, v110, s33
    v_lshl_add_u32 v113, v111, 4, v113
    s_lshl_b32 s32, s30, 7
    v_lshlrev_b32 v114, 3, v111
    v_add_u32 v114, s32, v114
    v_cmp_gt_u32 vcc, 1376, v114
    s_and_saveexec_b64 s[44:45], vcc
    s_cbranch_execz ffn1_kernel_done
    ds_read_b128 v[0:3], v112 offset:0
    ds_read_b128 v[4:7], v112 offset:4352
    ds_read_b128 v[8:11], v112 offset:8704
    ds_read_b128 v[12:15], v112 offset:13056
    ds_read_b128 v[16:19], v112 offset:17408
    ds_read_b128 v[20:23], v112 offset:21760
    ds_read_b128 v[24:27], v112 offset:26112
    ds_read_b128 v[28:31], v112 offset:30464
    s_waitcnt vmcnt(0) lgkmcnt(0)
    s_mov_b32 s32, 0
    buffer_store_dwordx4 v[0:3], v113, s[16:19], s32 offen
    s_mov_b32 s32, 44032
    buffer_store_dwordx4 v[4:7], v113, s[16:19], s32 offen
    s_mov_b32 s32, 88064
    buffer_store_dwordx4 v[8:11], v113, s[16:19], s32 offen
    s_mov_b32 s32, 132096
    buffer_store_dwordx4 v[12:15], v113, s[16:19], s32 offen
    s_mov_b32 s32, 176128
    buffer_store_dwordx4 v[16:19], v113, s[16:19], s32 offen
    s_mov_b32 s32, 220160
    buffer_store_dwordx4 v[20:23], v113, s[16:19], s32 offen
    s_mov_b32 s32, 264192
    buffer_store_dwordx4 v[24:27], v113, s[16:19], s32 offen
    s_mov_b32 s32, 308224
    buffer_store_dwordx4 v[28:31], v113, s[16:19], s32 offen
ffn1_kernel_done:
    s_endpgm
.section .rodata,"a"
.p2align 6
.amdhsa_kernel ffn1_kernel
  .amdhsa_next_free_vgpr 143
  .amdhsa_next_free_sgpr 48
  .amdhsa_accum_offset 144
  .amdhsa_group_segment_fixed_size 0
  .amdhsa_kernarg_size 112
  .amdhsa_user_sgpr_count 2
  .amdhsa_user_sgpr_kernarg_segment_ptr 1
  .amdhsa_system_sgpr_workgroup_id_x 1
.end_amdhsa_kernel
.text
.globl ffn2_kernel
.p2align 8
.type ffn2_kernel,@function
ffn2_kernel:
    s_cmp_ge_u32 s2, 128
    s_cbranch_scc1 ffn2_kernel_done
    v_and_b32 v76, 63, v0
    v_lshrrev_b32 v68, 6, v0
    s_nop 0
    v_readfirstlane_b32 s28, v68
    s_mov_b32 s31, 0
    s_lshr_b32 s29, s2, 2
    s_and_b32 s30, s2, 3
    s_load_dwordx2 s[4:5], s[0:1], 104
    s_load_dwordx2 s[6:7], s[0:1], 72
    s_load_dwordx2 s[42:43], s[0:1], 80
    s_load_dwordx2 s[44:45], s[0:1], 88
    s_waitcnt lgkmcnt(0)
    s_mul_i32 s32, s29, 176128
    s_add_u32 s32, s32, 0x600000
    s_sub_u32 s33, 0xb60000, s32
    s_add_u32 s8, s4, s32
    s_addc_u32 s9, s5, 0
    s_and_b32 s9, s9, 0xffff
    s_mov_b32 s10, s33
    s_mov_b32 s11, 0x00020000
    s_lshl_b32 s32, s30, 8
    s_sub_u32 s33, 0x158000, s32
    s_add_u32 s12, s6, s32
    s_addc_u32 s13, s7, 0
    s_and_b32 s13, s13, 0xffff
    s_mov_b32 s14, s33
    s_mov_b32 s15, 0x00020000
    s_lshl_b32 s32, s29, 16
    s_lshl_b32 s33, s30, 8
    s_add_u32 s32, s32, s33
    s_sub_u32 s33, 0x200000, s32
    s_add_u32 s16, s44, s32
    s_addc_u32 s17, s45, 0
    s_and_b32 s17, s17, 0xffff
    s_mov_b32 s18, s33
    s_mov_b32 s19, 0x00020000
    s_add_u32 s32, s32, 0x400000
    s_sub_u32 s33, 0x600000, s32
    s_add_u32 s24, s4, s32
    s_addc_u32 s25, s5, 0
    s_and_b32 s25, s25, 0xffff
    s_mov_b32 s26, s33
    s_mov_b32 s27, 0x00020000
    s_lshl_b32 s32, s30, 8
    s_sub_u32 s33, 0x400, s32
    s_add_u32 s20, s42, s32
    s_addc_u32 s21, s43, 0
    s_and_b32 s21, s21, 0xffff
    s_mov_b32 s22, s33
    s_mov_b32 s23, 0x00020000
    s_mul_i32 s32, s28, 2
    s_add_u32 s32, s32, 0
    v_lshrrev_b32 v68, 3, v76
    s_lshl_b32 s33, s32, 3
    v_add_u32 v68, s33, v68
    v_lshrrev_b32 v69, 1, v68
    v_and_b32 v69, 7, v69
    v_and_b32 v70, 7, v76
    v_xor_b32 v69, v69, v70
    v_lshlrev_b32 v69, 4, v69
    s_mov_b32 s33, 2752
    v_mul_lo_u32 v56, v68, s33
    v_add_u32 v56, v56, v69
    s_mul_i32 s32, s28, 2
    s_add_u32 s32, s32, 1
    v_lshrrev_b32 v68, 3, v76
    s_lshl_b32 s33, s32, 3
    v_add_u32 v68, s33, v68
    v_lshrrev_b32 v69, 1, v68
    v_and_b32 v69, 7, v69
    v_and_b32 v70, 7, v76
    v_xor_b32 v69, v69, v70
    v_lshlrev_b32 v69, 4, v69
    s_mov_b32 s33, 2752
    v_mul_lo_u32 v57, v68, s33
    v_add_u32 v57, v57, v69
    s_lshl_b32 s32, s28, 2
    s_add_u32 s32, s32, 0
    v_lshrrev_b32 v68, 4, v76
    v_lshlrev_b32 v69, 2, v68
    s_lshl_b32 s33, s32, 2
    v_add_u32 v68, s33, v68
    v_and_b32 v70, 15, v76
    v_xor_b32 v69, v69, v70
    v_lshlrev_b32 v69, 4, v69
    s_mov_b32 s33, 1024
    v_mul_lo_u32 v58, v68, s33
    v_add_u32 v58, v58, v69
    s_lshl_b32 s32, s28, 2
    s_add_u32 s32, s32, 1
    v_lshrrev_b32 v68, 4, v76
    v_lshlrev_b32 v69, 2, v68
    s_lshl_b32 s33, s32, 2
    v_add_u32 v68, s33, v68
    v_and_b32 v70, 15, v76
    v_xor_b32 v69, v69, v70
    v_lshlrev_b32 v69, 4, v69
    s_mov_b32 s33, 1024
    v_mul_lo_u32 v59, v68, s33
    v_add_u32 v59, v59, v69
    s_lshl_b32 s32, s28, 2
    s_add_u32 s32, s32, 2
    v_lshrrev_b32 v68, 4, v76
    v_lshlrev_b32 v69, 2, v68
    s_lshl_b32 s33, s32, 2
    v_add_u32 v68, s33, v68
    v_and_b32 v70, 15, v76
    v_xor_b32 v69, v69, v70
    v_lshlrev_b32 v69, 4, v69
    s_mov_b32 s33, 1024
    v_mul_lo_u32 v60, v68, s33
    v_add_u32 v60, v60, v69
    s_lshl_b32 s32, s28, 2
    s_add_u32 s32, s32, 3
    v_lshrrev_b32 v68, 4, v76
    v_lshlrev_b32 v69, 2, v68
    s_lshl_b32 s33, s32, 2
    v_add_u32 v68, s33, v68
    v_and_b32 v70, 15, v76
    v_xor_b32 v69, v69, v70
    v_lshlrev_b32 v69, 4, v69
    s_mov_b32 s33, 1024
    v_mul_lo_u32 v61, v68, s33
    v_add_u32 v61, v61, v69
    s_lshr_b32 s34, s28, 1
    s_and_b32 s35, s28, 1
    v_and_b32 v68, 31, v76
    s_mul_i32 s32, s34, 32
    v_add_u32 v68, s32, v68
    v_lshrrev_b32 v69, 1, v68
    v_and_b32 v69, 7, v69
    v_lshrrev_b32 v70, 5, v76
    v_xor_b32 v69, v69, v70
    v_lshlrev_b32 v69, 4, v69
    v_lshl_add_u32 v62, v68, 7, v69
    v_xor_b32 v63, 32, v62
    v_xor_b32 v64, 64, v62
    v_xor_b32 v65, 96, v62
    v_lshrrev_b32 v68, 5, v76
    v_lshlrev_b32 v68, 3, v68
    v_bfe_u32 v69, v76, 2, 2
    v_add_u32 v68, v68, v69
    v_lshlrev_b32 v68, 8, v68
    v_bfe_u32 v70, v76, 4, 1
    v_lshlrev_b32 v70, 5, v70
    v_and_b32 v71, 3, v76
    v_lshl_add_u32 v70, v71, 3, v70
    v_add_u32 v68, v68, v70
    s_lshl_b32 s32, s35, 1
    s_add_u32 s32, s32, 0
    v_xor_b32 v71, s32, v69
    v_lshl_add_u32 v66, v71, 6, v68
    s_lshl_b32 s32, s35, 1
    s_add_u32 s32, s32, 1
    v_xor_b32 v71, s32, v69
    v_lshl_add_u32 v67, v71, 6, v68
    v_mov_b32 v0, 0
    v_mov_b32 v1, 0
    v_mov_b32 v2, 0
    v_mov_b32 v3, 0
    v_mov_b32 v4, 0
    v_mov_b32 v5, 0
    v_mov_b32 v6, 0
    v_mov_b32 v7, 0
    v_mov_b32 v8, 0
    v_mov_b32 v9, 0
    v_mov_b32 v10, 0
    v_mov_b32 v11, 0
    v_mov_b32 v12, 0
    v_mov_b32 v13, 0
    v_mov_b32 v14, 0
    v_mov_b32 v15, 0
    v_mov_b32 v16, 0
    v_mov_b32 v17, 0
    v_mov_b32 v18, 0
    v_mov_b32 v19, 0
    v_mov_b32 v20, 0
    v_mov_b32 v21, 0
    v_mov_b32 v22, 0
    v_mov_b32 v23, 0
    v_mov_b32 v24, 0
    v_mov_b32 v25, 0
    v_mov_b32 v26, 0
    v_mov_b32 v27, 0
    v_mov_b32 v28, 0
    v_mov_b32 v29, 0
    v_mov_b32 v30, 0
    v_mov_b32 v31, 0
    s_mul_i32 s36, s28, 2048
    s_lshl_b32 s37, s28, 12
    s_add_u32 s37, s37, 8192
    s_mov_b32 s38, 0
    s_mov_b32 s39, 0
    s_add_u32 m0, s36, 0
    s_nop 0
    buffer_load_dwordx4 v56, s[8:11], s38 offen lds
    s_add_u32 m0, s36, 1024
    s_nop 0
    buffer_load_dwordx4 v57, s[8:11], s38 offen lds
    s_add_u32 m0, s37, 0
    s_nop 0
    buffer_load_dwordx4 v58, s[12:15], s39 offen lds
    s_add_u32 m0, s37, 1024
    s_nop 0
    buffer_load_dwordx4 v59, s[12:15], s39 offen lds
    s_add_u32 m0, s37, 2048
    s_nop 0
    buffer_load_dwordx4 v60, s[12:15], s39 offen lds
    s_add_u32 m0, s37, 3072
    s_nop 0
    buffer_load_dwordx4 v61, s[12:15], s39 offen lds
    s_add_u32 s38, s38, 128
    s_add_u32 s39, s39, 65536
    s_waitcnt vmcnt(0)
    s_barrier
    s_add_u32 m0, s36, 24576
    s_nop 0
    buffer_load_dwordx4 v56, s[8:11], s38 offen lds
    s_add_u32 m0, s36, 25600
    s_nop 0
    buffer_load_dwordx4 v57, s[8:11], s38 offen lds
    s_add_u32 m0, s37, 24576
    s_nop 0
    buffer_load_dwordx4 v58, s[12:15], s39 offen lds
    s_add_u32 m0, s37, 25600
    s_nop 0
    buffer_load_dwordx4 v59, s[12:15], s39 offen lds
    s_add_u32 m0, s37, 26624
    s_nop 0
    buffer_load_dwordx4 v60, s[12:15], s39 offen lds
    s_add_u32 m0, s37, 27648
    s_nop 0
    buffer_load_dwordx4 v61, s[12:15], s39 offen lds
    s_add_u32 s38, s38, 128
    s_add_u32 s39, s39, 65536
    ds_read_b128 v[32:35], v62 offset:0
    ds_read_b64_tr_b16 v[36:37], v66 offset:8192
    ds_read_b64_tr_b16 v[38:39], v66 offset:9216
    ds_read_b64_tr_b16 v[40:41], v67 offset:8192
    ds_read_b64_tr_b16 v[42:43], v67 offset:9216
    ds_read_b128 v[44:47], v63 offset:0
    ds_read_b64_tr_b16 v[48:49], v66 offset:12288
    ds_read_b64_tr_b16 v[50:51], v66 offset:13312
    ds_read_b64_tr_b16 v[52:53], v67 offset:12288
    ds_read_b64_tr_b16 v[54:55], v67 offset:13312
    s_waitcnt lgkmcnt(5)
    v_mfma_f32_32x32x16_bf16 v[0:15], v[36:39], v[32:35], v[0:15]
    v_mfma_f32_32x32x16_bf16 v[16:31], v[40:43], v[32:35], v[16:31]
    ds_read_b128 v[32:35], v64 offset:0
    ds_read_b64_tr_b16 v[36:37], v66 offset:16384
    ds_read_b64_tr_b16 v[38:39], v66 offset:17408
    ds_read_b64_tr_b16 v[40:41], v67 offset:16384
    ds_read_b64_tr_b16 v[42:43], v67 offset:17408
    s_waitcnt lgkmcnt(5)
    v_mfma_f32_32x32x16_bf16 v[0:15], v[48:51], v[44:47], v[0:15]
    v_mfma_f32_32x32x16_bf16 v[16:31], v[52:55], v[44:47], v[16:31]
    ds_read_b128 v[44:47], v65 offset:0
    ds_read_b64_tr_b16 v[48:49], v66 offset:20480
    ds_read_b64_tr_b16 v[50:51], v66 offset:21504
    ds_read_b64_tr_b16 v[52:53], v67 offset:20480
    ds_read_b64_tr_b16 v[54:55], v67 offset:21504
    s_waitcnt lgkmcnt(5)
    v_mfma_f32_32x32x16_bf16 v[0:15], v[36:39], v[32:35], v[0:15]
    v_mfma_f32_32x32x16_bf16 v[16:31], v[40:43], v[32:35], v[16:31]
    s_waitcnt lgkmcnt(0)
    v_mfma_f32_32x32x16_bf16 v[0:15], v[48:51], v[44:47], v[0:15]
    v_mfma_f32_32x32x16_bf16 v[16:31], v[52:55], v[44:47], v[16:31]
    s_waitcnt vmcnt(0)
    s_barrier
    s_add_u32 m0, s36, 0
    s_nop 0
    buffer_load_dwordx4 v56, s[8:11], s38 offen lds
    s_add_u32 m0, s36, 1024
    s_nop 0
    buffer_load_dwordx4 v57, s[8:11], s38 offen lds
    s_add_u32 m0, s37, 0
    s_nop 0
    buffer_load_dwordx4 v58, s[12:15], s39 offen lds
    s_add_u32 m0, s37, 1024
    s_nop 0
    buffer_load_dwordx4 v59, s[12:15], s39 offen lds
    s_add_u32 m0, s37, 2048
    s_nop 0
    buffer_load_dwordx4 v60, s[12:15], s39 offen lds
    s_add_u32 m0, s37, 3072
    s_nop 0
    buffer_load_dwordx4 v61, s[12:15], s39 offen lds
    s_add_u32 s38, s38, 128
    s_add_u32 s39, s39, 65536
    ds_read_b128 v[32:35], v62 offset:24576
    ds_read_b64_tr_b16 v[36:37], v66 offset:32768
    ds_read_b64_tr_b16 v[38:39], v66 offset:33792
    ds_read_b64_tr_b16 v[40:41], v67 offset:32768
    ds_read_b64_tr_b16 v[42:43], v67 offset:33792
    ds_read_b128 v[44:47], v63 offset:24576
    ds_read_b64_tr_b16 v[48:49], v66 offset:36864
    ds_read_b64_tr_b16 v[50:51], v66 offset:37888
    ds_read_b64_tr_b16 v[52:53], v67 offset:36864
    ds_read_b64_tr_b16 v[54:55], v67 offset:37888
    s_waitcnt lgkmcnt(5)
    v_mfma_f32_32x32x16_bf16 v[0:15], v[36:39], v[32:35], v[0:15]
    v_mfma_f32_32x32x16_bf16 v[16:31], v[40:43], v[32:35], v[16:31]
    ds_read_b128 v[32:35], v64 offset:24576
    ds_read_b64_tr_b16 v[36:37], v66 offset:40960
    ds_read_b64_tr_b16 v[38:39], v66 offset:41984
    ds_read_b64_tr_b16 v[40:41], v67 offset:40960
    ds_read_b64_tr_b16 v[42:43], v67 offset:41984
    s_waitcnt lgkmcnt(5)
    v_mfma_f32_32x32x16_bf16 v[0:15], v[48:51], v[44:47], v[0:15]
    v_mfma_f32_32x32x16_bf16 v[16:31], v[52:55], v[44:47], v[16:31]
    ds_read_b128 v[44:47], v65 offset:24576
    ds_read_b64_tr_b16 v[48:49], v66 offset:45056
    ds_read_b64_tr_b16 v[50:51], v66 offset:46080
    ds_read_b64_tr_b16 v[52:53], v67 offset:45056
    ds_read_b64_tr_b16 v[54:55], v67 offset:46080
    s_waitcnt lgkmcnt(5)
    v_mfma_f32_32x32x16_bf16 v[0:15], v[36:39], v[32:35], v[0:15]
    v_mfma_f32_32x32x16_bf16 v[16:31], v[40:43], v[32:35], v[16:31]
    s_waitcnt lgkmcnt(0)
    v_mfma_f32_32x32x16_bf16 v[0:15], v[48:51], v[44:47], v[0:15]
    v_mfma_f32_32x32x16_bf16 v[16:31], v[52:55], v[44:47], v[16:31]
    s_waitcnt vmcnt(0)
    s_barrier
    s_add_u32 m0, s36, 24576
    s_nop 0
    buffer_load_dwordx4 v56, s[8:11], s38 offen lds
    s_add_u32 m0, s36, 25600
    s_nop 0
    buffer_load_dwordx4 v57, s[8:11], s38 offen lds
    s_add_u32 m0, s37, 24576
    s_nop 0
    buffer_load_dwordx4 v58, s[12:15], s39 offen lds
    s_add_u32 m0, s37, 25600
    s_nop 0
    buffer_load_dwordx4 v59, s[12:15], s39 offen lds
    s_add_u32 m0, s37, 26624
    s_nop 0
    buffer_load_dwordx4 v60, s[12:15], s39 offen lds
    s_add_u32 m0, s37, 27648
    s_nop 0
    buffer_load_dwordx4 v61, s[12:15], s39 offen lds
    s_add_u32 s38, s38, 128
    s_add_u32 s39, s39, 65536
    ds_read_b128 v[32:35], v62 offset:0
    ds_read_b64_tr_b16 v[36:37], v66 offset:8192
    ds_read_b64_tr_b16 v[38:39], v66 offset:9216
    ds_read_b64_tr_b16 v[40:41], v67 offset:8192
    ds_read_b64_tr_b16 v[42:43], v67 offset:9216
    ds_read_b128 v[44:47], v63 offset:0
    ds_read_b64_tr_b16 v[48:49], v66 offset:12288
    ds_read_b64_tr_b16 v[50:51], v66 offset:13312
    ds_read_b64_tr_b16 v[52:53], v67 offset:12288
    ds_read_b64_tr_b16 v[54:55], v67 offset:13312
    s_waitcnt lgkmcnt(5)
    v_mfma_f32_32x32x16_bf16 v[0:15], v[36:39], v[32:35], v[0:15]
    v_mfma_f32_32x32x16_bf16 v[16:31], v[40:43], v[32:35], v[16:31]
    ds_read_b128 v[32:35], v64 offset:0
    ds_read_b64_tr_b16 v[36:37], v66 offset:16384
    ds_read_b64_tr_b16 v[38:39], v66 offset:17408
    ds_read_b64_tr_b16 v[40:41], v67 offset:16384
    ds_read_b64_tr_b16 v[42:43], v67 offset:17408
    s_waitcnt lgkmcnt(5)
    v_mfma_f32_32x32x16_bf16 v[0:15], v[48:51], v[44:47], v[0:15]
    v_mfma_f32_32x32x16_bf16 v[16:31], v[52:55], v[44:47], v[16:31]
    ds_read_b128 v[44:47], v65 offset:0
    ds_read_b64_tr_b16 v[48:49], v66 offset:20480
    ds_read_b64_tr_b16 v[50:51], v66 offset:21504
    ds_read_b64_tr_b16 v[52:53], v67 offset:20480
    ds_read_b64_tr_b16 v[54:55], v67 offset:21504
    s_waitcnt lgkmcnt(5)
    v_mfma_f32_32x32x16_bf16 v[0:15], v[36:39], v[32:35], v[0:15]
    v_mfma_f32_32x32x16_bf16 v[16:31], v[40:43], v[32:35], v[16:31]
    s_waitcnt lgkmcnt(0)
    v_mfma_f32_32x32x16_bf16 v[0:15], v[48:51], v[44:47], v[0:15]
    v_mfma_f32_32x32x16_bf16 v[16:31], v[52:55], v[44:47], v[16:31]
    s_waitcnt vmcnt(0)
    s_barrier
    s_add_u32 m0, s36, 0
    s_nop 0
    buffer_load_dwordx4 v56, s[8:11], s38 offen lds
    s_add_u32 m0, s36, 1024
    s_nop 0
    buffer_load_dwordx4 v57, s[8:11], s38 offen lds
    s_add_u32 m0, s37, 0
    s_nop 0
    buffer_load_dwordx4 v58, s[12:15], s39 offen lds
    s_add_u32 m0, s37, 1024
    s_nop 0
    buffer_load_dwordx4 v59, s[12:15], s39 offen lds
    s_add_u32 m0, s37, 2048
    s_nop 0
    buffer_load_dwordx4 v60, s[12:15], s39 offen lds
    s_add_u32 m0, s37, 3072
    s_nop 0
    buffer_load_dwordx4 v61, s[12:15], s39 offen lds
    s_add_u32 s38, s38, 128
    s_add_u32 s39, s39, 65536
    ds_read_b128 v[32:35], v62 offset:24576
    ds_read_b64_tr_b16 v[36:37], v66 offset:32768
    ds_read_b64_tr_b16 v[38:39], v66 offset:33792
    ds_read_b64_tr_b16 v[40:41], v67 offset:32768
    ds_read_b64_tr_b16 v[42:43], v67 offset:33792
    ds_read_b128 v[44:47], v63 offset:24576
    ds_read_b64_tr_b16 v[48:49], v66 offset:36864
    ds_read_b64_tr_b16 v[50:51], v66 offset:37888
    ds_read_b64_tr_b16 v[52:53], v67 offset:36864
    ds_read_b64_tr_b16 v[54:55], v67 offset:37888
    s_waitcnt lgkmcnt(5)
    v_mfma_f32_32x32x16_bf16 v[0:15], v[36:39], v[32:35], v[0:15]
    v_mfma_f32_32x32x16_bf16 v[16:31], v[40:43], v[32:35], v[16:31]
    ds_read_b128 v[32:35], v64 offset:24576
    ds_read_b64_tr_b16 v[36:37], v66 offset:40960
    ds_read_b64_tr_b16 v[38:39], v66 offset:41984
    ds_read_b64_tr_b16 v[40:41], v67 offset:40960
    ds_read_b64_tr_b16 v[42:43], v67 offset:41984
    s_waitcnt lgkmcnt(5)
    v_mfma_f32_32x32x16_bf16 v[0:15], v[48:51], v[44:47], v[0:15]
    v_mfma_f32_32x32x16_bf16 v[16:31], v[52:55], v[44:47], v[16:31]
    ds_read_b128 v[44:47], v65 offset:24576
    ds_read_b64_tr_b16 v[48:49], v66 offset:45056
    ds_read_b64_tr_b16 v[50:51], v66 offset:46080
    ds_read_b64_tr_b16 v[52:53], v67 offset:45056
    ds_read_b64_tr_b16 v[54:55], v67 offset:46080
    s_waitcnt lgkmcnt(5)
    v_mfma_f32_32x32x16_bf16 v[0:15], v[36:39], v[32:35], v[0:15]
    v_mfma_f32_32x32x16_bf16 v[16:31], v[40:43], v[32:35], v[16:31]
    s_waitcnt lgkmcnt(0)
    v_mfma_f32_32x32x16_bf16 v[0:15], v[48:51], v[44:47], v[0:15]
    v_mfma_f32_32x32x16_bf16 v[16:31], v[52:55], v[44:47], v[16:31]
    s_waitcnt vmcnt(0)
    s_barrier
    s_add_u32 m0, s36, 24576
    s_nop 0
    buffer_load_dwordx4 v56, s[8:11], s38 offen lds
    s_add_u32 m0, s36, 25600
    s_nop 0
    buffer_load_dwordx4 v57, s[8:11], s38 offen lds
    s_add_u32 m0, s37, 24576
    s_nop 0
    buffer_load_dwordx4 v58, s[12:15], s39 offen lds
    s_add_u32 m0, s37, 25600
    s_nop 0
    buffer_load_dwordx4 v59, s[12:15], s39 offen lds
    s_add_u32 m0, s37, 26624
    s_nop 0
    buffer_load_dwordx4 v60, s[12:15], s39 offen lds
    s_add_u32 m0, s37, 27648
    s_nop 0
    buffer_load_dwordx4 v61, s[12:15], s39 offen lds
    s_add_u32 s38, s38, 128
    s_add_u32 s39, s39, 65536
    ds_read_b128 v[32:35], v62 offset:0
    ds_read_b64_tr_b16 v[36:37], v66 offset:8192
    ds_read_b64_tr_b16 v[38:39], v66 offset:9216
    ds_read_b64_tr_b16 v[40:41], v67 offset:8192
    ds_read_b64_tr_b16 v[42:43], v67 offset:9216
    ds_read_b128 v[44:47], v63 offset:0
    ds_read_b64_tr_b16 v[48:49], v66 offset:12288
    ds_read_b64_tr_b16 v[50:51], v66 offset:13312
    ds_read_b64_tr_b16 v[52:53], v67 offset:12288
    ds_read_b64_tr_b16 v[54:55], v67 offset:13312
    s_waitcnt lgkmcnt(5)
    v_mfma_f32_32x32x16_bf16 v[0:15], v[36:39], v[32:35], v[0:15]
    v_mfma_f32_32x32x16_bf16 v[16:31], v[40:43], v[32:35], v[16:31]
    ds_read_b128 v[32:35], v64 offset:0
    ds_read_b64_tr_b16 v[36:37], v66 offset:16384
    ds_read_b64_tr_b16 v[38:39], v66 offset:17408
    ds_read_b64_tr_b16 v[40:41], v67 offset:16384
    ds_read_b64_tr_b16 v[42:43], v67 offset:17408
    s_waitcnt lgkmcnt(5)
    v_mfma_f32_32x32x16_bf16 v[0:15], v[48:51], v[44:47], v[0:15]
    v_mfma_f32_32x32x16_bf16 v[16:31], v[52:55], v[44:47], v[16:31]
    ds_read_b128 v[44:47], v65 offset:0
    ds_read_b64_tr_b16 v[48:49], v66 offset:20480
    ds_read_b64_tr_b16 v[50:51], v66 offset:21504
    ds_read_b64_tr_b16 v[52:53], v67 offset:20480
    ds_read_b64_tr_b16 v[54:55], v67 offset:21504
    s_waitcnt lgkmcnt(5)
    v_mfma_f32_32x32x16_bf16 v[0:15], v[36:39], v[32:35], v[0:15]
    v_mfma_f32_32x32x16_bf16 v[16:31], v[40:43], v[32:35], v[16:31]
    s_waitcnt lgkmcnt(0)
    v_mfma_f32_32x32x16_bf16 v[0:15], v[48:51], v[44:47], v[0:15]
    v_mfma_f32_32x32x16_bf16 v[16:31], v[52:55], v[44:47], v[16:31]
    s_waitcnt vmcnt(0)
    s_barrier
    s_add_u32 m0, s36, 0
    s_nop 0
    buffer_load_dwordx4 v56, s[8:11], s38 offen lds
    s_add_u32 m0, s36, 1024
    s_nop 0
    buffer_load_dwordx4 v57, s[8:11], s38 offen lds
    s_add_u32 m0, s37, 0
    s_nop 0
    buffer_load_dwordx4 v58, s[12:15], s39 offen lds
    s_add_u32 m0, s37, 1024
    s_nop 0
    buffer_load_dwordx4 v59, s[12:15], s39 offen lds
    s_add_u32 m0, s37, 2048
    s_nop 0
    buffer_load_dwordx4 v60, s[12:15], s39 offen lds
    s_add_u32 m0, s37, 3072
    s_nop 0
    buffer_load_dwordx4 v61, s[12:15], s39 offen lds
    s_add_u32 s38, s38, 128
    s_add_u32 s39, s39, 65536
    ds_read_b128 v[32:35], v62 offset:24576
    ds_read_b64_tr_b16 v[36:37], v66 offset:32768
    ds_read_b64_tr_b16 v[38:39], v66 offset:33792
    ds_read_b64_tr_b16 v[40:41], v67 offset:32768
    ds_read_b64_tr_b16 v[42:43], v67 offset:33792
    ds_read_b128 v[44:47], v63 offset:24576
    ds_read_b64_tr_b16 v[48:49], v66 offset:36864
    ds_read_b64_tr_b16 v[50:51], v66 offset:37888
    ds_read_b64_tr_b16 v[52:53], v67 offset:36864
    ds_read_b64_tr_b16 v[54:55], v67 offset:37888
    s_waitcnt lgkmcnt(5)
    v_mfma_f32_32x32x16_bf16 v[0:15], v[36:39], v[32:35], v[0:15]
    v_mfma_f32_32x32x16_bf16 v[16:31], v[40:43], v[32:35], v[16:31]
    ds_read_b128 v[32:35], v64 offset:24576
    ds_read_b64_tr_b16 v[36:37], v66 offset:40960
    ds_read_b64_tr_b16 v[38:39], v66 offset:41984
    ds_read_b64_tr_b16 v[40:41], v67 offset:40960
    ds_read_b64_tr_b16 v[42:43], v67 offset:41984
    s_waitcnt lgkmcnt(5)
    v_mfma_f32_32x32x16_bf16 v[0:15], v[48:51], v[44:47], v[0:15]
    v_mfma_f32_32x32x16_bf16 v[16:31], v[52:55], v[44:47], v[16:31]
    ds_read_b128 v[44:47], v65 offset:24576
    ds_read_b64_tr_b16 v[48:49], v66 offset:45056
    ds_read_b64_tr_b16 v[50:51], v66 offset:46080
    ds_read_b64_tr_b16 v[52:53], v67 offset:45056
    ds_read_b64_tr_b16 v[54:55], v67 offset:46080
    s_waitcnt lgkmcnt(5)
    v_mfma_f32_32x32x16_bf16 v[0:15], v[36:39], v[32:35], v[0:15]
    v_mfma_f32_32x32x16_bf16 v[16:31], v[40:43], v[32:35], v[16:31]
    s_waitcnt lgkmcnt(0)
    v_mfma_f32_32x32x16_bf16 v[0:15], v[48:51], v[44:47], v[0:15]
    v_mfma_f32_32x32x16_bf16 v[16:31], v[52:55], v[44:47], v[16:31]
    s_waitcnt vmcnt(0)
    s_barrier
    s_add_u32 m0, s36, 24576
    s_nop 0
    buffer_load_dwordx4 v56, s[8:11], s38 offen lds
    s_add_u32 m0, s36, 25600
    s_nop 0
    buffer_load_dwordx4 v57, s[8:11], s38 offen lds
    s_add_u32 m0, s37, 24576
    s_nop 0
    buffer_load_dwordx4 v58, s[12:15], s39 offen lds
    s_add_u32 m0, s37, 25600
    s_nop 0
    buffer_load_dwordx4 v59, s[12:15], s39 offen lds
    s_add_u32 m0, s37, 26624
    s_nop 0
    buffer_load_dwordx4 v60, s[12:15], s39 offen lds
    s_add_u32 m0, s37, 27648
    s_nop 0
    buffer_load_dwordx4 v61, s[12:15], s39 offen lds
    s_add_u32 s38, s38, 128
    s_add_u32 s39, s39, 65536
    ds_read_b128 v[32:35], v62 offset:0
    ds_read_b64_tr_b16 v[36:37], v66 offset:8192
    ds_read_b64_tr_b16 v[38:39], v66 offset:9216
    ds_read_b64_tr_b16 v[40:41], v67 offset:8192
    ds_read_b64_tr_b16 v[42:43], v67 offset:9216
    ds_read_b128 v[44:47], v63 offset:0
    ds_read_b64_tr_b16 v[48:49], v66 offset:12288
    ds_read_b64_tr_b16 v[50:51], v66 offset:13312
    ds_read_b64_tr_b16 v[52:53], v67 offset:12288
    ds_read_b64_tr_b16 v[54:55], v67 offset:13312
    s_waitcnt lgkmcnt(5)
    v_mfma_f32_32x32x16_bf16 v[0:15], v[36:39], v[32:35], v[0:15]
    v_mfma_f32_32x32x16_bf16 v[16:31], v[40:43], v[32:35], v[16:31]
    ds_read_b128 v[32:35], v64 offset:0
    ds_read_b64_tr_b16 v[36:37], v66 offset:16384
    ds_read_b64_tr_b16 v[38:39], v66 offset:17408
    ds_read_b64_tr_b16 v[40:41], v67 offset:16384
    ds_read_b64_tr_b16 v[42:43], v67 offset:17408
    s_waitcnt lgkmcnt(5)
    v_mfma_f32_32x32x16_bf16 v[0:15], v[48:51], v[44:47], v[0:15]
    v_mfma_f32_32x32x16_bf16 v[16:31], v[52:55], v[44:47], v[16:31]
    ds_read_b128 v[44:47], v65 offset:0
    ds_read_b64_tr_b16 v[48:49], v66 offset:20480
    ds_read_b64_tr_b16 v[50:51], v66 offset:21504
    ds_read_b64_tr_b16 v[52:53], v67 offset:20480
    ds_read_b64_tr_b16 v[54:55], v67 offset:21504
    s_waitcnt lgkmcnt(5)
    v_mfma_f32_32x32x16_bf16 v[0:15], v[36:39], v[32:35], v[0:15]
    v_mfma_f32_32x32x16_bf16 v[16:31], v[40:43], v[32:35], v[16:31]
    s_waitcnt lgkmcnt(0)
    v_mfma_f32_32x32x16_bf16 v[0:15], v[48:51], v[44:47], v[0:15]
    v_mfma_f32_32x32x16_bf16 v[16:31], v[52:55], v[44:47], v[16:31]
    s_waitcnt vmcnt(0)
    s_barrier
    s_add_u32 m0, s36, 0
    s_nop 0
    buffer_load_dwordx4 v56, s[8:11], s38 offen lds
    s_add_u32 m0, s36, 1024
    s_nop 0
    buffer_load_dwordx4 v57, s[8:11], s38 offen lds
    s_add_u32 m0, s37, 0
    s_nop 0
    buffer_load_dwordx4 v58, s[12:15], s39 offen lds
    s_add_u32 m0, s37, 1024
    s_nop 0
    buffer_load_dwordx4 v59, s[12:15], s39 offen lds
    s_add_u32 m0, s37, 2048
    s_nop 0
    buffer_load_dwordx4 v60, s[12:15], s39 offen lds
    s_add_u32 m0, s37, 3072
    s_nop 0
    buffer_load_dwordx4 v61, s[12:15], s39 offen lds
    s_add_u32 s38, s38, 128
    s_add_u32 s39, s39, 65536
    ds_read_b128 v[32:35], v62 offset:24576
    ds_read_b64_tr_b16 v[36:37], v66 offset:32768
    ds_read_b64_tr_b16 v[38:39], v66 offset:33792
    ds_read_b64_tr_b16 v[40:41], v67 offset:32768
    ds_read_b64_tr_b16 v[42:43], v67 offset:33792
    ds_read_b128 v[44:47], v63 offset:24576
    ds_read_b64_tr_b16 v[48:49], v66 offset:36864
    ds_read_b64_tr_b16 v[50:51], v66 offset:37888
    ds_read_b64_tr_b16 v[52:53], v67 offset:36864
    ds_read_b64_tr_b16 v[54:55], v67 offset:37888
    s_waitcnt lgkmcnt(5)
    v_mfma_f32_32x32x16_bf16 v[0:15], v[36:39], v[32:35], v[0:15]
    v_mfma_f32_32x32x16_bf16 v[16:31], v[40:43], v[32:35], v[16:31]
    ds_read_b128 v[32:35], v64 offset:24576
    ds_read_b64_tr_b16 v[36:37], v66 offset:40960
    ds_read_b64_tr_b16 v[38:39], v66 offset:41984
    ds_read_b64_tr_b16 v[40:41], v67 offset:40960
    ds_read_b64_tr_b16 v[42:43], v67 offset:41984
    s_waitcnt lgkmcnt(5)
    v_mfma_f32_32x32x16_bf16 v[0:15], v[48:51], v[44:47], v[0:15]
    v_mfma_f32_32x32x16_bf16 v[16:31], v[52:55], v[44:47], v[16:31]
    ds_read_b128 v[44:47], v65 offset:24576
    ds_read_b64_tr_b16 v[48:49], v66 offset:45056
    ds_read_b64_tr_b16 v[50:51], v66 offset:46080
    ds_read_b64_tr_b16 v[52:53], v67 offset:45056
    ds_read_b64_tr_b16 v[54:55], v67 offset:46080
    s_waitcnt lgkmcnt(5)
    v_mfma_f32_32x32x16_bf16 v[0:15], v[36:39], v[32:35], v[0:15]
    v_mfma_f32_32x32x16_bf16 v[16:31], v[40:43], v[32:35], v[16:31]
    s_waitcnt lgkmcnt(0)
    v_mfma_f32_32x32x16_bf16 v[0:15], v[48:51], v[44:47], v[0:15]
    v_mfma_f32_32x32x16_bf16 v[16:31], v[52:55], v[44:47], v[16:31]
    s_waitcnt vmcnt(0)
    s_barrier
    s_add_u32 m0, s36, 24576
    s_nop 0
    buffer_load_dwordx4 v56, s[8:11], s38 offen lds
    s_add_u32 m0, s36, 25600
    s_nop 0
    buffer_load_dwordx4 v57, s[8:11], s38 offen lds
    s_add_u32 m0, s37, 24576
    s_nop 0
    buffer_load_dwordx4 v58, s[12:15], s39 offen lds
    s_add_u32 m0, s37, 25600
    s_nop 0
    buffer_load_dwordx4 v59, s[12:15], s39 offen lds
    s_add_u32 m0, s37, 26624
    s_nop 0
    buffer_load_dwordx4 v60, s[12:15], s39 offen lds
    s_add_u32 m0, s37, 27648
    s_nop 0
    buffer_load_dwordx4 v61, s[12:15], s39 offen lds
    s_add_u32 s38, s38, 128
    s_add_u32 s39, s39, 65536
    ds_read_b128 v[32:35], v62 offset:0
    ds_read_b64_tr_b16 v[36:37], v66 offset:8192
    ds_read_b64_tr_b16 v[38:39], v66 offset:9216
    ds_read_b64_tr_b16 v[40:41], v67 offset:8192
    ds_read_b64_tr_b16 v[42:43], v67 offset:9216
    ds_read_b128 v[44:47], v63 offset:0
    ds_read_b64_tr_b16 v[48:49], v66 offset:12288
    ds_read_b64_tr_b16 v[50:51], v66 offset:13312
    ds_read_b64_tr_b16 v[52:53], v67 offset:12288
    ds_read_b64_tr_b16 v[54:55], v67 offset:13312
    s_waitcnt lgkmcnt(5)
    v_mfma_f32_32x32x16_bf16 v[0:15], v[36:39], v[32:35], v[0:15]
    v_mfma_f32_32x32x16_bf16 v[16:31], v[40:43], v[32:35], v[16:31]
    ds_read_b128 v[32:35], v64 offset:0
    ds_read_b64_tr_b16 v[36:37], v66 offset:16384
    ds_read_b64_tr_b16 v[38:39], v66 offset:17408
    ds_read_b64_tr_b16 v[40:41], v67 offset:16384
    ds_read_b64_tr_b16 v[42:43], v67 offset:17408
    s_waitcnt lgkmcnt(5)
    v_mfma_f32_32x32x16_bf16 v[0:15], v[48:51], v[44:47], v[0:15]
    v_mfma_f32_32x32x16_bf16 v[16:31], v[52:55], v[44:47], v[16:31]
    ds_read_b128 v[44:47], v65 offset:0
    ds_read_b64_tr_b16 v[48:49], v66 offset:20480
    ds_read_b64_tr_b16 v[50:51], v66 offset:21504
    ds_read_b64_tr_b16 v[52:53], v67 offset:20480
    ds_read_b64_tr_b16 v[54:55], v67 offset:21504
    s_waitcnt lgkmcnt(5)
    v_mfma_f32_32x32x16_bf16 v[0:15], v[36:39], v[32:35], v[0:15]
    v_mfma_f32_32x32x16_bf16 v[16:31], v[40:43], v[32:35], v[16:31]
    s_waitcnt lgkmcnt(0)
    v_mfma_f32_32x32x16_bf16 v[0:15], v[48:51], v[44:47], v[0:15]
    v_mfma_f32_32x32x16_bf16 v[16:31], v[52:55], v[44:47], v[16:31]
    s_waitcnt vmcnt(0)
    s_barrier
    s_add_u32 m0, s36, 0
    s_nop 0
    buffer_load_dwordx4 v56, s[8:11], s38 offen lds
    s_add_u32 m0, s36, 1024
    s_nop 0
    buffer_load_dwordx4 v57, s[8:11], s38 offen lds
    s_add_u32 m0, s37, 0
    s_nop 0
    buffer_load_dwordx4 v58, s[12:15], s39 offen lds
    s_add_u32 m0, s37, 1024
    s_nop 0
    buffer_load_dwordx4 v59, s[12:15], s39 offen lds
    s_add_u32 m0, s37, 2048
    s_nop 0
    buffer_load_dwordx4 v60, s[12:15], s39 offen lds
    s_add_u32 m0, s37, 3072
    s_nop 0
    buffer_load_dwordx4 v61, s[12:15], s39 offen lds
    s_add_u32 s38, s38, 128
    s_add_u32 s39, s39, 65536
    ds_read_b128 v[32:35], v62 offset:24576
    ds_read_b64_tr_b16 v[36:37], v66 offset:32768
    ds_read_b64_tr_b16 v[38:39], v66 offset:33792
    ds_read_b64_tr_b16 v[40:41], v67 offset:32768
    ds_read_b64_tr_b16 v[42:43], v67 offset:33792
    ds_read_b128 v[44:47], v63 offset:24576
    ds_read_b64_tr_b16 v[48:49], v66 offset:36864
    ds_read_b64_tr_b16 v[50:51], v66 offset:37888
    ds_read_b64_tr_b16 v[52:53], v67 offset:36864
    ds_read_b64_tr_b16 v[54:55], v67 offset:37888
    s_waitcnt lgkmcnt(5)
    v_mfma_f32_32x32x16_bf16 v[0:15], v[36:39], v[32:35], v[0:15]
    v_mfma_f32_32x32x16_bf16 v[16:31], v[40:43], v[32:35], v[16:31]
    ds_read_b128 v[32:35], v64 offset:24576
    ds_read_b64_tr_b16 v[36:37], v66 offset:40960
    ds_read_b64_tr_b16 v[38:39], v66 offset:41984
    ds_read_b64_tr_b16 v[40:41], v67 offset:40960
    ds_read_b64_tr_b16 v[42:43], v67 offset:41984
    s_waitcnt lgkmcnt(5)
    v_mfma_f32_32x32x16_bf16 v[0:15], v[48:51], v[44:47], v[0:15]
    v_mfma_f32_32x32x16_bf16 v[16:31], v[52:55], v[44:47], v[16:31]
    ds_read_b128 v[44:47], v65 offset:24576
    ds_read_b64_tr_b16 v[48:49], v66 offset:45056
    ds_read_b64_tr_b16 v[50:51], v66 offset:46080
    ds_read_b64_tr_b16 v[52:53], v67 offset:45056
    ds_read_b64_tr_b16 v[54:55], v67 offset:46080
    s_waitcnt lgkmcnt(5)
    v_mfma_f32_32x32x16_bf16 v[0:15], v[36:39], v[32:35], v[0:15]
    v_mfma_f32_32x32x16_bf16 v[16:31], v[40:43], v[32:35], v[16:31]
    s_waitcnt lgkmcnt(0)
    v_mfma_f32_32x32x16_bf16 v[0:15], v[48:51], v[44:47], v[0:15]
    v_mfma_f32_32x32x16_bf16 v[16:31], v[52:55], v[44:47], v[16:31]
    s_waitcnt vmcnt(0)
    s_barrier
    s_add_u32 m0, s36, 24576
    s_nop 0
    buffer_load_dwordx4 v56, s[8:11], s38 offen lds
    s_add_u32 m0, s36, 25600
    s_nop 0
    buffer_load_dwordx4 v57, s[8:11], s38 offen lds
    s_add_u32 m0, s37, 24576
    s_nop 0
    buffer_load_dwordx4 v58, s[12:15], s39 offen lds
    s_add_u32 m0, s37, 25600
    s_nop 0
    buffer_load_dwordx4 v59, s[12:15], s39 offen lds
    s_add_u32 m0, s37, 26624
    s_nop 0
    buffer_load_dwordx4 v60, s[12:15], s39 offen lds
    s_add_u32 m0, s37, 27648
    s_nop 0
    buffer_load_dwordx4 v61, s[12:15], s39 offen lds
    s_add_u32 s38, s38, 128
    s_add_u32 s39, s39, 65536
    ds_read_b128 v[32:35], v62 offset:0
    ds_read_b64_tr_b16 v[36:37], v66 offset:8192
    ds_read_b64_tr_b16 v[38:39], v66 offset:9216
    ds_read_b64_tr_b16 v[40:41], v67 offset:8192
    ds_read_b64_tr_b16 v[42:43], v67 offset:9216
    ds_read_b128 v[44:47], v63 offset:0
    ds_read_b64_tr_b16 v[48:49], v66 offset:12288
    ds_read_b64_tr_b16 v[50:51], v66 offset:13312
    ds_read_b64_tr_b16 v[52:53], v67 offset:12288
    ds_read_b64_tr_b16 v[54:55], v67 offset:13312
    s_waitcnt lgkmcnt(5)
    v_mfma_f32_32x32x16_bf16 v[0:15], v[36:39], v[32:35], v[0:15]
    v_mfma_f32_32x32x16_bf16 v[16:31], v[40:43], v[32:35], v[16:31]
    ds_read_b128 v[32:35], v64 offset:0
    ds_read_b64_tr_b16 v[36:37], v66 offset:16384
    ds_read_b64_tr_b16 v[38:39], v66 offset:17408
    ds_read_b64_tr_b16 v[40:41], v67 offset:16384
    ds_read_b64_tr_b16 v[42:43], v67 offset:17408
    s_waitcnt lgkmcnt(5)
    v_mfma_f32_32x32x16_bf16 v[0:15], v[48:51], v[44:47], v[0:15]
    v_mfma_f32_32x32x16_bf16 v[16:31], v[52:55], v[44:47], v[16:31]
    ds_read_b128 v[44:47], v65 offset:0
    ds_read_b64_tr_b16 v[48:49], v66 offset:20480
    ds_read_b64_tr_b16 v[50:51], v66 offset:21504
    ds_read_b64_tr_b16 v[52:53], v67 offset:20480
    ds_read_b64_tr_b16 v[54:55], v67 offset:21504
    s_waitcnt lgkmcnt(5)
    v_mfma_f32_32x32x16_bf16 v[0:15], v[36:39], v[32:35], v[0:15]
    v_mfma_f32_32x32x16_bf16 v[16:31], v[40:43], v[32:35], v[16:31]
    s_waitcnt lgkmcnt(0)
    v_mfma_f32_32x32x16_bf16 v[0:15], v[48:51], v[44:47], v[0:15]
    v_mfma_f32_32x32x16_bf16 v[16:31], v[52:55], v[44:47], v[16:31]
    s_waitcnt vmcnt(0)
    s_barrier
    s_add_u32 m0, s36, 0
    s_nop 0
    buffer_load_dwordx4 v56, s[8:11], s38 offen lds
    s_add_u32 m0, s36, 1024
    s_nop 0
    buffer_load_dwordx4 v57, s[8:11], s38 offen lds
    s_add_u32 m0, s37, 0
    s_nop 0
    buffer_load_dwordx4 v58, s[12:15], s39 offen lds
    s_add_u32 m0, s37, 1024
    s_nop 0
    buffer_load_dwordx4 v59, s[12:15], s39 offen lds
    s_add_u32 m0, s37, 2048
    s_nop 0
    buffer_load_dwordx4 v60, s[12:15], s39 offen lds
    s_add_u32 m0, s37, 3072
    s_nop 0
    buffer_load_dwordx4 v61, s[12:15], s39 offen lds
    s_add_u32 s38, s38, 128
    s_add_u32 s39, s39, 65536
    ds_read_b128 v[32:35], v62 offset:24576
    ds_read_b64_tr_b16 v[36:37], v66 offset:32768
    ds_read_b64_tr_b16 v[38:39], v66 offset:33792
    ds_read_b64_tr_b16 v[40:41], v67 offset:32768
    ds_read_b64_tr_b16 v[42:43], v67 offset:33792
    ds_read_b128 v[44:47], v63 offset:24576
    ds_read_b64_tr_b16 v[48:49], v66 offset:36864
    ds_read_b64_tr_b16 v[50:51], v66 offset:37888
    ds_read_b64_tr_b16 v[52:53], v67 offset:36864
    ds_read_b64_tr_b16 v[54:55], v67 offset:37888
    s_waitcnt lgkmcnt(5)
    v_mfma_f32_32x32x16_bf16 v[0:15], v[36:39], v[32:35], v[0:15]
    v_mfma_f32_32x32x16_bf16 v[16:31], v[40:43], v[32:35], v[16:31]
    ds_read_b128 v[32:35], v64 offset:24576
    ds_read_b64_tr_b16 v[36:37], v66 offset:40960
    ds_read_b64_tr_b16 v[38:39], v66 offset:41984
    ds_read_b64_tr_b16 v[40:41], v67 offset:40960
    ds_read_b64_tr_b16 v[42:43], v67 offset:41984
    s_waitcnt lgkmcnt(5)
    v_mfma_f32_32x32x16_bf16 v[0:15], v[48:51], v[44:47], v[0:15]
    v_mfma_f32_32x32x16_bf16 v[16:31], v[52:55], v[44:47], v[16:31]
    ds_read_b128 v[44:47], v65 offset:24576
    ds_read_b64_tr_b16 v[48:49], v66 offset:45056
    ds_read_b64_tr_b16 v[50:51], v66 offset:46080
    ds_read_b64_tr_b16 v[52:53], v67 offset:45056
    ds_read_b64_tr_b16 v[54:55], v67 offset:46080
    s_waitcnt lgkmcnt(5)
    v_mfma_f32_32x32x16_bf16 v[0:15], v[36:39], v[32:35], v[0:15]
    v_mfma_f32_32x32x16_bf16 v[16:31], v[40:43], v[32:35], v[16:31]
    s_waitcnt lgkmcnt(0)
    v_mfma_f32_32x32x16_bf16 v[0:15], v[48:51], v[44:47], v[0:15]
    v_mfma_f32_32x32x16_bf16 v[16:31], v[52:55], v[44:47], v[16:31]
    s_waitcnt vmcnt(0)
    s_barrier
    s_add_u32 m0, s36, 24576
    s_nop 0
    buffer_load_dwordx4 v56, s[8:11], s38 offen lds
    s_add_u32 m0, s36, 25600
    s_nop 0
    buffer_load_dwordx4 v57, s[8:11], s38 offen lds
    s_add_u32 m0, s37, 24576
    s_nop 0
    buffer_load_dwordx4 v58, s[12:15], s39 offen lds
    s_add_u32 m0, s37, 25600
    s_nop 0
    buffer_load_dwordx4 v59, s[12:15], s39 offen lds
    s_add_u32 m0, s37, 26624
    s_nop 0
    buffer_load_dwordx4 v60, s[12:15], s39 offen lds
    s_add_u32 m0, s37, 27648
    s_nop 0
    buffer_load_dwordx4 v61, s[12:15], s39 offen lds
    s_add_u32 s38, s38, 128
    s_add_u32 s39, s39, 65536
    ds_read_b128 v[32:35], v62 offset:0
    ds_read_b64_tr_b16 v[36:37], v66 offset:8192
    ds_read_b64_tr_b16 v[38:39], v66 offset:9216
    ds_read_b64_tr_b16 v[40:41], v67 offset:8192
    ds_read_b64_tr_b16 v[42:43], v67 offset:9216
    ds_read_b128 v[44:47], v63 offset:0
    ds_read_b64_tr_b16 v[48:49], v66 offset:12288
    ds_read_b64_tr_b16 v[50:51], v66 offset:13312
    ds_read_b64_tr_b16 v[52:53], v67 offset:12288
    ds_read_b64_tr_b16 v[54:55], v67 offset:13312
    s_waitcnt lgkmcnt(5)
    v_mfma_f32_32x32x16_bf16 v[0:15], v[36:39], v[32:35], v[0:15]
    v_mfma_f32_32x32x16_bf16 v[16:31], v[40:43], v[32:35], v[16:31]
    ds_read_b128 v[32:35], v64 offset:0
    ds_read_b64_tr_b16 v[36:37], v66 offset:16384
    ds_read_b64_tr_b16 v[38:39], v66 offset:17408
    ds_read_b64_tr_b16 v[40:41], v67 offset:16384
    ds_read_b64_tr_b16 v[42:43], v67 offset:17408
    s_waitcnt lgkmcnt(5)
    v_mfma_f32_32x32x16_bf16 v[0:15], v[48:51], v[44:47], v[0:15]
    v_mfma_f32_32x32x16_bf16 v[16:31], v[52:55], v[44:47], v[16:31]
    ds_read_b128 v[44:47], v65 offset:0
    ds_read_b64_tr_b16 v[48:49], v66 offset:20480
    ds_read_b64_tr_b16 v[50:51], v66 offset:21504
    ds_read_b64_tr_b16 v[52:53], v67 offset:20480
    ds_read_b64_tr_b16 v[54:55], v67 offset:21504
    s_waitcnt lgkmcnt(5)
    v_mfma_f32_32x32x16_bf16 v[0:15], v[36:39], v[32:35], v[0:15]
    v_mfma_f32_32x32x16_bf16 v[16:31], v[40:43], v[32:35], v[16:31]
    s_waitcnt lgkmcnt(0)
    v_mfma_f32_32x32x16_bf16 v[0:15], v[48:51], v[44:47], v[0:15]
    v_mfma_f32_32x32x16_bf16 v[16:31], v[52:55], v[44:47], v[16:31]
    s_waitcnt vmcnt(0)
    s_barrier
    s_add_u32 m0, s36, 0
    s_nop 0
    buffer_load_dwordx4 v56, s[8:11], s38 offen lds
    s_add_u32 m0, s36, 1024
    s_nop 0
    buffer_load_dwordx4 v57, s[8:11], s38 offen lds
    s_add_u32 m0, s37, 0
    s_nop 0
    buffer_load_dwordx4 v58, s[12:15], s39 offen lds
    s_add_u32 m0, s37, 1024
    s_nop 0
    buffer_load_dwordx4 v59, s[12:15], s39 offen lds
    s_add_u32 m0, s37, 2048
    s_nop 0
    buffer_load_dwordx4 v60, s[12:15], s39 offen lds
    s_add_u32 m0, s37, 3072
    s_nop 0
    buffer_load_dwordx4 v61, s[12:15], s39 offen lds
    s_add_u32 s38, s38, 128
    s_add_u32 s39, s39, 65536
    ds_read_b128 v[32:35], v62 offset:24576
    ds_read_b64_tr_b16 v[36:37], v66 offset:32768
    ds_read_b64_tr_b16 v[38:39], v66 offset:33792
    ds_read_b64_tr_b16 v[40:41], v67 offset:32768
    ds_read_b64_tr_b16 v[42:43], v67 offset:33792
    ds_read_b128 v[44:47], v63 offset:24576
    ds_read_b64_tr_b16 v[48:49], v66 offset:36864
    ds_read_b64_tr_b16 v[50:51], v66 offset:37888
    ds_read_b64_tr_b16 v[52:53], v67 offset:36864
    ds_read_b64_tr_b16 v[54:55], v67 offset:37888
    s_waitcnt lgkmcnt(5)
    v_mfma_f32_32x32x16_bf16 v[0:15], v[36:39], v[32:35], v[0:15]
    v_mfma_f32_32x32x16_bf16 v[16:31], v[40:43], v[32:35], v[16:31]
    ds_read_b128 v[32:35], v64 offset:24576
    ds_read_b64_tr_b16 v[36:37], v66 offset:40960
    ds_read_b64_tr_b16 v[38:39], v66 offset:41984
    ds_read_b64_tr_b16 v[40:41], v67 offset:40960
    ds_read_b64_tr_b16 v[42:43], v67 offset:41984
    s_waitcnt lgkmcnt(5)
    v_mfma_f32_32x32x16_bf16 v[0:15], v[48:51], v[44:47], v[0:15]
    v_mfma_f32_32x32x16_bf16 v[16:31], v[52:55], v[44:47], v[16:31]
    ds_read_b128 v[44:47], v65 offset:24576
    ds_read_b64_tr_b16 v[48:49], v66 offset:45056
    ds_read_b64_tr_b16 v[50:51], v66 offset:46080
    ds_read_b64_tr_b16 v[52:53], v67 offset:45056
    ds_read_b64_tr_b16 v[54:55], v67 offset:46080
    s_waitcnt lgkmcnt(5)
    v_mfma_f32_32x32x16_bf16 v[0:15], v[36:39], v[32:35], v[0:15]
    v_mfma_f32_32x32x16_bf16 v[16:31], v[40:43], v[32:35], v[16:31]
    s_waitcnt lgkmcnt(0)
    v_mfma_f32_32x32x16_bf16 v[0:15], v[48:51], v[44:47], v[0:15]
    v_mfma_f32_32x32x16_bf16 v[16:31], v[52:55], v[44:47], v[16:31]
    s_waitcnt vmcnt(0)
    s_barrier
    s_add_u32 m0, s36, 24576
    s_nop 0
    buffer_load_dwordx4 v56, s[8:11], s38 offen lds
    s_add_u32 m0, s36, 25600
    s_nop 0
    buffer_load_dwordx4 v57, s[8:11], s38 offen lds
    s_add_u32 m0, s37, 24576
    s_nop 0
    buffer_load_dwordx4 v58, s[12:15], s39 offen lds
    s_add_u32 m0, s37, 25600
    s_nop 0
    buffer_load_dwordx4 v59, s[12:15], s39 offen lds
    s_add_u32 m0, s37, 26624
    s_nop 0
    buffer_load_dwordx4 v60, s[12:15], s39 offen lds
    s_add_u32 m0, s37, 27648
    s_nop 0
    buffer_load_dwordx4 v61, s[12:15], s39 offen lds
    s_add_u32 s38, s38, 128
    s_add_u32 s39, s39, 65536
    ds_read_b128 v[32:35], v62 offset:0
    ds_read_b64_tr_b16 v[36:37], v66 offset:8192
    ds_read_b64_tr_b16 v[38:39], v66 offset:9216
    ds_read_b64_tr_b16 v[40:41], v67 offset:8192
    ds_read_b64_tr_b16 v[42:43], v67 offset:9216
    ds_read_b128 v[44:47], v63 offset:0
    ds_read_b64_tr_b16 v[48:49], v66 offset:12288
    ds_read_b64_tr_b16 v[50:51], v66 offset:13312
    ds_read_b64_tr_b16 v[52:53], v67 offset:12288
    ds_read_b64_tr_b16 v[54:55], v67 offset:13312
    s_waitcnt lgkmcnt(5)
    v_mfma_f32_32x32x16_bf16 v[0:15], v[36:39], v[32:35], v[0:15]
    v_mfma_f32_32x32x16_bf16 v[16:31], v[40:43], v[32:35], v[16:31]
    ds_read_b128 v[32:35], v64 offset:0
    ds_read_b64_tr_b16 v[36:37], v66 offset:16384
    ds_read_b64_tr_b16 v[38:39], v66 offset:17408
    ds_read_b64_tr_b16 v[40:41], v67 offset:16384
    ds_read_b64_tr_b16 v[42:43], v67 offset:17408
    s_waitcnt lgkmcnt(5)
    v_mfma_f32_32x32x16_bf16 v[0:15], v[48:51], v[44:47], v[0:15]
    v_mfma_f32_32x32x16_bf16 v[16:31], v[52:55], v[44:47], v[16:31]
    ds_read_b128 v[44:47], v65 offset:0
    ds_read_b64_tr_b16 v[48:49], v66 offset:20480
    ds_read_b64_tr_b16 v[50:51], v66 offset:21504
    ds_read_b64_tr_b16 v[52:53], v67 offset:20480
    ds_read_b64_tr_b16 v[54:55], v67 offset:21504
    s_waitcnt lgkmcnt(5)
    v_mfma_f32_32x32x16_bf16 v[0:15], v[36:39], v[32:35], v[0:15]
    v_mfma_f32_32x32x16_bf16 v[16:31], v[40:43], v[32:35], v[16:31]
    s_waitcnt lgkmcnt(0)
    v_mfma_f32_32x32x16_bf16 v[0:15], v[48:51], v[44:47], v[0:15]
    v_mfma_f32_32x32x16_bf16 v[16:31], v[52:55], v[44:47], v[16:31]
    s_waitcnt vmcnt(0)
    s_barrier
    s_add_u32 m0, s36, 0
    s_nop 0
    buffer_load_dwordx4 v56, s[8:11], s38 offen lds
    s_add_u32 m0, s36, 1024
    s_nop 0
    buffer_load_dwordx4 v57, s[8:11], s38 offen lds
    s_add_u32 m0, s37, 0
    s_nop 0
    buffer_load_dwordx4 v58, s[12:15], s39 offen lds
    s_add_u32 m0, s37, 1024
    s_nop 0
    buffer_load_dwordx4 v59, s[12:15], s39 offen lds
    s_add_u32 m0, s37, 2048
    s_nop 0
    buffer_load_dwordx4 v60, s[12:15], s39 offen lds
    s_add_u32 m0, s37, 3072
    s_nop 0
    buffer_load_dwordx4 v61, s[12:15], s39 offen lds
    s_add_u32 s38, s38, 128
    s_add_u32 s39, s39, 65536
    ds_read_b128 v[32:35], v62 offset:24576
    ds_read_b64_tr_b16 v[36:37], v66 offset:32768
    ds_read_b64_tr_b16 v[38:39], v66 offset:33792
    ds_read_b64_tr_b16 v[40:41], v67 offset:32768
    ds_read_b64_tr_b16 v[42:43], v67 offset:33792
    ds_read_b128 v[44:47], v63 offset:24576
    ds_read_b64_tr_b16 v[48:49], v66 offset:36864
    ds_read_b64_tr_b16 v[50:51], v66 offset:37888
    ds_read_b64_tr_b16 v[52:53], v67 offset:36864
    ds_read_b64_tr_b16 v[54:55], v67 offset:37888
    s_waitcnt lgkmcnt(5)
    v_mfma_f32_32x32x16_bf16 v[0:15], v[36:39], v[32:35], v[0:15]
    v_mfma_f32_32x32x16_bf16 v[16:31], v[40:43], v[32:35], v[16:31]
    ds_read_b128 v[32:35], v64 offset:24576
    ds_read_b64_tr_b16 v[36:37], v66 offset:40960
    ds_read_b64_tr_b16 v[38:39], v66 offset:41984
    ds_read_b64_tr_b16 v[40:41], v67 offset:40960
    ds_read_b64_tr_b16 v[42:43], v67 offset:41984
    s_waitcnt lgkmcnt(5)
    v_mfma_f32_32x32x16_bf16 v[0:15], v[48:51], v[44:47], v[0:15]
    v_mfma_f32_32x32x16_bf16 v[16:31], v[52:55], v[44:47], v[16:31]
    ds_read_b128 v[44:47], v65 offset:24576
    ds_read_b64_tr_b16 v[48:49], v66 offset:45056
    ds_read_b64_tr_b16 v[50:51], v66 offset:46080
    ds_read_b64_tr_b16 v[52:53], v67 offset:45056
    ds_read_b64_tr_b16 v[54:55], v67 offset:46080
    s_waitcnt lgkmcnt(5)
    v_mfma_f32_32x32x16_bf16 v[0:15], v[36:39], v[32:35], v[0:15]
    v_mfma_f32_32x32x16_bf16 v[16:31], v[40:43], v[32:35], v[16:31]
    s_waitcnt lgkmcnt(0)
    v_mfma_f32_32x32x16_bf16 v[0:15], v[48:51], v[44:47], v[0:15]
    v_mfma_f32_32x32x16_bf16 v[16:31], v[52:55], v[44:47], v[16:31]
    s_waitcnt vmcnt(0)
    s_barrier
    s_add_u32 m0, s36, 24576
    s_nop 0
    buffer_load_dwordx4 v56, s[8:11], s38 offen lds
    s_add_u32 m0, s36, 25600
    s_nop 0
    buffer_load_dwordx4 v57, s[8:11], s38 offen lds
    s_add_u32 m0, s37, 24576
    s_nop 0
    buffer_load_dwordx4 v58, s[12:15], s39 offen lds
    s_add_u32 m0, s37, 25600
    s_nop 0
    buffer_load_dwordx4 v59, s[12:15], s39 offen lds
    s_add_u32 m0, s37, 26624
    s_nop 0
    buffer_load_dwordx4 v60, s[12:15], s39 offen lds
    s_add_u32 m0, s37, 27648
    s_nop 0
    buffer_load_dwordx4 v61, s[12:15], s39 offen lds
    s_add_u32 s38, s38, 128
    s_add_u32 s39, s39, 65536
    ds_read_b128 v[32:35], v62 offset:0
    ds_read_b64_tr_b16 v[36:37], v66 offset:8192
    ds_read_b64_tr_b16 v[38:39], v66 offset:9216
    ds_read_b64_tr_b16 v[40:41], v67 offset:8192
    ds_read_b64_tr_b16 v[42:43], v67 offset:9216
    ds_read_b128 v[44:47], v63 offset:0
    ds_read_b64_tr_b16 v[48:49], v66 offset:12288
    ds_read_b64_tr_b16 v[50:51], v66 offset:13312
    ds_read_b64_tr_b16 v[52:53], v67 offset:12288
    ds_read_b64_tr_b16 v[54:55], v67 offset:13312
    s_waitcnt lgkmcnt(5)
    v_mfma_f32_32x32x16_bf16 v[0:15], v[36:39], v[32:35], v[0:15]
    v_mfma_f32_32x32x16_bf16 v[16:31], v[40:43], v[32:35], v[16:31]
    ds_read_b128 v[32:35], v64 offset:0
    ds_read_b64_tr_b16 v[36:37], v66 offset:16384
    ds_read_b64_tr_b16 v[38:39], v66 offset:17408
    ds_read_b64_tr_b16 v[40:41], v67 offset:16384
    ds_read_b64_tr_b16 v[42:43], v67 offset:17408
    s_waitcnt lgkmcnt(5)
    v_mfma_f32_32x32x16_bf16 v[0:15], v[48:51], v[44:47], v[0:15]
    v_mfma_f32_32x32x16_bf16 v[16:31], v[52:55], v[44:47], v[16:31]
    ds_read_b128 v[44:47], v65 offset:0
    ds_read_b64_tr_b16 v[48:49], v66 offset:20480
    ds_read_b64_tr_b16 v[50:51], v66 offset:21504
    ds_read_b64_tr_b16 v[52:53], v67 offset:20480
    ds_read_b64_tr_b16 v[54:55], v67 offset:21504
    s_waitcnt lgkmcnt(5)
    v_mfma_f32_32x32x16_bf16 v[0:15], v[36:39], v[32:35], v[0:15]
    v_mfma_f32_32x32x16_bf16 v[16:31], v[40:43], v[32:35], v[16:31]
    s_waitcnt lgkmcnt(0)
    v_mfma_f32_32x32x16_bf16 v[0:15], v[48:51], v[44:47], v[0:15]
    v_mfma_f32_32x32x16_bf16 v[16:31], v[52:55], v[44:47], v[16:31]
    s_waitcnt vmcnt(0)
    s_barrier
    s_add_u32 m0, s36, 0
    s_nop 0
    buffer_load_dwordx4 v56, s[8:11], s38 offen lds
    s_add_u32 m0, s36, 1024
    s_nop 0
    buffer_load_dwordx4 v57, s[8:11], s38 offen lds
    s_add_u32 m0, s37, 0
    s_nop 0
    buffer_load_dwordx4 v58, s[12:15], s39 offen lds
    s_add_u32 m0, s37, 1024
    s_nop 0
    buffer_load_dwordx4 v59, s[12:15], s39 offen lds
    s_add_u32 m0, s37, 2048
    s_nop 0
    buffer_load_dwordx4 v60, s[12:15], s39 offen lds
    s_add_u32 m0, s37, 3072
    s_nop 0
    buffer_load_dwordx4 v61, s[12:15], s39 offen lds
    s_add_u32 s38, s38, 128
    s_add_u32 s39, s39, 65536
    ds_read_b128 v[32:35], v62 offset:24576
    ds_read_b64_tr_b16 v[36:37], v66 offset:32768
    ds_read_b64_tr_b16 v[38:39], v66 offset:33792
    ds_read_b64_tr_b16 v[40:41], v67 offset:32768
    ds_read_b64_tr_b16 v[42:43], v67 offset:33792
    ds_read_b128 v[44:47], v63 offset:24576
    ds_read_b64_tr_b16 v[48:49], v66 offset:36864
    ds_read_b64_tr_b16 v[50:51], v66 offset:37888
    ds_read_b64_tr_b16 v[52:53], v67 offset:36864
    ds_read_b64_tr_b16 v[54:55], v67 offset:37888
    s_waitcnt lgkmcnt(5)
    v_mfma_f32_32x32x16_bf16 v[0:15], v[36:39], v[32:35], v[0:15]
    v_mfma_f32_32x32x16_bf16 v[16:31], v[40:43], v[32:35], v[16:31]
    ds_read_b128 v[32:35], v64 offset:24576
    ds_read_b64_tr_b16 v[36:37], v66 offset:40960
    ds_read_b64_tr_b16 v[38:39], v66 offset:41984
    ds_read_b64_tr_b16 v[40:41], v67 offset:40960
    ds_read_b64_tr_b16 v[42:43], v67 offset:41984
    s_waitcnt lgkmcnt(5)
    v_mfma_f32_32x32x16_bf16 v[0:15], v[48:51], v[44:47], v[0:15]
    v_mfma_f32_32x32x16_bf16 v[16:31], v[52:55], v[44:47], v[16:31]
    ds_read_b128 v[44:47], v65 offset:24576
    ds_read_b64_tr_b16 v[48:49], v66 offset:45056
    ds_read_b64_tr_b16 v[50:51], v66 offset:46080
    ds_read_b64_tr_b16 v[52:53], v67 offset:45056
    ds_read_b64_tr_b16 v[54:55], v67 offset:46080
    s_waitcnt lgkmcnt(5)
    v_mfma_f32_32x32x16_bf16 v[0:15], v[36:39], v[32:35], v[0:15]
    v_mfma_f32_32x32x16_bf16 v[16:31], v[40:43], v[32:35], v[16:31]
    s_waitcnt lgkmcnt(0)
    v_mfma_f32_32x32x16_bf16 v[0:15], v[48:51], v[44:47], v[0:15]
    v_mfma_f32_32x32x16_bf16 v[16:31], v[52:55], v[44:47], v[16:31]
    s_waitcnt vmcnt(0)
    s_barrier
    s_add_u32 m0, s36, 24576
    s_nop 0
    buffer_load_dwordx4 v56, s[8:11], s38 offen lds
    s_add_u32 m0, s36, 25600
    s_nop 0
    buffer_load_dwordx4 v57, s[8:11], s38 offen lds
    s_add_u32 m0, s37, 24576
    s_nop 0
    buffer_load_dwordx4 v58, s[12:15], s39 offen lds
    s_add_u32 m0, s37, 25600
    s_nop 0
    buffer_load_dwordx4 v59, s[12:15], s39 offen lds
    s_add_u32 m0, s37, 26624
    s_nop 0
    buffer_load_dwordx4 v60, s[12:15], s39 offen lds
    s_add_u32 m0, s37, 27648
    s_nop 0
    buffer_load_dwordx4 v61, s[12:15], s39 offen lds
    s_add_u32 s38, s38, 128
    s_add_u32 s39, s39, 65536
    ds_read_b128 v[32:35], v62 offset:0
    ds_read_b64_tr_b16 v[36:37], v66 offset:8192
    ds_read_b64_tr_b16 v[38:39], v66 offset:9216
    ds_read_b64_tr_b16 v[40:41], v67 offset:8192
    ds_read_b64_tr_b16 v[42:43], v67 offset:9216
    ds_read_b128 v[44:47], v63 offset:0
    ds_read_b64_tr_b16 v[48:49], v66 offset:12288
    ds_read_b64_tr_b16 v[50:51], v66 offset:13312
    ds_read_b64_tr_b16 v[52:53], v67 offset:12288
    ds_read_b64_tr_b16 v[54:55], v67 offset:13312
    s_waitcnt lgkmcnt(5)
    v_mfma_f32_32x32x16_bf16 v[0:15], v[36:39], v[32:35], v[0:15]
    v_mfma_f32_32x32x16_bf16 v[16:31], v[40:43], v[32:35], v[16:31]
    ds_read_b128 v[32:35], v64 offset:0
    ds_read_b64_tr_b16 v[36:37], v66 offset:16384
    ds_read_b64_tr_b16 v[38:39], v66 offset:17408
    ds_read_b64_tr_b16 v[40:41], v67 offset:16384
    ds_read_b64_tr_b16 v[42:43], v67 offset:17408
    s_waitcnt lgkmcnt(5)
    v_mfma_f32_32x32x16_bf16 v[0:15], v[48:51], v[44:47], v[0:15]
    v_mfma_f32_32x32x16_bf16 v[16:31], v[52:55], v[44:47], v[16:31]
    ds_read_b128 v[44:47], v65 offset:0
    ds_read_b64_tr_b16 v[48:49], v66 offset:20480
    ds_read_b64_tr_b16 v[50:51], v66 offset:21504
    ds_read_b64_tr_b16 v[52:53], v67 offset:20480
    ds_read_b64_tr_b16 v[54:55], v67 offset:21504
    s_waitcnt lgkmcnt(5)
    v_mfma_f32_32x32x16_bf16 v[0:15], v[36:39], v[32:35], v[0:15]
    v_mfma_f32_32x32x16_bf16 v[16:31], v[40:43], v[32:35], v[16:31]
    s_waitcnt lgkmcnt(0)
    v_mfma_f32_32x32x16_bf16 v[0:15], v[48:51], v[44:47], v[0:15]
    v_mfma_f32_32x32x16_bf16 v[16:31], v[52:55], v[44:47], v[16:31]
    s_waitcnt vmcnt(0)
    s_barrier
    s_add_u32 m0, s36, 0
    s_nop 0
    buffer_load_dwordx4 v56, s[8:11], s38 offen lds
    s_add_u32 m0, s36, 1024
    s_nop 0
    buffer_load_dwordx4 v57, s[8:11], s38 offen lds
    s_add_u32 m0, s37, 0
    s_nop 0
    buffer_load_dwordx4 v58, s[12:15], s39 offen lds
    s_add_u32 m0, s37, 1024
    s_nop 0
    buffer_load_dwordx4 v59, s[12:15], s39 offen lds
    s_add_u32 m0, s37, 2048
    s_nop 0
    buffer_load_dwordx4 v60, s[12:15], s39 offen lds
    s_add_u32 m0, s37, 3072
    s_nop 0
    buffer_load_dwordx4 v61, s[12:15], s39 offen lds
    s_add_u32 s38, s38, 128
    s_add_u32 s39, s39, 65536
    ds_read_b128 v[32:35], v62 offset:24576
    ds_read_b64_tr_b16 v[36:37], v66 offset:32768
    ds_read_b64_tr_b16 v[38:39], v66 offset:33792
    ds_read_b64_tr_b16 v[40:41], v67 offset:32768
    ds_read_b64_tr_b16 v[42:43], v67 offset:33792
    ds_read_b128 v[44:47], v63 offset:24576
    ds_read_b64_tr_b16 v[48:49], v66 offset:36864
    ds_read_b64_tr_b16 v[50:51], v66 offset:37888
    ds_read_b64_tr_b16 v[52:53], v67 offset:36864
    ds_read_b64_tr_b16 v[54:55], v67 offset:37888
    s_waitcnt lgkmcnt(5)
    v_mfma_f32_32x32x16_bf16 v[0:15], v[36:39], v[32:35], v[0:15]
    v_mfma_f32_32x32x16_bf16 v[16:31], v[40:43], v[32:35], v[16:31]
    ds_read_b128 v[32:35], v64 offset:24576
    ds_read_b64_tr_b16 v[36:37], v66 offset:40960
    ds_read_b64_tr_b16 v[38:39], v66 offset:41984
    ds_read_b64_tr_b16 v[40:41], v67 offset:40960
    ds_read_b64_tr_b16 v[42:43], v67 offset:41984
    s_waitcnt lgkmcnt(5)
    v_mfma_f32_32x32x16_bf16 v[0:15], v[48:51], v[44:47], v[0:15]
    v_mfma_f32_32x32x16_bf16 v[16:31], v[52:55], v[44:47], v[16:31]
    ds_read_b128 v[44:47], v65 offset:24576
    ds_read_b64_tr_b16 v[48:49], v66 offset:45056
    ds_read_b64_tr_b16 v[50:51], v66 offset:46080
    ds_read_b64_tr_b16 v[52:53], v67 offset:45056
    ds_read_b64_tr_b16 v[54:55], v67 offset:46080
    s_waitcnt lgkmcnt(5)
    v_mfma_f32_32x32x16_bf16 v[0:15], v[36:39], v[32:35], v[0:15]
    v_mfma_f32_32x32x16_bf16 v[16:31], v[40:43], v[32:35], v[16:31]
    s_waitcnt lgkmcnt(0)
    v_mfma_f32_32x32x16_bf16 v[0:15], v[48:51], v[44:47], v[0:15]
    v_mfma_f32_32x32x16_bf16 v[16:31], v[52:55], v[44:47], v[16:31]
    s_waitcnt vmcnt(0)
    s_barrier
    s_add_u32 m0, s36, 24576
    s_nop 0
    buffer_load_dwordx4 v56, s[8:11], s38 offen lds
    s_add_u32 m0, s36, 25600
    s_nop 0
    buffer_load_dwordx4 v57, s[8:11], s38 offen lds
    s_add_u32 m0, s37, 24576
    s_nop 0
    buffer_load_dwordx4 v58, s[12:15], s39 offen lds
    s_add_u32 m0, s37, 25600
    s_nop 0
    buffer_load_dwordx4 v59, s[12:15], s39 offen lds
    s_add_u32 m0, s37, 26624
    s_nop 0
    buffer_load_dwordx4 v60, s[12:15], s39 offen lds
    s_add_u32 m0, s37, 27648
    s_nop 0
    buffer_load_dwordx4 v61, s[12:15], s39 offen lds
    s_add_u32 s38, s38, 128
    s_add_u32 s39, s39, 65536
    ds_read_b128 v[32:35], v62 offset:0
    ds_read_b64_tr_b16 v[36:37], v66 offset:8192
    ds_read_b64_tr_b16 v[38:39], v66 offset:9216
    ds_read_b64_tr_b16 v[40:41], v67 offset:8192
    ds_read_b64_tr_b16 v[42:43], v67 offset:9216
    ds_read_b128 v[44:47], v63 offset:0
    ds_read_b64_tr_b16 v[48:49], v66 offset:12288
    ds_read_b64_tr_b16 v[50:51], v66 offset:13312
    ds_read_b64_tr_b16 v[52:53], v67 offset:12288
    ds_read_b64_tr_b16 v[54:55], v67 offset:13312
    s_waitcnt lgkmcnt(5)
    v_mfma_f32_32x32x16_bf16 v[0:15], v[36:39], v[32:35], v[0:15]
    v_mfma_f32_32x32x16_bf16 v[16:31], v[40:43], v[32:35], v[16:31]
    ds_read_b128 v[32:35], v64 offset:0
    ds_read_b64_tr_b16 v[36:37], v66 offset:16384
    ds_read_b64_tr_b16 v[38:39], v66 offset:17408
    ds_read_b64_tr_b16 v[40:41], v67 offset:16384
    ds_read_b64_tr_b16 v[42:43], v67 offset:17408
    s_waitcnt lgkmcnt(5)
    v_mfma_f32_32x32x16_bf16 v[0:15], v[48:51], v[44:47], v[0:15]
    v_mfma_f32_32x32x16_bf16 v[16:31], v[52:55], v[44:47], v[16:31]
    ds_read_b128 v[44:47], v65 offset:0
    ds_read_b64_tr_b16 v[48:49], v66 offset:20480
    ds_read_b64_tr_b16 v[50:51], v66 offset:21504
    ds_read_b64_tr_b16 v[52:53], v67 offset:20480
    ds_read_b64_tr_b16 v[54:55], v67 offset:21504
    s_waitcnt lgkmcnt(5)
    v_mfma_f32_32x32x16_bf16 v[0:15], v[36:39], v[32:35], v[0:15]
    v_mfma_f32_32x32x16_bf16 v[16:31], v[40:43], v[32:35], v[16:31]
    s_waitcnt lgkmcnt(0)
    v_mfma_f32_32x32x16_bf16 v[0:15], v[48:51], v[44:47], v[0:15]
    v_mfma_f32_32x32x16_bf16 v[16:31], v[52:55], v[44:47], v[16:31]
    s_waitcnt vmcnt(0)
    s_barrier
    ds_read_b128 v[32:35], v62 offset:24576
    ds_read_b64_tr_b16 v[36:37], v66 offset:32768
    ds_read_b64_tr_b16 v[38:39], v66 offset:33792
    ds_read_b64_tr_b16 v[40:41], v67 offset:32768
    ds_read_b64_tr_b16 v[42:43], v67 offset:33792
    ds_read_b128 v[44:47], v63 offset:24576
    ds_read_b64_tr_b16 v[48:49], v66 offset:36864
    ds_read_b64_tr_b16 v[50:51], v66 offset:37888
    ds_read_b64_tr_b16 v[52:53], v67 offset:36864
    ds_read_b64_tr_b16 v[54:55], v67 offset:37888
    s_waitcnt lgkmcnt(5)
    v_mfma_f32_32x32x16_bf16 v[0:15], v[36:39], v[32:35], v[0:15]
    v_mfma_f32_32x32x16_bf16 v[16:31], v[40:43], v[32:35], v[16:31]
    ds_read_b128 v[32:35], v64 offset:24576
    ds_read_b64_tr_b16 v[36:37], v66 offset:40960
    ds_read_b64_tr_b16 v[38:39], v66 offset:41984
    ds_read_b64_tr_b16 v[40:41], v67 offset:40960
    ds_read_b64_tr_b16 v[42:43], v67 offset:41984
    s_waitcnt lgkmcnt(5)
    v_mfma_f32_32x32x16_bf16 v[0:15], v[48:51], v[44:47], v[0:15]
    v_mfma_f32_32x32x16_bf16 v[16:31], v[52:55], v[44:47], v[16:31]
    ds_read_b128 v[44:47], v65 offset:24576
    ds_read_b64_tr_b16 v[48:49], v66 offset:45056
    ds_read_b64_tr_b16 v[50:51], v66 offset:46080
    ds_read_b64_tr_b16 v[52:53], v67 offset:45056
    ds_read_b64_tr_b16 v[54:55], v67 offset:46080
    s_waitcnt lgkmcnt(5)
    v_mfma_f32_32x32x16_bf16 v[0:15], v[36:39], v[32:35], v[0:15]
    v_mfma_f32_32x32x16_bf16 v[16:31], v[40:43], v[32:35], v[16:31]
    s_waitcnt lgkmcnt(0)
    v_mfma_f32_32x32x16_bf16 v[0:15], v[48:51], v[44:47], v[0:15]
    v_mfma_f32_32x32x16_bf16 v[16:31], v[52:55], v[44:47], v[16:31]
    s_nop 15
    s_nop 3
    s_barrier
    v_lshrrev_b32 v68, 5, v76
    v_lshlrev_b32 v68, 3, v68
    s_lshl_b32 s32, s35, 7
    v_add_u32 v68, s32, v68
    buffer_load_dwordx2 v[32:33], v68, s[20:23], 0 offen offset:0
    buffer_load_dwordx2 v[34:35], v68, s[20:23], 0 offen offset:16
    buffer_load_dwordx2 v[36:37], v68, s[20:23], 0 offen offset:32
    buffer_load_dwordx2 v[38:39], v68, s[20:23], 0 offen offset:48
    buffer_load_dwordx2 v[40:41], v68, s[20:23], 0 offen offset:64
    buffer_load_dwordx2 v[42:43], v68, s[20:23], 0 offen offset:80
    buffer_load_dwordx2 v[44:45], v68, s[20:23], 0 offen offset:96
    buffer_load_dwordx2 v[46:47], v68, s[20:23], 0 offen offset:112
    s_waitcnt vmcnt(0)
    v_and_b32 v68, 31, v76
    s_mul_i32 s32, s34, 32
    v_add_u32 v68, s32, v68
    v_mul_u32_u24 v68, 272, v68
    v_lshrrev_b32 v69, 5, v76
    v_lshl_add_u32 v68, v69, 3, v68
    s_lshl_b32 s32, s35, 7
    v_add_u32 v68, s32, v68
    v_cvt_pk_bf16_f32 v70, v0, v1
    v_lshlrev_b32 v0, 16, v70
    v_and_b32 v1, 0xffff0000, v70
    v_cvt_pk_bf16_f32 v70, v2, v3
    v_lshlrev_b32 v2, 16, v70
    v_and_b32 v3, 0xffff0000, v70
    v_lshlrev_b32 v70, 16, v32
    v_and_b32 v71, 0xffff0000, v32
    v_lshlrev_b32 v72, 16, v33
    v_and_b32 v73, 0xffff0000, v33
    v_add_f32 v0, v0, v70
    v_add_f32 v1, v1, v71
    v_add_f32 v2, v2, v72
    v_add_f32 v3, v3, v73
    v_cvt_pk_bf16_f32 v0, v0, v1
    v_cvt_pk_bf16_f32 v1, v2, v3
    ds_write_b64 v68, v[0:1] offset:0
    v_cvt_pk_bf16_f32 v70, v4, v5
    v_lshlrev_b32 v4, 16, v70
    v_and_b32 v5, 0xffff0000, v70
    v_cvt_pk_bf16_f32 v70, v6, v7
    v_lshlrev_b32 v6, 16, v70
    v_and_b32 v7, 0xffff0000, v70
    v_lshlrev_b32 v70, 16, v34
    v_and_b32 v71, 0xffff0000, v34
    v_lshlrev_b32 v72, 16, v35
    v_and_b32 v73, 0xffff0000, v35
    v_add_f32 v4, v4, v70
    v_add_f32 v5, v5, v71
    v_add_f32 v6, v6, v72
    v_add_f32 v7, v7, v73
    v_cvt_pk_bf16_f32 v4, v4, v5
    v_cvt_pk_bf16_f32 v5, v6, v7
    ds_write_b64 v68, v[4:5] offset:16
    v_cvt_pk_bf16_f32 v70, v8, v9
    v_lshlrev_b32 v8, 16, v70
    v_and_b32 v9, 0xffff0000, v70
    v_cvt_pk_bf16_f32 v70, v10, v11
    v_lshlrev_b32 v10, 16, v70
    v_and_b32 v11, 0xffff0000, v70
    v_lshlrev_b32 v70, 16, v36
    v_and_b32 v71, 0xffff0000, v36
    v_lshlrev_b32 v72, 16, v37
    v_and_b32 v73, 0xffff0000, v37
    v_add_f32 v8, v8, v70
    v_add_f32 v9, v9, v71
    v_add_f32 v10, v10, v72
    v_add_f32 v11, v11, v73
    v_cvt_pk_bf16_f32 v8, v8, v9
    v_cvt_pk_bf16_f32 v9, v10, v11
    ds_write_b64 v68, v[8:9] offset:32
    v_cvt_pk_bf16_f32 v70, v12, v13
    v_lshlrev_b32 v12, 16, v70
    v_and_b32 v13, 0xffff0000, v70
    v_cvt_pk_bf16_f32 v70, v14, v15
    v_lshlrev_b32 v14, 16, v70
    v_and_b32 v15, 0xffff0000, v70
    v_lshlrev_b32 v70, 16, v38
    v_and_b32 v71, 0xffff0000, v38
    v_lshlrev_b32 v72, 16, v39
    v_and_b32 v73, 0xffff0000, v39
    v_add_f32 v12, v12, v70
    v_add_f32 v13, v13, v71
    v_add_f32 v14, v14, v72
    v_add_f32 v15, v15, v73
    v_cvt_pk_bf16_f32 v12, v12, v13
    v_cvt_pk_bf16_f32 v13, v14, v15
    ds_write_b64 v68, v[12:13] offset:48
    v_cvt_pk_bf16_f32 v70, v16, v17
    v_lshlrev_b32 v16, 16, v70
    v_and_b32 v17, 0xffff0000, v70
    v_cvt_pk_bf16_f32 v70, v18, v19
    v_lshlrev_b32 v18, 16, v70
    v_and_b32 v19, 0xffff0000, v70
    v_lshlrev_b32 v70, 16, v40
    v_and_b32 v71, 0xffff0000, v40
    v_lshlrev_b32 v72, 16, v41
    v_and_b32 v73, 0xffff0000, v41
    v_add_f32 v16, v16, v70
    v_add_f32 v17, v17, v71
    v_add_f32 v18, v18, v72
    v_add_f32 v19, v19, v73
    v_cvt_pk_bf16_f32 v16, v16, v17
    v_cvt_pk_bf16_f32 v17, v18, v19
    ds_write_b64 v68, v[16:17] offset:64
    v_cvt_pk_bf16_f32 v70, v20, v21
    v_lshlrev_b32 v20, 16, v70
    v_and_b32 v21, 0xffff0000, v70
    v_cvt_pk_bf16_f32 v70, v22, v23
    v_lshlrev_b32 v22, 16, v70
    v_and_b32 v23, 0xffff0000, v70
    v_lshlrev_b32 v70, 16, v42
    v_and_b32 v71, 0xffff0000, v42
    v_lshlrev_b32 v72, 16, v43
    v_and_b32 v73, 0xffff0000, v43
    v_add_f32 v20, v20, v70
    v_add_f32 v21, v21, v71
    v_add_f32 v22, v22, v72
    v_add_f32 v23, v23, v73
    v_cvt_pk_bf16_f32 v20, v20, v21
    v_cvt_pk_bf16_f32 v21, v22, v23
    ds_write_b64 v68, v[20:21] offset:80
    v_cvt_pk_bf16_f32 v70, v24, v25
    v_lshlrev_b32 v24, 16, v70
    v_and_b32 v25, 0xffff0000, v70
    v_cvt_pk_bf16_f32 v70, v26, v27
    v_lshlrev_b32 v26, 16, v70
    v_and_b32 v27, 0xffff0000, v70
    v_lshlrev_b32 v70, 16, v44
    v_and_b32 v71, 0xffff0000, v44
    v_lshlrev_b32 v72, 16, v45
    v_and_b32 v73, 0xffff0000, v45
    v_add_f32 v24, v24, v70
    v_add_f32 v25, v25, v71
    v_add_f32 v26, v26, v72
    v_add_f32 v27, v27, v73
    v_cvt_pk_bf16_f32 v24, v24, v25
    v_cvt_pk_bf16_f32 v25, v26, v27
    ds_write_b64 v68, v[24:25] offset:96
    v_cvt_pk_bf16_f32 v70, v28, v29
    v_lshlrev_b32 v28, 16, v70
    v_and_b32 v29, 0xffff0000, v70
    v_cvt_pk_bf16_f32 v70, v30, v31
    v_lshlrev_b32 v30, 16, v70
    v_and_b32 v31, 0xffff0000, v70
    v_lshlrev_b32 v70, 16, v46
    v_and_b32 v71, 0xffff0000, v46
    v_lshlrev_b32 v72, 16, v47
    v_and_b32 v73, 0xffff0000, v47
    v_add_f32 v28, v28, v70
    v_add_f32 v29, v29, v71
    v_add_f32 v30, v30, v72
    v_add_f32 v31, v31, v73
    v_cvt_pk_bf16_f32 v28, v28, v29
    v_cvt_pk_bf16_f32 v29, v30, v31
    ds_write_b64 v68, v[28:29] offset:112
    s_waitcnt lgkmcnt(0)
    s_barrier
    s_lshl_b32 s32, s28, 6
    v_add_u32 v74, s32, v76
    v_lshrrev_b32 v68, 4, v74
    v_and_b32 v69, 15, v74
    v_mul_u32_u24 v70, 272, v68
    v_lshl_add_u32 v70, v69, 4, v70
    s_mov_b32 s33, 1024
    v_mul_lo_u32 v71, v68, s33
    v_lshl_add_u32 v71, v69, 4, v71
    ds_read_b128 v[0:3], v70 offset:0
    s_mov_b32 s32, 0
    buffer_load_dwordx4 v[32:35], v71, s[24:27], s32 offen
    ds_read_b128 v[4:7], v70 offset:4352
    s_mov_b32 s32, 16384
    buffer_load_dwordx4 v[36:39], v71, s[24:27], s32 offen
    ds_read_b128 v[8:11], v70 offset:8704
    s_mov_b32 s32, 32768
    buffer_load_dwordx4 v[40:43], v71, s[24:27], s32 offen
    ds_read_b128 v[12:15], v70 offset:13056
    s_mov_b32 s32, 49152
    buffer_load_dwordx4 v[44:47], v71, s[24:27], s32 offen
    s_waitcnt vmcnt(0) lgkmcnt(0)
    v_lshlrev_b32 v72, 16, v0
    v_and_b32 v73, 0xffff0000, v0
    v_lshlrev_b32 v74, 16, v32
    v_and_b32 v75, 0xffff0000, v32
    v_add_f32 v72, v72, v74
    v_add_f32 v73, v73, v75
    v_cvt_pk_bf16_f32 v0, v72, v73
    v_lshlrev_b32 v72, 16, v1
    v_and_b32 v73, 0xffff0000, v1
    v_lshlrev_b32 v74, 16, v33
    v_and_b32 v75, 0xffff0000, v33
    v_add_f32 v72, v72, v74
    v_add_f32 v73, v73, v75
    v_cvt_pk_bf16_f32 v1, v72, v73
    v_lshlrev_b32 v72, 16, v2
    v_and_b32 v73, 0xffff0000, v2
    v_lshlrev_b32 v74, 16, v34
    v_and_b32 v75, 0xffff0000, v34
    v_add_f32 v72, v72, v74
    v_add_f32 v73, v73, v75
    v_cvt_pk_bf16_f32 v2, v72, v73
    v_lshlrev_b32 v72, 16, v3
    v_and_b32 v73, 0xffff0000, v3
    v_lshlrev_b32 v74, 16, v35
    v_and_b32 v75, 0xffff0000, v35
    v_add_f32 v72, v72, v74
    v_add_f32 v73, v73, v75
    v_cvt_pk_bf16_f32 v3, v72, v73
    s_mov_b32 s32, 0
    buffer_store_dwordx4 v[0:3], v71, s[16:19], s32 offen
    v_lshlrev_b32 v72, 16, v4
    v_and_b32 v73, 0xffff0000, v4
    v_lshlrev_b32 v74, 16, v36
    v_and_b32 v75, 0xffff0000, v36
    v_add_f32 v72, v72, v74
    v_add_f32 v73, v73, v75
    v_cvt_pk_bf16_f32 v4, v72, v73
    v_lshlrev_b32 v72, 16, v5
    v_and_b32 v73, 0xffff0000, v5
    v_lshlrev_b32 v74, 16, v37
    v_and_b32 v75, 0xffff0000, v37
    v_add_f32 v72, v72, v74
    v_add_f32 v73, v73, v75
    v_cvt_pk_bf16_f32 v5, v72, v73
    v_lshlrev_b32 v72, 16, v6
    v_and_b32 v73, 0xffff0000, v6
    v_lshlrev_b32 v74, 16, v38
    v_and_b32 v75, 0xffff0000, v38
    v_add_f32 v72, v72, v74
    v_add_f32 v73, v73, v75
    v_cvt_pk_bf16_f32 v6, v72, v73
    v_lshlrev_b32 v72, 16, v7
    v_and_b32 v73, 0xffff0000, v7
    v_lshlrev_b32 v74, 16, v39
    v_and_b32 v75, 0xffff0000, v39
    v_add_f32 v72, v72, v74
    v_add_f32 v73, v73, v75
    v_cvt_pk_bf16_f32 v7, v72, v73
    s_mov_b32 s32, 16384
    buffer_store_dwordx4 v[4:7], v71, s[16:19], s32 offen
    v_lshlrev_b32 v72, 16, v8
    v_and_b32 v73, 0xffff0000, v8
    v_lshlrev_b32 v74, 16, v40
    v_and_b32 v75, 0xffff0000, v40
    v_add_f32 v72, v72, v74
    v_add_f32 v73, v73, v75
    v_cvt_pk_bf16_f32 v8, v72, v73
    v_lshlrev_b32 v72, 16, v9
    v_and_b32 v73, 0xffff0000, v9
    v_lshlrev_b32 v74, 16, v41
    v_and_b32 v75, 0xffff0000, v41
    v_add_f32 v72, v72, v74
    v_add_f32 v73, v73, v75
    v_cvt_pk_bf16_f32 v9, v72, v73
    v_lshlrev_b32 v72, 16, v10
    v_and_b32 v73, 0xffff0000, v10
    v_lshlrev_b32 v74, 16, v42
    v_and_b32 v75, 0xffff0000, v42
    v_add_f32 v72, v72, v74
    v_add_f32 v73, v73, v75
    v_cvt_pk_bf16_f32 v10, v72, v73
    v_lshlrev_b32 v72, 16, v11
    v_and_b32 v73, 0xffff0000, v11
    v_lshlrev_b32 v74, 16, v43
    v_and_b32 v75, 0xffff0000, v43
    v_add_f32 v72, v72, v74
    v_add_f32 v73, v73, v75
    v_cvt_pk_bf16_f32 v11, v72, v73
    s_mov_b32 s32, 32768
    buffer_store_dwordx4 v[8:11], v71, s[16:19], s32 offen
    v_lshlrev_b32 v72, 16, v12
    v_and_b32 v73, 0xffff0000, v12
    v_lshlrev_b32 v74, 16, v44
    v_and_b32 v75, 0xffff0000, v44
    v_add_f32 v72, v72, v74
    v_add_f32 v73, v73, v75
    v_cvt_pk_bf16_f32 v12, v72, v73
    v_lshlrev_b32 v72, 16, v13
    v_and_b32 v73, 0xffff0000, v13
    v_lshlrev_b32 v74, 16, v45
    v_and_b32 v75, 0xffff0000, v45
    v_add_f32 v72, v72, v74
    v_add_f32 v73, v73, v75
    v_cvt_pk_bf16_f32 v13, v72, v73
    v_lshlrev_b32 v72, 16, v14
    v_and_b32 v73, 0xffff0000, v14
    v_lshlrev_b32 v74, 16, v46
    v_and_b32 v75, 0xffff0000, v46
    v_add_f32 v72, v72, v74
    v_add_f32 v73, v73, v75
    v_cvt_pk_bf16_f32 v14, v72, v73
    v_lshlrev_b32 v72, 16, v15
    v_and_b32 v73, 0xffff0000, v15
    v_lshlrev_b32 v74, 16, v47
    v_and_b32 v75, 0xffff0000, v47
    v_add_f32 v72, v72, v74
    v_add_f32 v73, v73, v75
    v_cvt_pk_bf16_f32 v15, v72, v73
    s_mov_b32 s32, 49152
    buffer_store_dwordx4 v[12:15], v71, s[16:19], s32 offen
ffn2_kernel_done:
    s_endpgm
.section .rodata,"a"
.p2align 6
.amdhsa_kernel ffn2_kernel
  .amdhsa_next_free_vgpr 101
  .amdhsa_next_free_sgpr 48
  .amdhsa_accum_offset 104
  .amdhsa_group_segment_fixed_size 0
  .amdhsa_kernarg_size 112
  .amdhsa_user_sgpr_count 2
  .amdhsa_user_sgpr_kernarg_segment_ptr 1
  .amdhsa_system_sgpr_workgroup_id_x 1
.end_amdhsa_kernel
.text
```
